```python
import torch

def _softmax(x, axis=-1):
    return torch.softmax(x, dim=axis)

def _gelu(x):
    return torch.nn.functional.gelu(x, approximate='tanh')

def _silu(x):
    return torch.nn.functional.silu(x)

def _sigmoid(x):
    return torch.sigmoid(x)

def _layernorm(x, axis=-1, eps=1e-05):
    m = x.mean(dim=axis, keepdim=True)
    v = x.var(dim=axis, keepdim=True, unbiased=False)
    return (x - m) / torch.sqrt(v + eps)

def _scatter_add(tgt, idx, src, axis=0):
    return tgt.clone().index_add_(axis, idx, src)

def _segment_sum(src, seg, n):
    out = torch.zeros((n,) + src.shape[1:], dtype=src.dtype)
    return out.index_add_(0, seg, src)

def _pad(x, pw):
    flat = tuple((v for pair in reversed(pw) for v in pair))
    return torch.nn.functional.pad(x, flat)
kernel_name = 'concat_heads__sliding_block__memory_aug_recurrent_mem_tr__prompt'

def setup_inputs():

    _w = lambda a: (lambda t: t.to(torch.bfloat16) if t.is_floating_point() else t)(torch.as_tensor(a))

    def _A_setup():
        B, S, D = (1, 2048, 640)
        return {'x': _w((lambda *s: torch.randn(*s, dtype=torch.bfloat16) * 0.2)(B, S, D)), 'wqkv': _w((lambda *s: torch.randn(*s, dtype=torch.bfloat16) * 0.2)(D, 3 * D)), 'wo': _w((lambda *s: torch.randn(*s, dtype=torch.bfloat16) * 0.05)(D, D))}
    _A_in = _A_setup()

    def _B_setup():
        B, S, Dm = (1, 2048, 640)
        H, Dh = (32, 128)
        M, seg = (8, 32)
        seg = min(seg, S)
        S = S // seg * seg
        return {'x': _w((lambda *s: torch.randn(*s, dtype=torch.bfloat16) * 0.05)(B, S, Dm)), 'mem0': _w((lambda *s: torch.randn(*s, dtype=torch.bfloat16) * 1.6)(B, M, Dm)), 'Wq': _w((lambda *s: torch.randn(*s, dtype=torch.bfloat16) * 0.8)(Dm, H, Dh) * Dm ** (-0.5)), 'Wk': _w((lambda *s: torch.randn(*s, dtype=torch.bfloat16) * 0.8)(Dm, H, Dh) * Dm ** (-0.5)), 'Wv': _w((lambda *s: torch.randn(*s, dtype=torch.bfloat16) * 1.6)(Dm, H, Dh) * Dm ** (-0.5)), 'Wo': _w((lambda *s: torch.randn(*s, dtype=torch.bfloat16) * 1.6)(H, Dh, Dm) * (H * Dh) ** (-0.5)), 'seg_len': seg}
    _B_in = _B_setup()
    return {'A_x': _A_in['x'], 'A_wqkv': _A_in['wqkv'], 'A_wo': _A_in['wo'], 'B_x': _B_in['x'], 'B_mem0': _B_in['mem0'], 'B_Wq': _B_in['Wq'], 'B_Wk': _B_in['Wk'], 'B_Wv': _B_in['Wv'], 'B_Wo': _B_in['Wo'], 'B_seg_len': _B_in['seg_len']}

def reference(A_x, A_wqkv, A_wo, B_x, B_mem0, B_Wq, B_Wk, B_Wv, B_Wo, B_seg_len):

    def _A_ref(x, wqkv, wo):
        B, S, D = x.shape
        H = 32
        Dh = D // H
        W = 256
        qkv = (lambda x, *d: x.permute(*d))((x @ wqkv).reshape(B, S, 3, H, Dh), 2, 0, 3, 1, 4)
        q, k, v = (qkv[0], qkv[1], qkv[2])
        scores = torch.einsum('bhqd,bhkd->bhqk', q, k) * Dh ** (-0.5)
        idx = torch.arange(S)
        mask = (idx[:, None] - idx[None, :] >= 0) & (idx[:, None] - idx[None, :] < W)
        scores = torch.where(mask[None, None], scores, -1000000000.0)
        p = _softmax(scores, axis=-1)
        o = torch.einsum('bhqk,bhkd->bhqd', p, v)
        return (lambda x, *d: x.permute(*d))(o, 0, 2, 1, 3).reshape(B, S, D) @ wo

    def _B_ref(x, mem0, Wq, Wk, Wv, Wo, seg_len):
        B, S, Dm = x.shape
        H, Dh = (Wq.shape[1], Wq.shape[2])
        M = mem0.shape[1]
        scale = Dh ** (-0.5)
        n_seg = S // seg_len
        L = M + seg_len
        idx = torch.arange(L)
        mask = (idx[:, None] < M) | (idx[:, None] >= idx[None, :])
        mem = mem0
        outs = []
        for s in range(n_seg):
            xs = x[:, s * seg_len:(s + 1) * seg_len, :].clone()
            h = torch.concatenate([mem, xs], axis=1)
            q = torch.einsum('btd,dhe->bhte', h, Wq)
            k = torch.einsum('btd,dhe->bhte', h, Wk)
            v = torch.einsum('btd,dhe->bhte', h, Wv)
            scores = torch.einsum('bhqe,bhke->bhqk', q, k) * scale
            scores = torch.where(mask[None, None], scores, -1000000000.0)
            p = _softmax(scores, axis=-1)
            o = torch.einsum('bhqk,bhke->bhqe', p, v)
            o = torch.einsum('bhte,hed->btd', o, Wo)
            mem = o[:, :M, :].clone()
            outs.append(o[:, M:, :])
        return torch.concatenate(outs, axis=1)
    a = _A_ref(A_x, A_wqkv, A_wo)
    b = _B_ref(B_x, B_mem0, B_Wq, B_Wk, B_Wv, B_Wo, B_seg_len)
    return torch.concatenate([a, b], axis=-1)
```

```asm
; @launch grid=(256,1,1) block=(256,1,1) lds=163840
.amdgcn_target "amdgcn-amd-amdhsa--gfx950"
.text
.globl concat_heads__sliding_block__memory_aug_recurrent_mem_tr__prompt_kernel
.p2align 8
.type concat_heads__sliding_block__memory_aug_recurrent_mem_tr__prompt_kernel,@function
concat_heads__sliding_block__memory_aug_recurrent_mem_tr__prompt_kernel:

  s_cmp_ge_u32 s2, 256
  s_cbranch_scc1 L_exit
  s_load_dwordx16 s[4:19], s[0:1], 0
  s_load_dwordx8 s[20:27], s[0:1], 64
  s_load_dwordx2 s[28:29], s[0:1], 96
  v_and_b32 v1, 63, v0
  v_lshrrev_b32 v2, 6, v0
  s_nop 0
  v_readfirstlane_b32 s56, v2
  s_and_b32 s30, s2, 7
  s_lshr_b32 s31, s2, 3
  s_lshl_b32 s31, s31, 2
  s_and_b32 s70, s30, 3
  s_add_u32 s31, s31, s70
  s_waitcnt lgkmcnt(0)

  s_mov_b32 s32, s28
  s_mov_b32 s33, s29
  s_mov_b32 s34, 268435456
  s_mov_b32 s35, 0x20000
  s_mov_b32 s52, s26
  s_mov_b32 s53, s27
  s_mov_b32 s54, 256
  s_mov_b32 s55, 0x20000
  s_mov_b32 s36, s10
  s_mov_b32 s37, s11
  s_mov_b32 s38, 2621440
  s_mov_b32 s39, 0x20000
  s_mov_b32 s40, s14
  s_mov_b32 s41, s15
  s_mov_b32 s42, 5242880
  s_mov_b32 s43, 0x20000
  s_mov_b32 s44, s28
  s_mov_b32 s45, s29
  s_mov_b32 s46, 268435456
  s_mov_b32 s47, 0x20000
  s_add_u32 s48, s28, 2097151
  s_addc_u32 s49, s29, 0
  s_and_b32 s48, s48, 0xffe00000
  s_mov_b32 s50, 2097152
  s_mov_b32 s51, 0x20000
  s_cmp_ge_u32 s30, 4
  s_cbranch_scc1 L_half1
  s_cmp_lt_u32 s31, 32
  s_cbranch_scc1 L_team1
  s_cmp_lt_u32 s31, 112
  s_cbranch_scc1 L_team2
  s_cmp_ge_u32 s31, 120
  s_cbranch_scc1 L_spare
  s_sub_u32 s57, s31, 24
  s_branch L_pw
L_half1:
  s_mov_b32 s57, s31
  s_cmp_lt_u32 s31, 88
  s_cbranch_scc1 L_pw
  s_sub_u32 s57, s31, 88
  s_branch L_team3

L_pw:
  s_lshl_b32 s58, s57, 7
  s_add_u32 s58, s58, 88080384
  s_cmp_eq_u32 s56, 0
  s_cselect_b32 s58, s58, 0x7ff00000
  v_mov_b32 v21, s58
  v_lshlrev_b32 v18, 4, v1
  s_mov_b32 s68, 0
  s_mov_b32 s69, 16
  s_mov_b32 s84, 0
  s_lshr_b32 s80, s57, 5
  s_and_b32 s81, s57, 31
  s_cmp_eq_u32 s80, 0
  s_cselect_b32 s40, s16, s14
  s_cselect_b32 s41, s17, s15
  s_cselect_b32 s82, 8192, 0
  s_cmp_eq_u32 s80, 1
  s_cselect_b32 s40, s18, s40
  s_cselect_b32 s41, s19, s41
  s_cselect_b32 s82, 16384, s82
  s_cselect_b32 s83, 11, 10
  s_movk_i32 s67, 4096
  s_cselect_b32 s67, 1024, s67
  s_mov_b32 s60, 8192
  s_lshl_b32 s61, s81, 8
  s_mov_b32 s62, 64
  s_mov_b32 s63, 32
  s_mov_b32 s64, 8
  s_mul_i32 s65, s81, 24576
  s_add_u32 s65, s65, s82
  s_lshl_b32 s70, s56, s83
  s_add_u32 s65, s65, s70
  s_add_u32 s65, s65, 4194304
  s_mov_b32 s66, 786432
  s_mov_b32 s59, 0
  s_lshr_b32 s83, s57, 2
  s_branch L_pwgo
L_pwA:
  s_mov_b32 s84, 2
  v_add_u32 v21, 12288, v21
  s_mul_i32 s83, s57, 2731
  s_lshr_b32 s83, s83, 16
  s_mul_i32 s81, s83, 24
  s_sub_u32 s81, s57, s81
  s_mul_i32 s68, s83, 655360
  s_mov_b32 s69, 4
  s_lshr_b32 s82, s81, 3
  s_and_b32 s81, s81, 7
  s_mov_b32 s36, s4
  s_mov_b32 s37, s5
  s_mov_b32 s40, s6
  s_mov_b32 s41, s7
  s_mov_b32 s42, 2457600
  s_mov_b32 s60, 3840
  s_mul_i32 s61, s82, 1280
  s_mul_i32 s70, s81, 160
  s_add_u32 s61, s61, s70
  s_mov_b32 s62, 40
  s_mov_b32 s63, 32
  s_mov_b32 s64, 8
  s_lshl_b32 s65, s81, 2
  s_add_u32 s65, s65, s56
  s_lshl_b32 s65, s65, 17
  s_lshl_b32 s70, s82, 22
  s_add_u32 s65, s65, s70
  s_add_u32 s65, s65, 71303168
  s_lshl_b32 s70, s83, 15
  s_add_u32 s65, s65, s70
  s_mov_b32 s66, 2048
  s_mov_b32 s67, 1024
  s_mov_b32 s59, 1
  s_cmp_eq_u32 s82, 2
  s_cselect_b32 s80, 1, 0
  s_lshl_b32 s83, s82, 1
  s_lshr_b32 s70, s81, 2
  s_add_u32 s83, s83, s70
L_pwgo:

  v_lshrrev_b32 v22, 4, v1
  v_and_b32 v23, 15, v1

  v_add_u32 v24, 0, v22
  v_xor_b32 v25, v24, v23
  v_mul_u32_u24 v24, 1280, v24
  v_lshl_add_u32 v2, v25, 4, v24
  v_add_u32 v24, 4, v22
  v_xor_b32 v25, v24, v23
  v_mul_u32_u24 v24, 1280, v24
  v_lshl_add_u32 v3, v25, 4, v24
  v_add_u32 v24, 8, v22
  v_xor_b32 v25, v24, v23
  v_mul_u32_u24 v24, 1280, v24
  v_lshl_add_u32 v4, v25, 4, v24
  v_add_u32 v24, 12, v22
  v_xor_b32 v25, v24, v23
  v_mul_u32_u24 v24, 1280, v24
  v_lshl_add_u32 v5, v25, 4, v24
  v_mul_lo_u32 v24, v22, s60
  v_add_u32 v25, 0, v22
  v_lshlrev_b32 v25, 1, v25
  v_xor_b32 v25, v25, v23
  v_lshl_add_u32 v6, v25, 4, v24
  v_add_u32 v25, 4, v22
  v_lshlrev_b32 v25, 1, v25
  v_xor_b32 v25, v25, v23
  v_lshl_add_u32 v7, v25, 4, v24
  v_lshrrev_b32 v24, 2, v23
  v_and_b32 v25, 3, v1
  v_lshl_add_u32 v26, v22, 3, v24
  v_lshlrev_b32 v26, 8, v26
  v_and_b32 v27, 1, v22
  v_lshl_add_u32 v27, v27, 2, v24
  v_lshlrev_b32 v27, 1, v27
  v_mul_lo_u32 v25, v25, s64
  s_mul_i32 s70, s56, s62
  v_add_u32 v25, s70, v25

  v_lshrrev_b32 v28, 4, v25
  v_xor_b32 v28, v28, v27
  v_lshl_add_u32 v28, v28, 4, v26
  v_and_b32 v29, 8, v25
  v_add_u32 v8, v28, v29
  v_add_u32 v25, s63, v25
  v_lshrrev_b32 v28, 4, v25
  v_xor_b32 v28, v28, v27
  v_lshl_add_u32 v28, v28, 4, v26
  v_and_b32 v29, 8, v25
  v_add_u32 v9, v28, v29
  v_add_u32 v24, 0, v22
  v_xor_b32 v24, v24, v23
  v_lshlrev_b32 v24, 4, v24
  v_lshl_add_u32 v30, v23, 8, v24
  v_add_u32 v34, 0x10000, v30
  v_add_u32 v38, 0x20000, v30
  v_add_u32 v24, 4, v22
  v_xor_b32 v24, v24, v23
  v_lshlrev_b32 v24, 4, v24
  v_lshl_add_u32 v31, v23, 8, v24
  v_add_u32 v35, 0x10000, v31
  v_add_u32 v39, 0x20000, v31
  v_add_u32 v24, 8, v22
  v_xor_b32 v24, v24, v23
  v_lshlrev_b32 v24, 4, v24
  v_lshl_add_u32 v32, v23, 8, v24
  v_add_u32 v36, 0x10000, v32
  v_add_u32 v40, 0x20000, v32
  v_add_u32 v24, 12, v22
  v_xor_b32 v24, v24, v23
  v_lshlrev_b32 v24, 4, v24
  v_lshl_add_u32 v33, v23, 8, v24
  v_add_u32 v37, 0x10000, v33
  v_add_u32 v41, 0x20000, v33
  v_cmp_eq_u32 vcc, 0, v22
  s_nop 1
  v_cndmask_b32 v19, 0, -1, vcc
  s_cmp_eq_u32 s59, 0
  s_cselect_b32 s70, -1, 0
  v_or_b32 v19, s70, v19
  v_cmp_eq_u32 vcc, 4, v23
  v_mov_b32 v24, 0x3f803f80
  s_nop 0
  v_cndmask_b32 v42, 0, v24, vcc
  v_cndmask_b32 v43, -1, 0, vcc
  v_or_b32 v43, s70, v43
  v_not_b32 v24, v43
  v_and_b32 v42, v24, v42
  s_lshl_b32 s74, s56, 13
  s_mul_i32 s70, s56, 32
  s_mul_i32 s76, s70, s60
  s_add_u32 s76, s76, s61
  s_lshl_b32 s77, s60, 2
  s_mul_i32 s78, s60, 96
  s_mul_i32 s70, s70, 1280
  s_add_u32 s72, s68, s70
  s_add_u32 s73, s72, 163840
  s_lshl_b32 s85, s83, 2
  s_add_u32 s85, s85, s56
  s_mul_i32 s70, s85, 7168
  s_add_u32 s70, s70, s68
  s_add_u32 s70, s70, 327680
  s_cmp_lt_u32 s85, 23
  s_cselect_b32 s85, s70, 0x7ff00000
  v_lshlrev_b32 v46, 4, v1
  s_add_u32 m0, s74, 65536
  s_nop 0
  buffer_load_dwordx4 v6, s[40:43], s76 offen  lds
  s_add_u32 s76, s76, s77
  s_add_u32 m0, s74, 66560
  s_nop 0
  buffer_load_dwordx4 v6, s[40:43], s76 offen  lds
  s_add_u32 s76, s76, s77
  s_add_u32 m0, s74, 67584
  s_nop 0
  buffer_load_dwordx4 v7, s[40:43], s76 offen  lds
  s_add_u32 s76, s76, s77
  s_add_u32 m0, s74, 68608
  s_nop 0
  buffer_load_dwordx4 v7, s[40:43], s76 offen  lds
  s_add_u32 s76, s76, s77
  s_add_u32 m0, s74, 69632
  s_nop 0
  buffer_load_dwordx4 v6, s[40:43], s76 offen  lds
  s_add_u32 s76, s76, s77
  s_add_u32 m0, s74, 70656
  s_nop 0
  buffer_load_dwordx4 v6, s[40:43], s76 offen  lds
  s_add_u32 s76, s76, s77
  s_add_u32 m0, s74, 71680
  s_nop 0
  buffer_load_dwordx4 v7, s[40:43], s76 offen  lds
  s_add_u32 s76, s76, s77
  s_add_u32 m0, s74, 72704
  s_nop 0
  buffer_load_dwordx4 v7, s[40:43], s76 offen  lds
  s_add_u32 s76, s76, s77
  s_add_u32 s76, s76, s78
  s_add_u32 s75, s72, 0
  s_add_u32 m0, s74, 0
  s_nop 0
  buffer_load_dwordx4 v2, s[36:39], s75 offen lds
  s_add_u32 s75, s72, 0
  s_add_u32 m0, s74, 1024
  s_nop 0
  buffer_load_dwordx4 v3, s[36:39], s75 offen lds
  s_add_u32 s75, s72, 0
  s_add_u32 m0, s74, 2048
  s_nop 0
  buffer_load_dwordx4 v4, s[36:39], s75 offen lds
  s_add_u32 s75, s72, 0
  s_add_u32 m0, s74, 3072
  s_nop 0
  buffer_load_dwordx4 v5, s[36:39], s75 offen lds
  s_add_u32 s75, s72, 20480
  s_add_u32 m0, s74, 4096
  s_nop 0
  buffer_load_dwordx4 v2, s[36:39], s75 offen lds
  s_add_u32 s75, s72, 20480
  s_add_u32 m0, s74, 5120
  s_nop 0
  buffer_load_dwordx4 v3, s[36:39], s75 offen lds
  s_add_u32 s75, s72, 20480
  s_add_u32 m0, s74, 6144
  s_nop 0
  buffer_load_dwordx4 v4, s[36:39], s75 offen lds
  s_add_u32 s75, s72, 20480
  s_add_u32 m0, s74, 7168
  s_nop 0
  buffer_load_dwordx4 v5, s[36:39], s75 offen lds
  s_add_u32 m0, s74, 98304
  s_nop 0
  buffer_load_dwordx4 v6, s[40:43], s76 offen  lds
  s_add_u32 s76, s76, s77
  s_add_u32 m0, s74, 99328
  s_nop 0
  buffer_load_dwordx4 v6, s[40:43], s76 offen  lds
  s_add_u32 s76, s76, s77
  s_add_u32 m0, s74, 100352
  s_nop 0
  buffer_load_dwordx4 v7, s[40:43], s76 offen  lds
  s_add_u32 s76, s76, s77
  s_add_u32 m0, s74, 101376
  s_nop 0
  buffer_load_dwordx4 v7, s[40:43], s76 offen  lds
  s_add_u32 s76, s76, s77
  s_add_u32 m0, s74, 102400
  s_nop 0
  buffer_load_dwordx4 v6, s[40:43], s76 offen  lds
  s_add_u32 s76, s76, s77
  s_add_u32 m0, s74, 103424
  s_nop 0
  buffer_load_dwordx4 v6, s[40:43], s76 offen  lds
  s_add_u32 s76, s76, s77
  s_add_u32 m0, s74, 104448
  s_nop 0
  buffer_load_dwordx4 v7, s[40:43], s76 offen  lds
  s_add_u32 s76, s76, s77
  s_add_u32 m0, s74, 105472
  s_nop 0
  buffer_load_dwordx4 v7, s[40:43], s76 offen  lds
  s_add_u32 s76, s76, s77
  s_add_u32 s76, s76, s78
  s_cmp_eq_u32 s80, 1
  s_cbranch_scc1 L_pwN
L_pwT:
  s_waitcnt vmcnt(16)
  s_waitcnt vmcnt(8)
  s_barrier
  v_add_u32 v44, 65536, v8
  v_add_u32 v45, 65536, v9
  ds_read_b64_tr_b16 a[0:1], v44 offset:0
  ds_read_b64_tr_b16 a[2:3], v44 offset:1024
  ds_read_b64_tr_b16 a[4:5], v45 offset:0
  ds_read_b64_tr_b16 a[6:7], v45 offset:1024
  ds_read_b64_tr_b16 a[8:9], v44 offset:8192
  ds_read_b64_tr_b16 a[10:11], v44 offset:9216
  ds_read_b64_tr_b16 a[12:13], v45 offset:8192
  ds_read_b64_tr_b16 a[14:15], v45 offset:9216
  ds_read_b64_tr_b16 a[16:17], v44 offset:16384
  ds_read_b64_tr_b16 a[18:19], v44 offset:17408
  ds_read_b64_tr_b16 a[20:21], v45 offset:16384
  ds_read_b64_tr_b16 a[22:23], v45 offset:17408
  ds_read_b64_tr_b16 a[24:25], v44 offset:24576
  ds_read_b64_tr_b16 a[26:27], v44 offset:25600
  ds_read_b64_tr_b16 a[28:29], v45 offset:24576
  ds_read_b64_tr_b16 a[30:31], v45 offset:25600
  s_waitcnt lgkmcnt(0)
  ds_read_b128 v[128:131], v30 offset:0
  ds_read_b128 v[132:135], v30 offset:4096
  ds_read_b128 v[136:139], v30 offset:8192
  ds_read_b128 v[140:143], v30 offset:12288
  ds_read_b128 v[144:147], v30 offset:16384
  ds_read_b128 v[148:151], v30 offset:20480
  ds_read_b128 v[152:155], v30 offset:24576
  ds_read_b128 v[156:159], v30 offset:28672
  s_waitcnt lgkmcnt(7)
  v_mfma_f32_16x16x32_bf16 v[64:67], a[0:3], v[128:131], 0
  v_mfma_f32_16x16x32_bf16 v[68:71], a[4:7], v[128:131], 0
  ds_read_b128 v[160:163], v31 offset:0
  s_waitcnt lgkmcnt(7)
  v_mfma_f32_16x16x32_bf16 v[72:75], a[0:3], v[132:135], 0
  v_mfma_f32_16x16x32_bf16 v[76:79], a[4:7], v[132:135], 0
  ds_read_b128 v[164:167], v31 offset:4096
  s_add_u32 s75, s72, 256
  s_add_u32 m0, s74, 32768
  s_nop 0
  buffer_load_dwordx4 v2, s[36:39], s75 offen lds
  s_waitcnt lgkmcnt(7)
  v_mfma_f32_16x16x32_bf16 v[80:83], a[0:3], v[136:139], 0
  v_mfma_f32_16x16x32_bf16 v[84:87], a[4:7], v[136:139], 0
  ds_read_b128 v[168:171], v31 offset:8192
  s_waitcnt lgkmcnt(7)
  v_mfma_f32_16x16x32_bf16 v[88:91], a[0:3], v[140:143], 0
  v_mfma_f32_16x16x32_bf16 v[92:95], a[4:7], v[140:143], 0
  ds_read_b128 v[172:175], v31 offset:12288
  s_add_u32 s75, s72, 256
  s_add_u32 m0, s74, 33792
  s_nop 0
  buffer_load_dwordx4 v3, s[36:39], s75 offen lds
  s_waitcnt lgkmcnt(7)
  v_mfma_f32_16x16x32_bf16 v[96:99], a[0:3], v[144:147], 0
  v_mfma_f32_16x16x32_bf16 v[100:103], a[4:7], v[144:147], 0
  ds_read_b128 v[176:179], v31 offset:16384
  s_waitcnt lgkmcnt(7)
  v_mfma_f32_16x16x32_bf16 v[104:107], a[0:3], v[148:151], 0
  v_mfma_f32_16x16x32_bf16 v[108:111], a[4:7], v[148:151], 0
  ds_read_b128 v[180:183], v31 offset:20480
  s_add_u32 s75, s72, 256
  s_add_u32 m0, s74, 34816
  s_nop 0
  buffer_load_dwordx4 v4, s[36:39], s75 offen lds
  s_waitcnt lgkmcnt(7)
  v_mfma_f32_16x16x32_bf16 v[112:115], a[0:3], v[152:155], 0
  v_mfma_f32_16x16x32_bf16 v[116:119], a[4:7], v[152:155], 0
  ds_read_b128 v[184:187], v31 offset:24576
  s_waitcnt lgkmcnt(7)
  v_mfma_f32_16x16x32_bf16 v[120:123], a[0:3], v[156:159], 0
  v_mfma_f32_16x16x32_bf16 v[124:127], a[4:7], v[156:159], 0
  ds_read_b128 v[188:191], v31 offset:28672
  s_add_u32 s75, s72, 256
  s_add_u32 m0, s74, 35840
  s_nop 0
  buffer_load_dwordx4 v5, s[36:39], s75 offen lds
  s_waitcnt lgkmcnt(7)
  v_mfma_f32_16x16x32_bf16 v[64:67], a[8:11], v[160:163], v[64:67]
  v_mfma_f32_16x16x32_bf16 v[68:71], a[12:15], v[160:163], v[68:71]
  ds_read_b128 v[128:131], v32 offset:0
  s_waitcnt lgkmcnt(7)
  v_mfma_f32_16x16x32_bf16 v[72:75], a[8:11], v[164:167], v[72:75]
  v_mfma_f32_16x16x32_bf16 v[76:79], a[12:15], v[164:167], v[76:79]
  ds_read_b128 v[132:135], v32 offset:4096
  s_add_u32 s75, s72, 20736
  s_add_u32 m0, s74, 36864
  s_nop 0
  buffer_load_dwordx4 v2, s[36:39], s75 offen lds
  s_waitcnt lgkmcnt(7)
  v_mfma_f32_16x16x32_bf16 v[80:83], a[8:11], v[168:171], v[80:83]
  v_mfma_f32_16x16x32_bf16 v[84:87], a[12:15], v[168:171], v[84:87]
  ds_read_b128 v[136:139], v32 offset:8192
  s_waitcnt lgkmcnt(7)
  v_mfma_f32_16x16x32_bf16 v[88:91], a[8:11], v[172:175], v[88:91]
  v_mfma_f32_16x16x32_bf16 v[92:95], a[12:15], v[172:175], v[92:95]
  ds_read_b128 v[140:143], v32 offset:12288
  s_add_u32 s75, s72, 20736
  s_add_u32 m0, s74, 37888
  s_nop 0
  buffer_load_dwordx4 v3, s[36:39], s75 offen lds
  s_waitcnt lgkmcnt(7)
  v_mfma_f32_16x16x32_bf16 v[96:99], a[8:11], v[176:179], v[96:99]
  v_mfma_f32_16x16x32_bf16 v[100:103], a[12:15], v[176:179], v[100:103]
  ds_read_b128 v[144:147], v32 offset:16384
  s_waitcnt lgkmcnt(7)
  v_mfma_f32_16x16x32_bf16 v[104:107], a[8:11], v[180:183], v[104:107]
  v_mfma_f32_16x16x32_bf16 v[108:111], a[12:15], v[180:183], v[108:111]
  ds_read_b128 v[148:151], v32 offset:20480
  s_add_u32 s75, s72, 20736
  s_add_u32 m0, s74, 38912
  s_nop 0
  buffer_load_dwordx4 v4, s[36:39], s75 offen lds
  s_waitcnt lgkmcnt(7)
  v_mfma_f32_16x16x32_bf16 v[112:115], a[8:11], v[184:187], v[112:115]
  v_mfma_f32_16x16x32_bf16 v[116:119], a[12:15], v[184:187], v[116:119]
  ds_read_b128 v[152:155], v32 offset:24576
  s_waitcnt lgkmcnt(7)
  v_mfma_f32_16x16x32_bf16 v[120:123], a[8:11], v[188:191], v[120:123]
  v_mfma_f32_16x16x32_bf16 v[124:127], a[12:15], v[188:191], v[124:127]
  ds_read_b128 v[156:159], v32 offset:28672
  s_add_u32 s75, s72, 20736
  s_add_u32 m0, s74, 39936
  s_nop 0
  buffer_load_dwordx4 v5, s[36:39], s75 offen lds
  s_waitcnt lgkmcnt(7)
  v_mfma_f32_16x16x32_bf16 v[64:67], a[16:19], v[128:131], v[64:67]
  v_mfma_f32_16x16x32_bf16 v[68:71], a[20:23], v[128:131], v[68:71]
  ds_read_b128 v[160:163], v33 offset:0
  s_waitcnt lgkmcnt(7)
  v_mfma_f32_16x16x32_bf16 v[72:75], a[16:19], v[132:135], v[72:75]
  v_mfma_f32_16x16x32_bf16 v[76:79], a[20:23], v[132:135], v[76:79]
  ds_read_b128 v[164:167], v33 offset:4096
  s_add_u32 m0, s74, 131072
  s_nop 0
  buffer_load_dwordx4 v6, s[40:43], s76 offen  lds
  s_add_u32 s76, s76, s77
  s_waitcnt lgkmcnt(7)
  v_mfma_f32_16x16x32_bf16 v[80:83], a[16:19], v[136:139], v[80:83]
  v_mfma_f32_16x16x32_bf16 v[84:87], a[20:23], v[136:139], v[84:87]
  ds_read_b128 v[168:171], v33 offset:8192
  s_waitcnt lgkmcnt(7)
  v_mfma_f32_16x16x32_bf16 v[88:91], a[16:19], v[140:143], v[88:91]
  v_mfma_f32_16x16x32_bf16 v[92:95], a[20:23], v[140:143], v[92:95]
  ds_read_b128 v[172:175], v33 offset:12288
  s_add_u32 m0, s74, 132096
  s_nop 0
  buffer_load_dwordx4 v6, s[40:43], s76 offen  lds
  s_add_u32 s76, s76, s77
  s_waitcnt lgkmcnt(7)
  v_mfma_f32_16x16x32_bf16 v[96:99], a[16:19], v[144:147], v[96:99]
  v_mfma_f32_16x16x32_bf16 v[100:103], a[20:23], v[144:147], v[100:103]
  ds_read_b128 v[176:179], v33 offset:16384
  s_waitcnt lgkmcnt(7)
  v_mfma_f32_16x16x32_bf16 v[104:107], a[16:19], v[148:151], v[104:107]
  v_mfma_f32_16x16x32_bf16 v[108:111], a[20:23], v[148:151], v[108:111]
  ds_read_b128 v[180:183], v33 offset:20480
  s_add_u32 m0, s74, 133120
  s_nop 0
  buffer_load_dwordx4 v7, s[40:43], s76 offen  lds
  s_add_u32 s76, s76, s77
  s_waitcnt lgkmcnt(7)
  v_mfma_f32_16x16x32_bf16 v[112:115], a[16:19], v[152:155], v[112:115]
  v_mfma_f32_16x16x32_bf16 v[116:119], a[20:23], v[152:155], v[116:119]
  ds_read_b128 v[184:187], v33 offset:24576
  s_waitcnt lgkmcnt(7)
  v_mfma_f32_16x16x32_bf16 v[120:123], a[16:19], v[156:159], v[120:123]
  v_mfma_f32_16x16x32_bf16 v[124:127], a[20:23], v[156:159], v[124:127]
  ds_read_b128 v[188:191], v33 offset:28672
  s_add_u32 m0, s74, 134144
  s_nop 0
  buffer_load_dwordx4 v7, s[40:43], s76 offen  lds
  s_add_u32 s76, s76, s77
  s_waitcnt lgkmcnt(7)
  v_mfma_f32_16x16x32_bf16 v[64:67], a[24:27], v[160:163], v[64:67]
  v_mfma_f32_16x16x32_bf16 v[68:71], a[28:31], v[160:163], v[68:71]
  s_waitcnt lgkmcnt(6)
  v_mfma_f32_16x16x32_bf16 v[72:75], a[24:27], v[164:167], v[72:75]
  v_mfma_f32_16x16x32_bf16 v[76:79], a[28:31], v[164:167], v[76:79]
  s_add_u32 m0, s74, 135168
  s_nop 0
  buffer_load_dwordx4 v6, s[40:43], s76 offen  lds
  s_add_u32 s76, s76, s77
  s_waitcnt lgkmcnt(5)
  v_mfma_f32_16x16x32_bf16 v[80:83], a[24:27], v[168:171], v[80:83]
  v_mfma_f32_16x16x32_bf16 v[84:87], a[28:31], v[168:171], v[84:87]
  s_waitcnt lgkmcnt(4)
  v_mfma_f32_16x16x32_bf16 v[88:91], a[24:27], v[172:175], v[88:91]
  v_mfma_f32_16x16x32_bf16 v[92:95], a[28:31], v[172:175], v[92:95]
  s_add_u32 m0, s74, 136192
  s_nop 0
  buffer_load_dwordx4 v6, s[40:43], s76 offen  lds
  s_add_u32 s76, s76, s77
  s_waitcnt lgkmcnt(3)
  v_mfma_f32_16x16x32_bf16 v[96:99], a[24:27], v[176:179], v[96:99]
  v_mfma_f32_16x16x32_bf16 v[100:103], a[28:31], v[176:179], v[100:103]
  s_waitcnt lgkmcnt(2)
  v_mfma_f32_16x16x32_bf16 v[104:107], a[24:27], v[180:183], v[104:107]
  v_mfma_f32_16x16x32_bf16 v[108:111], a[28:31], v[180:183], v[108:111]
  s_add_u32 m0, s74, 137216
  s_nop 0
  buffer_load_dwordx4 v7, s[40:43], s76 offen  lds
  s_add_u32 s76, s76, s77
  s_waitcnt lgkmcnt(1)
  v_mfma_f32_16x16x32_bf16 v[112:115], a[24:27], v[184:187], v[112:115]
  v_mfma_f32_16x16x32_bf16 v[116:119], a[28:31], v[184:187], v[116:119]
  s_waitcnt lgkmcnt(0)
  v_mfma_f32_16x16x32_bf16 v[120:123], a[24:27], v[188:191], v[120:123]
  v_mfma_f32_16x16x32_bf16 v[124:127], a[28:31], v[188:191], v[124:127]
  s_add_u32 m0, s74, 138240
  s_nop 0
  buffer_load_dwordx4 v7, s[40:43], s76 offen  lds
  s_add_u32 s76, s76, s77
  s_add_u32 s76, s76, s78
  s_waitcnt vmcnt(16)
  s_waitcnt vmcnt(8)
  s_barrier
  v_add_u32 v44, 98304, v8
  v_add_u32 v45, 98304, v9
  ds_read_b64_tr_b16 a[32:33], v44 offset:0
  ds_read_b64_tr_b16 a[34:35], v44 offset:1024
  ds_read_b64_tr_b16 a[36:37], v45 offset:0
  ds_read_b64_tr_b16 a[38:39], v45 offset:1024
  ds_read_b64_tr_b16 a[40:41], v44 offset:8192
  ds_read_b64_tr_b16 a[42:43], v44 offset:9216
  ds_read_b64_tr_b16 a[44:45], v45 offset:8192
  ds_read_b64_tr_b16 a[46:47], v45 offset:9216
  ds_read_b64_tr_b16 a[48:49], v44 offset:16384
  ds_read_b64_tr_b16 a[50:51], v44 offset:17408
  ds_read_b64_tr_b16 a[52:53], v45 offset:16384
  ds_read_b64_tr_b16 a[54:55], v45 offset:17408
  ds_read_b64_tr_b16 a[56:57], v44 offset:24576
  ds_read_b64_tr_b16 a[58:59], v44 offset:25600
  ds_read_b64_tr_b16 a[60:61], v45 offset:24576
  ds_read_b64_tr_b16 a[62:63], v45 offset:25600
  s_waitcnt lgkmcnt(0)
  ds_read_b128 v[128:131], v30 offset:32768
  ds_read_b128 v[132:135], v30 offset:36864
  ds_read_b128 v[136:139], v30 offset:40960
  ds_read_b128 v[140:143], v30 offset:45056
  ds_read_b128 v[144:147], v30 offset:49152
  ds_read_b128 v[148:151], v30 offset:53248
  ds_read_b128 v[152:155], v30 offset:57344
  ds_read_b128 v[156:159], v30 offset:61440
  s_waitcnt lgkmcnt(7)
  v_mfma_f32_16x16x32_bf16 v[64:67], a[32:35], v[128:131], v[64:67]
  v_mfma_f32_16x16x32_bf16 v[68:71], a[36:39], v[128:131], v[68:71]
  ds_read_b128 v[160:163], v31 offset:32768
  s_waitcnt lgkmcnt(7)
  v_mfma_f32_16x16x32_bf16 v[72:75], a[32:35], v[132:135], v[72:75]
  v_mfma_f32_16x16x32_bf16 v[76:79], a[36:39], v[132:135], v[76:79]
  ds_read_b128 v[164:167], v31 offset:36864
  s_add_u32 s75, s72, 512
  s_add_u32 m0, s74, 0
  s_nop 0
  buffer_load_dwordx4 v2, s[36:39], s75 offen lds
  s_waitcnt lgkmcnt(7)
  v_mfma_f32_16x16x32_bf16 v[80:83], a[32:35], v[136:139], v[80:83]
  v_mfma_f32_16x16x32_bf16 v[84:87], a[36:39], v[136:139], v[84:87]
  ds_read_b128 v[168:171], v31 offset:40960
  s_waitcnt lgkmcnt(7)
  v_mfma_f32_16x16x32_bf16 v[88:91], a[32:35], v[140:143], v[88:91]
  v_mfma_f32_16x16x32_bf16 v[92:95], a[36:39], v[140:143], v[92:95]
  ds_read_b128 v[172:175], v31 offset:45056
  s_add_u32 s75, s72, 512
  s_add_u32 m0, s74, 1024
  s_nop 0
  buffer_load_dwordx4 v3, s[36:39], s75 offen lds
  s_waitcnt lgkmcnt(7)
  v_mfma_f32_16x16x32_bf16 v[96:99], a[32:35], v[144:147], v[96:99]
  v_mfma_f32_16x16x32_bf16 v[100:103], a[36:39], v[144:147], v[100:103]
  ds_read_b128 v[176:179], v31 offset:49152
  s_waitcnt lgkmcnt(7)
  v_mfma_f32_16x16x32_bf16 v[104:107], a[32:35], v[148:151], v[104:107]
  v_mfma_f32_16x16x32_bf16 v[108:111], a[36:39], v[148:151], v[108:111]
  ds_read_b128 v[180:183], v31 offset:53248
  s_add_u32 s75, s72, 512
  s_add_u32 m0, s74, 2048
  s_nop 0
  buffer_load_dwordx4 v4, s[36:39], s75 offen lds
  s_waitcnt lgkmcnt(7)
  v_mfma_f32_16x16x32_bf16 v[112:115], a[32:35], v[152:155], v[112:115]
  v_mfma_f32_16x16x32_bf16 v[116:119], a[36:39], v[152:155], v[116:119]
  ds_read_b128 v[184:187], v31 offset:57344
  s_waitcnt lgkmcnt(7)
  v_mfma_f32_16x16x32_bf16 v[120:123], a[32:35], v[156:159], v[120:123]
  v_mfma_f32_16x16x32_bf16 v[124:127], a[36:39], v[156:159], v[124:127]
  ds_read_b128 v[188:191], v31 offset:61440
  s_add_u32 s75, s72, 512
  s_add_u32 m0, s74, 3072
  s_nop 0
  buffer_load_dwordx4 v5, s[36:39], s75 offen lds
  s_waitcnt lgkmcnt(7)
  v_mfma_f32_16x16x32_bf16 v[64:67], a[40:43], v[160:163], v[64:67]
  v_mfma_f32_16x16x32_bf16 v[68:71], a[44:47], v[160:163], v[68:71]
  ds_read_b128 v[128:131], v32 offset:32768
  s_waitcnt lgkmcnt(7)
  v_mfma_f32_16x16x32_bf16 v[72:75], a[40:43], v[164:167], v[72:75]
  v_mfma_f32_16x16x32_bf16 v[76:79], a[44:47], v[164:167], v[76:79]
  ds_read_b128 v[132:135], v32 offset:36864
  s_add_u32 s75, s72, 20992
  s_add_u32 m0, s74, 4096
  s_nop 0
  buffer_load_dwordx4 v2, s[36:39], s75 offen lds
  s_waitcnt lgkmcnt(7)
  v_mfma_f32_16x16x32_bf16 v[80:83], a[40:43], v[168:171], v[80:83]
  v_mfma_f32_16x16x32_bf16 v[84:87], a[44:47], v[168:171], v[84:87]
  ds_read_b128 v[136:139], v32 offset:40960
  s_waitcnt lgkmcnt(7)
  v_mfma_f32_16x16x32_bf16 v[88:91], a[40:43], v[172:175], v[88:91]
  v_mfma_f32_16x16x32_bf16 v[92:95], a[44:47], v[172:175], v[92:95]
  ds_read_b128 v[140:143], v32 offset:45056
  s_add_u32 s75, s72, 20992
  s_add_u32 m0, s74, 5120
  s_nop 0
  buffer_load_dwordx4 v3, s[36:39], s75 offen lds
  s_waitcnt lgkmcnt(7)
  v_mfma_f32_16x16x32_bf16 v[96:99], a[40:43], v[176:179], v[96:99]
  v_mfma_f32_16x16x32_bf16 v[100:103], a[44:47], v[176:179], v[100:103]
  ds_read_b128 v[144:147], v32 offset:49152
  s_waitcnt lgkmcnt(7)
  v_mfma_f32_16x16x32_bf16 v[104:107], a[40:43], v[180:183], v[104:107]
  v_mfma_f32_16x16x32_bf16 v[108:111], a[44:47], v[180:183], v[108:111]
  ds_read_b128 v[148:151], v32 offset:53248
  s_add_u32 s75, s72, 20992
  s_add_u32 m0, s74, 6144
  s_nop 0
  buffer_load_dwordx4 v4, s[36:39], s75 offen lds
  s_waitcnt lgkmcnt(7)
  v_mfma_f32_16x16x32_bf16 v[112:115], a[40:43], v[184:187], v[112:115]
  v_mfma_f32_16x16x32_bf16 v[116:119], a[44:47], v[184:187], v[116:119]
  ds_read_b128 v[152:155], v32 offset:57344
  s_waitcnt lgkmcnt(7)
  v_mfma_f32_16x16x32_bf16 v[120:123], a[40:43], v[188:191], v[120:123]
  v_mfma_f32_16x16x32_bf16 v[124:127], a[44:47], v[188:191], v[124:127]
  ds_read_b128 v[156:159], v32 offset:61440
  s_add_u32 s75, s72, 20992
  s_add_u32 m0, s74, 7168
  s_nop 0
  buffer_load_dwordx4 v5, s[36:39], s75 offen lds
  s_waitcnt lgkmcnt(7)
  v_mfma_f32_16x16x32_bf16 v[64:67], a[48:51], v[128:131], v[64:67]
  v_mfma_f32_16x16x32_bf16 v[68:71], a[52:55], v[128:131], v[68:71]
  ds_read_b128 v[160:163], v33 offset:32768
  s_waitcnt lgkmcnt(7)
  v_mfma_f32_16x16x32_bf16 v[72:75], a[48:51], v[132:135], v[72:75]
  v_mfma_f32_16x16x32_bf16 v[76:79], a[52:55], v[132:135], v[76:79]
  ds_read_b128 v[164:167], v33 offset:36864
  s_add_u32 m0, s74, 65536
  s_nop 0
  buffer_load_dwordx4 v6, s[40:43], s76 offen  lds
  s_add_u32 s76, s76, s77
  s_waitcnt lgkmcnt(7)
  v_mfma_f32_16x16x32_bf16 v[80:83], a[48:51], v[136:139], v[80:83]
  v_mfma_f32_16x16x32_bf16 v[84:87], a[52:55], v[136:139], v[84:87]
  ds_read_b128 v[168:171], v33 offset:40960
  s_waitcnt lgkmcnt(7)
  v_mfma_f32_16x16x32_bf16 v[88:91], a[48:51], v[140:143], v[88:91]
  v_mfma_f32_16x16x32_bf16 v[92:95], a[52:55], v[140:143], v[92:95]
  ds_read_b128 v[172:175], v33 offset:45056
  s_add_u32 m0, s74, 66560
  s_nop 0
  buffer_load_dwordx4 v6, s[40:43], s76 offen  lds
  s_add_u32 s76, s76, s77
  s_waitcnt lgkmcnt(7)
  v_mfma_f32_16x16x32_bf16 v[96:99], a[48:51], v[144:147], v[96:99]
  v_mfma_f32_16x16x32_bf16 v[100:103], a[52:55], v[144:147], v[100:103]
  ds_read_b128 v[176:179], v33 offset:49152
  s_waitcnt lgkmcnt(7)
  v_mfma_f32_16x16x32_bf16 v[104:107], a[48:51], v[148:151], v[104:107]
  v_mfma_f32_16x16x32_bf16 v[108:111], a[52:55], v[148:151], v[108:111]
  ds_read_b128 v[180:183], v33 offset:53248
  s_add_u32 m0, s74, 67584
  s_nop 0
  buffer_load_dwordx4 v7, s[40:43], s76 offen  lds
  s_add_u32 s76, s76, s77
  s_waitcnt lgkmcnt(7)
  v_mfma_f32_16x16x32_bf16 v[112:115], a[48:51], v[152:155], v[112:115]
  v_mfma_f32_16x16x32_bf16 v[116:119], a[52:55], v[152:155], v[116:119]
  ds_read_b128 v[184:187], v33 offset:57344
  s_waitcnt lgkmcnt(7)
  v_mfma_f32_16x16x32_bf16 v[120:123], a[48:51], v[156:159], v[120:123]
  v_mfma_f32_16x16x32_bf16 v[124:127], a[52:55], v[156:159], v[124:127]
  ds_read_b128 v[188:191], v33 offset:61440
  s_add_u32 m0, s74, 68608
  s_nop 0
  buffer_load_dwordx4 v7, s[40:43], s76 offen  lds
  s_add_u32 s76, s76, s77
  s_waitcnt lgkmcnt(7)
  v_mfma_f32_16x16x32_bf16 v[64:67], a[56:59], v[160:163], v[64:67]
  v_mfma_f32_16x16x32_bf16 v[68:71], a[60:63], v[160:163], v[68:71]
  s_waitcnt lgkmcnt(6)
  v_mfma_f32_16x16x32_bf16 v[72:75], a[56:59], v[164:167], v[72:75]
  v_mfma_f32_16x16x32_bf16 v[76:79], a[60:63], v[164:167], v[76:79]
  s_add_u32 m0, s74, 69632
  s_nop 0
  buffer_load_dwordx4 v6, s[40:43], s76 offen  lds
  s_add_u32 s76, s76, s77
  s_waitcnt lgkmcnt(5)
  v_mfma_f32_16x16x32_bf16 v[80:83], a[56:59], v[168:171], v[80:83]
  v_mfma_f32_16x16x32_bf16 v[84:87], a[60:63], v[168:171], v[84:87]
  s_waitcnt lgkmcnt(4)
  v_mfma_f32_16x16x32_bf16 v[88:91], a[56:59], v[172:175], v[88:91]
  v_mfma_f32_16x16x32_bf16 v[92:95], a[60:63], v[172:175], v[92:95]
  s_add_u32 m0, s74, 70656
  s_nop 0
  buffer_load_dwordx4 v6, s[40:43], s76 offen  lds
  s_add_u32 s76, s76, s77
  s_waitcnt lgkmcnt(3)
  v_mfma_f32_16x16x32_bf16 v[96:99], a[56:59], v[176:179], v[96:99]
  v_mfma_f32_16x16x32_bf16 v[100:103], a[60:63], v[176:179], v[100:103]
  s_waitcnt lgkmcnt(2)
  v_mfma_f32_16x16x32_bf16 v[104:107], a[56:59], v[180:183], v[104:107]
  v_mfma_f32_16x16x32_bf16 v[108:111], a[60:63], v[180:183], v[108:111]
  s_add_u32 m0, s74, 71680
  s_nop 0
  buffer_load_dwordx4 v7, s[40:43], s76 offen  lds
  s_add_u32 s76, s76, s77
  s_waitcnt lgkmcnt(1)
  v_mfma_f32_16x16x32_bf16 v[112:115], a[56:59], v[184:187], v[112:115]
  v_mfma_f32_16x16x32_bf16 v[116:119], a[60:63], v[184:187], v[116:119]
  s_waitcnt lgkmcnt(0)
  v_mfma_f32_16x16x32_bf16 v[120:123], a[56:59], v[188:191], v[120:123]
  v_mfma_f32_16x16x32_bf16 v[124:127], a[60:63], v[188:191], v[124:127]
  s_add_u32 m0, s74, 72704
  s_nop 0
  buffer_load_dwordx4 v7, s[40:43], s76 offen  lds
  s_add_u32 s76, s76, s77
  s_add_u32 s76, s76, s78
  s_waitcnt vmcnt(16)
  s_waitcnt vmcnt(8)
  s_barrier
  v_add_u32 v44, 131072, v8
  v_add_u32 v45, 131072, v9
  ds_read_b64_tr_b16 a[64:65], v44 offset:0
  ds_read_b64_tr_b16 a[66:67], v44 offset:1024
  ds_read_b64_tr_b16 a[68:69], v45 offset:0
  ds_read_b64_tr_b16 a[70:71], v45 offset:1024
  ds_read_b64_tr_b16 a[72:73], v44 offset:8192
  ds_read_b64_tr_b16 a[74:75], v44 offset:9216
  ds_read_b64_tr_b16 a[76:77], v45 offset:8192
  ds_read_b64_tr_b16 a[78:79], v45 offset:9216
  ds_read_b64_tr_b16 a[80:81], v44 offset:16384
  ds_read_b64_tr_b16 a[82:83], v44 offset:17408
  ds_read_b64_tr_b16 a[84:85], v45 offset:16384
  ds_read_b64_tr_b16 a[86:87], v45 offset:17408
  ds_read_b64_tr_b16 a[88:89], v44 offset:24576
  ds_read_b64_tr_b16 a[90:91], v44 offset:25600
  ds_read_b64_tr_b16 a[92:93], v45 offset:24576
  ds_read_b64_tr_b16 a[94:95], v45 offset:25600
  s_waitcnt lgkmcnt(0)
  ds_read_b128 v[128:131], v30 offset:0
  ds_read_b128 v[132:135], v30 offset:4096
  ds_read_b128 v[136:139], v30 offset:8192
  ds_read_b128 v[140:143], v30 offset:12288
  ds_read_b128 v[144:147], v30 offset:16384
  ds_read_b128 v[148:151], v30 offset:20480
  ds_read_b128 v[152:155], v30 offset:24576
  ds_read_b128 v[156:159], v30 offset:28672
  s_waitcnt lgkmcnt(7)
  v_mfma_f32_16x16x32_bf16 v[64:67], a[64:67], v[128:131], v[64:67]
  v_mfma_f32_16x16x32_bf16 v[68:71], a[68:71], v[128:131], v[68:71]
  ds_read_b128 v[160:163], v31 offset:0
  s_waitcnt lgkmcnt(7)
  v_mfma_f32_16x16x32_bf16 v[72:75], a[64:67], v[132:135], v[72:75]
  v_mfma_f32_16x16x32_bf16 v[76:79], a[68:71], v[132:135], v[76:79]
  ds_read_b128 v[164:167], v31 offset:4096
  s_add_u32 s75, s72, 768
  s_add_u32 m0, s74, 32768
  s_nop 0
  buffer_load_dwordx4 v2, s[36:39], s75 offen lds
  s_waitcnt lgkmcnt(7)
  v_mfma_f32_16x16x32_bf16 v[80:83], a[64:67], v[136:139], v[80:83]
  v_mfma_f32_16x16x32_bf16 v[84:87], a[68:71], v[136:139], v[84:87]
  ds_read_b128 v[168:171], v31 offset:8192
  s_waitcnt lgkmcnt(7)
  v_mfma_f32_16x16x32_bf16 v[88:91], a[64:67], v[140:143], v[88:91]
  v_mfma_f32_16x16x32_bf16 v[92:95], a[68:71], v[140:143], v[92:95]
  ds_read_b128 v[172:175], v31 offset:12288
  s_add_u32 s75, s72, 768
  s_add_u32 m0, s74, 33792
  s_nop 0
  buffer_load_dwordx4 v3, s[36:39], s75 offen lds
  s_waitcnt lgkmcnt(7)
  v_mfma_f32_16x16x32_bf16 v[96:99], a[64:67], v[144:147], v[96:99]
  v_mfma_f32_16x16x32_bf16 v[100:103], a[68:71], v[144:147], v[100:103]
  ds_read_b128 v[176:179], v31 offset:16384
  s_waitcnt lgkmcnt(7)
  v_mfma_f32_16x16x32_bf16 v[104:107], a[64:67], v[148:151], v[104:107]
  v_mfma_f32_16x16x32_bf16 v[108:111], a[68:71], v[148:151], v[108:111]
  ds_read_b128 v[180:183], v31 offset:20480
  s_add_u32 s75, s72, 768
  s_add_u32 m0, s74, 34816
  s_nop 0
  buffer_load_dwordx4 v4, s[36:39], s75 offen lds
  s_waitcnt lgkmcnt(7)
  v_mfma_f32_16x16x32_bf16 v[112:115], a[64:67], v[152:155], v[112:115]
  v_mfma_f32_16x16x32_bf16 v[116:119], a[68:71], v[152:155], v[116:119]
  ds_read_b128 v[184:187], v31 offset:24576
  s_waitcnt lgkmcnt(7)
  v_mfma_f32_16x16x32_bf16 v[120:123], a[64:67], v[156:159], v[120:123]
  v_mfma_f32_16x16x32_bf16 v[124:127], a[68:71], v[156:159], v[124:127]
  ds_read_b128 v[188:191], v31 offset:28672
  s_add_u32 s75, s72, 768
  s_add_u32 m0, s74, 35840
  s_nop 0
  buffer_load_dwordx4 v5, s[36:39], s75 offen lds
  s_waitcnt lgkmcnt(7)
  v_mfma_f32_16x16x32_bf16 v[64:67], a[72:75], v[160:163], v[64:67]
  v_mfma_f32_16x16x32_bf16 v[68:71], a[76:79], v[160:163], v[68:71]
  ds_read_b128 v[128:131], v32 offset:0
  s_waitcnt lgkmcnt(7)
  v_mfma_f32_16x16x32_bf16 v[72:75], a[72:75], v[164:167], v[72:75]
  v_mfma_f32_16x16x32_bf16 v[76:79], a[76:79], v[164:167], v[76:79]
  ds_read_b128 v[132:135], v32 offset:4096
  s_add_u32 s75, s72, 21248
  s_add_u32 m0, s74, 36864
  s_nop 0
  buffer_load_dwordx4 v2, s[36:39], s75 offen lds
  s_waitcnt lgkmcnt(7)
  v_mfma_f32_16x16x32_bf16 v[80:83], a[72:75], v[168:171], v[80:83]
  v_mfma_f32_16x16x32_bf16 v[84:87], a[76:79], v[168:171], v[84:87]
  ds_read_b128 v[136:139], v32 offset:8192
  s_waitcnt lgkmcnt(7)
  v_mfma_f32_16x16x32_bf16 v[88:91], a[72:75], v[172:175], v[88:91]
  v_mfma_f32_16x16x32_bf16 v[92:95], a[76:79], v[172:175], v[92:95]
  ds_read_b128 v[140:143], v32 offset:12288
  s_add_u32 s75, s72, 21248
  s_add_u32 m0, s74, 37888
  s_nop 0
  buffer_load_dwordx4 v3, s[36:39], s75 offen lds
  s_waitcnt lgkmcnt(7)
  v_mfma_f32_16x16x32_bf16 v[96:99], a[72:75], v[176:179], v[96:99]
  v_mfma_f32_16x16x32_bf16 v[100:103], a[76:79], v[176:179], v[100:103]
  ds_read_b128 v[144:147], v32 offset:16384
  s_waitcnt lgkmcnt(7)
  v_mfma_f32_16x16x32_bf16 v[104:107], a[72:75], v[180:183], v[104:107]
  v_mfma_f32_16x16x32_bf16 v[108:111], a[76:79], v[180:183], v[108:111]
  ds_read_b128 v[148:151], v32 offset:20480
  s_add_u32 s75, s72, 21248
  s_add_u32 m0, s74, 38912
  s_nop 0
  buffer_load_dwordx4 v4, s[36:39], s75 offen lds
  s_waitcnt lgkmcnt(7)
  v_mfma_f32_16x16x32_bf16 v[112:115], a[72:75], v[184:187], v[112:115]
  v_mfma_f32_16x16x32_bf16 v[116:119], a[76:79], v[184:187], v[116:119]
  ds_read_b128 v[152:155], v32 offset:24576
  s_waitcnt lgkmcnt(7)
  v_mfma_f32_16x16x32_bf16 v[120:123], a[72:75], v[188:191], v[120:123]
  v_mfma_f32_16x16x32_bf16 v[124:127], a[76:79], v[188:191], v[124:127]
  ds_read_b128 v[156:159], v32 offset:28672
  s_add_u32 s75, s72, 21248
  s_add_u32 m0, s74, 39936
  s_nop 0
  buffer_load_dwordx4 v5, s[36:39], s75 offen lds
  s_waitcnt lgkmcnt(7)
  v_mfma_f32_16x16x32_bf16 v[64:67], a[80:83], v[128:131], v[64:67]
  v_mfma_f32_16x16x32_bf16 v[68:71], a[84:87], v[128:131], v[68:71]
  ds_read_b128 v[160:163], v33 offset:0
  s_waitcnt lgkmcnt(7)
  v_mfma_f32_16x16x32_bf16 v[72:75], a[80:83], v[132:135], v[72:75]
  v_mfma_f32_16x16x32_bf16 v[76:79], a[84:87], v[132:135], v[76:79]
  ds_read_b128 v[164:167], v33 offset:4096
  s_add_u32 m0, s74, 98304
  s_nop 0
  buffer_load_dwordx4 v6, s[40:43], s76 offen  lds
  s_add_u32 s76, s76, s77
  s_waitcnt lgkmcnt(7)
  v_mfma_f32_16x16x32_bf16 v[80:83], a[80:83], v[136:139], v[80:83]
  v_mfma_f32_16x16x32_bf16 v[84:87], a[84:87], v[136:139], v[84:87]
  ds_read_b128 v[168:171], v33 offset:8192
  s_waitcnt lgkmcnt(7)
  v_mfma_f32_16x16x32_bf16 v[88:91], a[80:83], v[140:143], v[88:91]
  v_mfma_f32_16x16x32_bf16 v[92:95], a[84:87], v[140:143], v[92:95]
  ds_read_b128 v[172:175], v33 offset:12288
  s_add_u32 m0, s74, 99328
  s_nop 0
  buffer_load_dwordx4 v6, s[40:43], s76 offen  lds
  s_add_u32 s76, s76, s77
  s_waitcnt lgkmcnt(7)
  v_mfma_f32_16x16x32_bf16 v[96:99], a[80:83], v[144:147], v[96:99]
  v_mfma_f32_16x16x32_bf16 v[100:103], a[84:87], v[144:147], v[100:103]
  ds_read_b128 v[176:179], v33 offset:16384
  s_waitcnt lgkmcnt(7)
  v_mfma_f32_16x16x32_bf16 v[104:107], a[80:83], v[148:151], v[104:107]
  v_mfma_f32_16x16x32_bf16 v[108:111], a[84:87], v[148:151], v[108:111]
  ds_read_b128 v[180:183], v33 offset:20480
  s_add_u32 m0, s74, 100352
  s_nop 0
  buffer_load_dwordx4 v7, s[40:43], s76 offen  lds
  s_add_u32 s76, s76, s77
  s_waitcnt lgkmcnt(7)
  v_mfma_f32_16x16x32_bf16 v[112:115], a[80:83], v[152:155], v[112:115]
  v_mfma_f32_16x16x32_bf16 v[116:119], a[84:87], v[152:155], v[116:119]
  ds_read_b128 v[184:187], v33 offset:24576
  s_waitcnt lgkmcnt(7)
  v_mfma_f32_16x16x32_bf16 v[120:123], a[80:83], v[156:159], v[120:123]
  v_mfma_f32_16x16x32_bf16 v[124:127], a[84:87], v[156:159], v[124:127]
  ds_read_b128 v[188:191], v33 offset:28672
  s_add_u32 m0, s74, 101376
  s_nop 0
  buffer_load_dwordx4 v7, s[40:43], s76 offen  lds
  s_add_u32 s76, s76, s77
  s_waitcnt lgkmcnt(7)
  v_mfma_f32_16x16x32_bf16 v[64:67], a[88:91], v[160:163], v[64:67]
  v_mfma_f32_16x16x32_bf16 v[68:71], a[92:95], v[160:163], v[68:71]
  s_waitcnt lgkmcnt(6)
  v_mfma_f32_16x16x32_bf16 v[72:75], a[88:91], v[164:167], v[72:75]
  v_mfma_f32_16x16x32_bf16 v[76:79], a[92:95], v[164:167], v[76:79]
  s_add_u32 m0, s74, 102400
  s_nop 0
  buffer_load_dwordx4 v6, s[40:43], s76 offen  lds
  s_add_u32 s76, s76, s77
  s_waitcnt lgkmcnt(5)
  v_mfma_f32_16x16x32_bf16 v[80:83], a[88:91], v[168:171], v[80:83]
  v_mfma_f32_16x16x32_bf16 v[84:87], a[92:95], v[168:171], v[84:87]
  s_waitcnt lgkmcnt(4)
  v_mfma_f32_16x16x32_bf16 v[88:91], a[88:91], v[172:175], v[88:91]
  v_mfma_f32_16x16x32_bf16 v[92:95], a[92:95], v[172:175], v[92:95]
  s_add_u32 m0, s74, 103424
  s_nop 0
  buffer_load_dwordx4 v6, s[40:43], s76 offen  lds
  s_add_u32 s76, s76, s77
  s_waitcnt lgkmcnt(3)
  v_mfma_f32_16x16x32_bf16 v[96:99], a[88:91], v[176:179], v[96:99]
  v_mfma_f32_16x16x32_bf16 v[100:103], a[92:95], v[176:179], v[100:103]
  s_waitcnt lgkmcnt(2)
  v_mfma_f32_16x16x32_bf16 v[104:107], a[88:91], v[180:183], v[104:107]
  v_mfma_f32_16x16x32_bf16 v[108:111], a[92:95], v[180:183], v[108:111]
  s_add_u32 m0, s74, 104448
  s_nop 0
  buffer_load_dwordx4 v7, s[40:43], s76 offen  lds
  s_add_u32 s76, s76, s77
  s_waitcnt lgkmcnt(1)
  v_mfma_f32_16x16x32_bf16 v[112:115], a[88:91], v[184:187], v[112:115]
  v_mfma_f32_16x16x32_bf16 v[116:119], a[92:95], v[184:187], v[116:119]
  s_waitcnt lgkmcnt(0)
  v_mfma_f32_16x16x32_bf16 v[120:123], a[88:91], v[188:191], v[120:123]
  v_mfma_f32_16x16x32_bf16 v[124:127], a[92:95], v[188:191], v[124:127]
  s_add_u32 m0, s74, 105472
  s_nop 0
  buffer_load_dwordx4 v7, s[40:43], s76 offen  lds
  s_add_u32 s76, s76, s77
  s_add_u32 s76, s76, s78
  s_waitcnt vmcnt(16)
  s_waitcnt vmcnt(8)
  s_barrier
  v_add_u32 v44, 65536, v8
  v_add_u32 v45, 65536, v9
  ds_read_b64_tr_b16 a[96:97], v44 offset:0
  ds_read_b64_tr_b16 a[98:99], v44 offset:1024
  ds_read_b64_tr_b16 a[100:101], v45 offset:0
  ds_read_b64_tr_b16 a[102:103], v45 offset:1024
  ds_read_b64_tr_b16 a[104:105], v44 offset:8192
  ds_read_b64_tr_b16 a[106:107], v44 offset:9216
  ds_read_b64_tr_b16 a[108:109], v45 offset:8192
  ds_read_b64_tr_b16 a[110:111], v45 offset:9216
  ds_read_b64_tr_b16 a[112:113], v44 offset:16384
  ds_read_b64_tr_b16 a[114:115], v44 offset:17408
  ds_read_b64_tr_b16 a[116:117], v45 offset:16384
  ds_read_b64_tr_b16 a[118:119], v45 offset:17408
  ds_read_b64_tr_b16 a[120:121], v44 offset:24576
  ds_read_b64_tr_b16 a[122:123], v44 offset:25600
  ds_read_b64_tr_b16 a[124:125], v45 offset:24576
  ds_read_b64_tr_b16 a[126:127], v45 offset:25600
  s_waitcnt lgkmcnt(0)
  ds_read_b128 v[128:131], v30 offset:32768
  ds_read_b128 v[132:135], v30 offset:36864
  ds_read_b128 v[136:139], v30 offset:40960
  ds_read_b128 v[140:143], v30 offset:45056
  ds_read_b128 v[144:147], v30 offset:49152
  ds_read_b128 v[148:151], v30 offset:53248
  ds_read_b128 v[152:155], v30 offset:57344
  ds_read_b128 v[156:159], v30 offset:61440
  s_waitcnt lgkmcnt(7)
  v_mfma_f32_16x16x32_bf16 v[64:67], a[96:99], v[128:131], v[64:67]
  v_mfma_f32_16x16x32_bf16 v[68:71], a[100:103], v[128:131], v[68:71]
  ds_read_b128 v[160:163], v31 offset:32768
  s_waitcnt lgkmcnt(7)
  v_mfma_f32_16x16x32_bf16 v[72:75], a[96:99], v[132:135], v[72:75]
  v_mfma_f32_16x16x32_bf16 v[76:79], a[100:103], v[132:135], v[76:79]
  ds_read_b128 v[164:167], v31 offset:36864
  s_add_u32 s75, s72, 1024
  s_add_u32 m0, s74, 0
  s_nop 0
  buffer_load_dwordx4 v2, s[36:39], s75 offen lds
  s_waitcnt lgkmcnt(7)
  v_mfma_f32_16x16x32_bf16 v[80:83], a[96:99], v[136:139], v[80:83]
  v_mfma_f32_16x16x32_bf16 v[84:87], a[100:103], v[136:139], v[84:87]
  ds_read_b128 v[168:171], v31 offset:40960
  s_waitcnt lgkmcnt(7)
  v_mfma_f32_16x16x32_bf16 v[88:91], a[96:99], v[140:143], v[88:91]
  v_mfma_f32_16x16x32_bf16 v[92:95], a[100:103], v[140:143], v[92:95]
  ds_read_b128 v[172:175], v31 offset:45056
  s_add_u32 s75, s72, 1024
  s_add_u32 m0, s74, 1024
  s_nop 0
  buffer_load_dwordx4 v3, s[36:39], s75 offen lds
  s_waitcnt lgkmcnt(7)
  v_mfma_f32_16x16x32_bf16 v[96:99], a[96:99], v[144:147], v[96:99]
  v_mfma_f32_16x16x32_bf16 v[100:103], a[100:103], v[144:147], v[100:103]
  ds_read_b128 v[176:179], v31 offset:49152
  s_waitcnt lgkmcnt(7)
  v_mfma_f32_16x16x32_bf16 v[104:107], a[96:99], v[148:151], v[104:107]
  v_mfma_f32_16x16x32_bf16 v[108:111], a[100:103], v[148:151], v[108:111]
  ds_read_b128 v[180:183], v31 offset:53248
  s_add_u32 s75, s72, 1024
  s_add_u32 m0, s74, 2048
  s_nop 0
  buffer_load_dwordx4 v4, s[36:39], s75 offen lds
  s_waitcnt lgkmcnt(7)
  v_mfma_f32_16x16x32_bf16 v[112:115], a[96:99], v[152:155], v[112:115]
  v_mfma_f32_16x16x32_bf16 v[116:119], a[100:103], v[152:155], v[116:119]
  ds_read_b128 v[184:187], v31 offset:57344
  s_waitcnt lgkmcnt(7)
  v_mfma_f32_16x16x32_bf16 v[120:123], a[96:99], v[156:159], v[120:123]
  v_mfma_f32_16x16x32_bf16 v[124:127], a[100:103], v[156:159], v[124:127]
  ds_read_b128 v[188:191], v31 offset:61440
  s_add_u32 s75, s72, 1024
  s_add_u32 m0, s74, 3072
  s_nop 0
  buffer_load_dwordx4 v5, s[36:39], s75 offen lds
  s_waitcnt lgkmcnt(7)
  v_mfma_f32_16x16x32_bf16 v[64:67], a[104:107], v[160:163], v[64:67]
  v_mfma_f32_16x16x32_bf16 v[68:71], a[108:111], v[160:163], v[68:71]
  ds_read_b128 v[128:131], v32 offset:32768
  s_waitcnt lgkmcnt(7)
  v_mfma_f32_16x16x32_bf16 v[72:75], a[104:107], v[164:167], v[72:75]
  v_mfma_f32_16x16x32_bf16 v[76:79], a[108:111], v[164:167], v[76:79]
  ds_read_b128 v[132:135], v32 offset:36864
  s_add_u32 s75, s72, 21504
  s_add_u32 m0, s74, 4096
  s_nop 0
  buffer_load_dwordx4 v2, s[36:39], s75 offen lds
  s_waitcnt lgkmcnt(7)
  v_mfma_f32_16x16x32_bf16 v[80:83], a[104:107], v[168:171], v[80:83]
  v_mfma_f32_16x16x32_bf16 v[84:87], a[108:111], v[168:171], v[84:87]
  ds_read_b128 v[136:139], v32 offset:40960
  s_waitcnt lgkmcnt(7)
  v_mfma_f32_16x16x32_bf16 v[88:91], a[104:107], v[172:175], v[88:91]
  v_mfma_f32_16x16x32_bf16 v[92:95], a[108:111], v[172:175], v[92:95]
  ds_read_b128 v[140:143], v32 offset:45056
  s_add_u32 s75, s72, 21504
  s_add_u32 m0, s74, 5120
  s_nop 0
  buffer_load_dwordx4 v3, s[36:39], s75 offen lds
  s_waitcnt lgkmcnt(7)
  v_mfma_f32_16x16x32_bf16 v[96:99], a[104:107], v[176:179], v[96:99]
  v_mfma_f32_16x16x32_bf16 v[100:103], a[108:111], v[176:179], v[100:103]
  ds_read_b128 v[144:147], v32 offset:49152
  s_waitcnt lgkmcnt(7)
  v_mfma_f32_16x16x32_bf16 v[104:107], a[104:107], v[180:183], v[104:107]
  v_mfma_f32_16x16x32_bf16 v[108:111], a[108:111], v[180:183], v[108:111]
  ds_read_b128 v[148:151], v32 offset:53248
  s_add_u32 s75, s72, 21504
  s_add_u32 m0, s74, 6144
  s_nop 0
  buffer_load_dwordx4 v4, s[36:39], s75 offen lds
  s_waitcnt lgkmcnt(7)
  v_mfma_f32_16x16x32_bf16 v[112:115], a[104:107], v[184:187], v[112:115]
  v_mfma_f32_16x16x32_bf16 v[116:119], a[108:111], v[184:187], v[116:119]
  ds_read_b128 v[152:155], v32 offset:57344
  s_waitcnt lgkmcnt(7)
  v_mfma_f32_16x16x32_bf16 v[120:123], a[104:107], v[188:191], v[120:123]
  v_mfma_f32_16x16x32_bf16 v[124:127], a[108:111], v[188:191], v[124:127]
  ds_read_b128 v[156:159], v32 offset:61440
  s_add_u32 s75, s72, 21504
  s_add_u32 m0, s74, 7168
  s_nop 0
  buffer_load_dwordx4 v5, s[36:39], s75 offen lds
  s_waitcnt lgkmcnt(7)
  v_mfma_f32_16x16x32_bf16 v[64:67], a[112:115], v[128:131], v[64:67]
  v_mfma_f32_16x16x32_bf16 v[68:71], a[116:119], v[128:131], v[68:71]
  ds_read_b128 v[160:163], v33 offset:32768
  s_waitcnt lgkmcnt(7)
  v_mfma_f32_16x16x32_bf16 v[72:75], a[112:115], v[132:135], v[72:75]
  v_mfma_f32_16x16x32_bf16 v[76:79], a[116:119], v[132:135], v[76:79]
  ds_read_b128 v[164:167], v33 offset:36864
  s_waitcnt lgkmcnt(7)
  v_mfma_f32_16x16x32_bf16 v[80:83], a[112:115], v[136:139], v[80:83]
  v_mfma_f32_16x16x32_bf16 v[84:87], a[116:119], v[136:139], v[84:87]
  ds_read_b128 v[168:171], v33 offset:40960
  s_waitcnt lgkmcnt(7)
  v_mfma_f32_16x16x32_bf16 v[88:91], a[112:115], v[140:143], v[88:91]
  v_mfma_f32_16x16x32_bf16 v[92:95], a[116:119], v[140:143], v[92:95]
  ds_read_b128 v[172:175], v33 offset:45056
  s_waitcnt lgkmcnt(7)
  v_mfma_f32_16x16x32_bf16 v[96:99], a[112:115], v[144:147], v[96:99]
  v_mfma_f32_16x16x32_bf16 v[100:103], a[116:119], v[144:147], v[100:103]
  ds_read_b128 v[176:179], v33 offset:49152
  s_waitcnt lgkmcnt(7)
  v_mfma_f32_16x16x32_bf16 v[104:107], a[112:115], v[148:151], v[104:107]
  v_mfma_f32_16x16x32_bf16 v[108:111], a[116:119], v[148:151], v[108:111]
  ds_read_b128 v[180:183], v33 offset:53248
  s_waitcnt lgkmcnt(7)
  v_mfma_f32_16x16x32_bf16 v[112:115], a[112:115], v[152:155], v[112:115]
  v_mfma_f32_16x16x32_bf16 v[116:119], a[116:119], v[152:155], v[116:119]
  ds_read_b128 v[184:187], v33 offset:57344
  s_waitcnt lgkmcnt(7)
  v_mfma_f32_16x16x32_bf16 v[120:123], a[112:115], v[156:159], v[120:123]
  v_mfma_f32_16x16x32_bf16 v[124:127], a[116:119], v[156:159], v[124:127]
  ds_read_b128 v[188:191], v33 offset:61440
  s_waitcnt lgkmcnt(7)
  v_mfma_f32_16x16x32_bf16 v[64:67], a[120:123], v[160:163], v[64:67]
  v_mfma_f32_16x16x32_bf16 v[68:71], a[124:127], v[160:163], v[68:71]
  s_waitcnt lgkmcnt(6)
  v_mfma_f32_16x16x32_bf16 v[72:75], a[120:123], v[164:167], v[72:75]
  v_mfma_f32_16x16x32_bf16 v[76:79], a[124:127], v[164:167], v[76:79]
  s_waitcnt lgkmcnt(5)
  v_mfma_f32_16x16x32_bf16 v[80:83], a[120:123], v[168:171], v[80:83]
  v_mfma_f32_16x16x32_bf16 v[84:87], a[124:127], v[168:171], v[84:87]
  s_waitcnt lgkmcnt(4)
  v_mfma_f32_16x16x32_bf16 v[88:91], a[120:123], v[172:175], v[88:91]
  v_mfma_f32_16x16x32_bf16 v[92:95], a[124:127], v[172:175], v[92:95]
  s_waitcnt lgkmcnt(3)
  v_mfma_f32_16x16x32_bf16 v[96:99], a[120:123], v[176:179], v[96:99]
  v_mfma_f32_16x16x32_bf16 v[100:103], a[124:127], v[176:179], v[100:103]
  s_waitcnt lgkmcnt(2)
  v_mfma_f32_16x16x32_bf16 v[104:107], a[120:123], v[180:183], v[104:107]
  v_mfma_f32_16x16x32_bf16 v[108:111], a[124:127], v[180:183], v[108:111]
  s_waitcnt lgkmcnt(1)
  v_mfma_f32_16x16x32_bf16 v[112:115], a[120:123], v[184:187], v[112:115]
  v_mfma_f32_16x16x32_bf16 v[116:119], a[124:127], v[184:187], v[116:119]
  s_waitcnt lgkmcnt(0)
  v_mfma_f32_16x16x32_bf16 v[120:123], a[120:123], v[188:191], v[120:123]
  v_mfma_f32_16x16x32_bf16 v[124:127], a[124:127], v[188:191], v[124:127]
  s_waitcnt vmcnt(8)
  s_waitcnt vmcnt(0)
  s_barrier
  v_add_u32 v44, 98304, v8
  v_add_u32 v45, 98304, v9
  ds_read_b64_tr_b16 a[128:129], v44 offset:0
  ds_read_b64_tr_b16 a[130:131], v44 offset:1024
  ds_read_b64_tr_b16 a[132:133], v45 offset:0
  ds_read_b64_tr_b16 a[134:135], v45 offset:1024
  ds_read_b64_tr_b16 a[136:137], v44 offset:8192
  ds_read_b64_tr_b16 a[138:139], v44 offset:9216
  ds_read_b64_tr_b16 a[140:141], v45 offset:8192
  ds_read_b64_tr_b16 a[142:143], v45 offset:9216
  ds_read_b64_tr_b16 a[144:145], v44 offset:16384
  ds_read_b64_tr_b16 a[146:147], v44 offset:17408
  ds_read_b64_tr_b16 a[148:149], v45 offset:16384
  ds_read_b64_tr_b16 a[150:151], v45 offset:17408
  ds_read_b64_tr_b16 a[152:153], v44 offset:24576
  ds_read_b64_tr_b16 a[154:155], v44 offset:25600
  ds_read_b64_tr_b16 a[156:157], v45 offset:24576
  ds_read_b64_tr_b16 a[158:159], v45 offset:25600
  s_waitcnt lgkmcnt(0)
  ds_read_b128 v[128:131], v30 offset:0
  ds_read_b128 v[132:135], v30 offset:4096
  ds_read_b128 v[136:139], v30 offset:8192
  ds_read_b128 v[140:143], v30 offset:12288
  ds_read_b128 v[144:147], v30 offset:16384
  ds_read_b128 v[148:151], v30 offset:20480
  ds_read_b128 v[152:155], v30 offset:24576
  ds_read_b128 v[156:159], v30 offset:28672
  s_waitcnt lgkmcnt(7)
  v_mfma_f32_16x16x32_bf16 v[64:67], a[128:131], v[128:131], v[64:67]
  v_mfma_f32_16x16x32_bf16 v[68:71], a[132:135], v[128:131], v[68:71]
  ds_read_b128 v[160:163], v31 offset:0
  s_waitcnt lgkmcnt(7)
  v_mfma_f32_16x16x32_bf16 v[72:75], a[128:131], v[132:135], v[72:75]
  v_mfma_f32_16x16x32_bf16 v[76:79], a[132:135], v[132:135], v[76:79]
  ds_read_b128 v[164:167], v31 offset:4096
  s_waitcnt lgkmcnt(7)
  v_mfma_f32_16x16x32_bf16 v[80:83], a[128:131], v[136:139], v[80:83]
  v_mfma_f32_16x16x32_bf16 v[84:87], a[132:135], v[136:139], v[84:87]
  ds_read_b128 v[168:171], v31 offset:8192
  s_waitcnt lgkmcnt(7)
  v_mfma_f32_16x16x32_bf16 v[88:91], a[128:131], v[140:143], v[88:91]
  v_mfma_f32_16x16x32_bf16 v[92:95], a[132:135], v[140:143], v[92:95]
  ds_read_b128 v[172:175], v31 offset:12288
  s_waitcnt lgkmcnt(7)
  v_mfma_f32_16x16x32_bf16 v[96:99], a[128:131], v[144:147], v[96:99]
  v_mfma_f32_16x16x32_bf16 v[100:103], a[132:135], v[144:147], v[100:103]
  ds_read_b128 v[176:179], v31 offset:16384
  s_waitcnt lgkmcnt(7)
  v_mfma_f32_16x16x32_bf16 v[104:107], a[128:131], v[148:151], v[104:107]
  v_mfma_f32_16x16x32_bf16 v[108:111], a[132:135], v[148:151], v[108:111]
  ds_read_b128 v[180:183], v31 offset:20480
  s_waitcnt lgkmcnt(7)
  v_mfma_f32_16x16x32_bf16 v[112:115], a[128:131], v[152:155], v[112:115]
  v_mfma_f32_16x16x32_bf16 v[116:119], a[132:135], v[152:155], v[116:119]
  ds_read_b128 v[184:187], v31 offset:24576
  s_waitcnt lgkmcnt(7)
  v_mfma_f32_16x16x32_bf16 v[120:123], a[128:131], v[156:159], v[120:123]
  v_mfma_f32_16x16x32_bf16 v[124:127], a[132:135], v[156:159], v[124:127]
  ds_read_b128 v[188:191], v31 offset:28672
  s_waitcnt lgkmcnt(7)
  v_mfma_f32_16x16x32_bf16 v[64:67], a[136:139], v[160:163], v[64:67]
  v_mfma_f32_16x16x32_bf16 v[68:71], a[140:143], v[160:163], v[68:71]
  ds_read_b128 v[128:131], v32 offset:0
  s_waitcnt lgkmcnt(7)
  v_mfma_f32_16x16x32_bf16 v[72:75], a[136:139], v[164:167], v[72:75]
  v_mfma_f32_16x16x32_bf16 v[76:79], a[140:143], v[164:167], v[76:79]
  ds_read_b128 v[132:135], v32 offset:4096
  s_waitcnt lgkmcnt(7)
  v_mfma_f32_16x16x32_bf16 v[80:83], a[136:139], v[168:171], v[80:83]
  v_mfma_f32_16x16x32_bf16 v[84:87], a[140:143], v[168:171], v[84:87]
  ds_read_b128 v[136:139], v32 offset:8192
  s_waitcnt lgkmcnt(7)
  v_mfma_f32_16x16x32_bf16 v[88:91], a[136:139], v[172:175], v[88:91]
  v_mfma_f32_16x16x32_bf16 v[92:95], a[140:143], v[172:175], v[92:95]
  ds_read_b128 v[140:143], v32 offset:12288
  s_waitcnt lgkmcnt(7)
  v_mfma_f32_16x16x32_bf16 v[96:99], a[136:139], v[176:179], v[96:99]
  v_mfma_f32_16x16x32_bf16 v[100:103], a[140:143], v[176:179], v[100:103]
  ds_read_b128 v[144:147], v32 offset:16384
  s_waitcnt lgkmcnt(7)
  v_mfma_f32_16x16x32_bf16 v[104:107], a[136:139], v[180:183], v[104:107]
  v_mfma_f32_16x16x32_bf16 v[108:111], a[140:143], v[180:183], v[108:111]
  ds_read_b128 v[148:151], v32 offset:20480
  s_waitcnt lgkmcnt(7)
  v_mfma_f32_16x16x32_bf16 v[112:115], a[136:139], v[184:187], v[112:115]
  v_mfma_f32_16x16x32_bf16 v[116:119], a[140:143], v[184:187], v[116:119]
  ds_read_b128 v[152:155], v32 offset:24576
  s_waitcnt lgkmcnt(7)
  v_mfma_f32_16x16x32_bf16 v[120:123], a[136:139], v[188:191], v[120:123]
  v_mfma_f32_16x16x32_bf16 v[124:127], a[140:143], v[188:191], v[124:127]
  ds_read_b128 v[156:159], v32 offset:28672
  s_waitcnt lgkmcnt(7)
  v_mfma_f32_16x16x32_bf16 v[64:67], a[144:147], v[128:131], v[64:67]
  v_mfma_f32_16x16x32_bf16 v[68:71], a[148:151], v[128:131], v[68:71]
  ds_read_b128 v[160:163], v33 offset:0
  s_waitcnt lgkmcnt(7)
  v_mfma_f32_16x16x32_bf16 v[72:75], a[144:147], v[132:135], v[72:75]
  v_mfma_f32_16x16x32_bf16 v[76:79], a[148:151], v[132:135], v[76:79]
  ds_read_b128 v[164:167], v33 offset:4096
  s_waitcnt lgkmcnt(7)
  v_mfma_f32_16x16x32_bf16 v[80:83], a[144:147], v[136:139], v[80:83]
  v_mfma_f32_16x16x32_bf16 v[84:87], a[148:151], v[136:139], v[84:87]
  ds_read_b128 v[168:171], v33 offset:8192
  s_waitcnt lgkmcnt(7)
  v_mfma_f32_16x16x32_bf16 v[88:91], a[144:147], v[140:143], v[88:91]
  v_mfma_f32_16x16x32_bf16 v[92:95], a[148:151], v[140:143], v[92:95]
  ds_read_b128 v[172:175], v33 offset:12288
  s_waitcnt lgkmcnt(7)
  v_mfma_f32_16x16x32_bf16 v[96:99], a[144:147], v[144:147], v[96:99]
  v_mfma_f32_16x16x32_bf16 v[100:103], a[148:151], v[144:147], v[100:103]
  ds_read_b128 v[176:179], v33 offset:16384
  s_waitcnt lgkmcnt(7)
  v_mfma_f32_16x16x32_bf16 v[104:107], a[144:147], v[148:151], v[104:107]
  v_mfma_f32_16x16x32_bf16 v[108:111], a[148:151], v[148:151], v[108:111]
  ds_read_b128 v[180:183], v33 offset:20480
  s_waitcnt lgkmcnt(7)
  v_mfma_f32_16x16x32_bf16 v[112:115], a[144:147], v[152:155], v[112:115]
  v_mfma_f32_16x16x32_bf16 v[116:119], a[148:151], v[152:155], v[116:119]
  ds_read_b128 v[184:187], v33 offset:24576
  s_waitcnt lgkmcnt(7)
  v_mfma_f32_16x16x32_bf16 v[120:123], a[144:147], v[156:159], v[120:123]
  v_mfma_f32_16x16x32_bf16 v[124:127], a[148:151], v[156:159], v[124:127]
  ds_read_b128 v[188:191], v33 offset:28672
  s_waitcnt lgkmcnt(7)
  v_mfma_f32_16x16x32_bf16 v[64:67], a[152:155], v[160:163], v[64:67]
  v_mfma_f32_16x16x32_bf16 v[68:71], a[156:159], v[160:163], v[68:71]
  s_waitcnt lgkmcnt(6)
  v_mfma_f32_16x16x32_bf16 v[72:75], a[152:155], v[164:167], v[72:75]
  v_mfma_f32_16x16x32_bf16 v[76:79], a[156:159], v[164:167], v[76:79]
  s_waitcnt lgkmcnt(5)
  v_mfma_f32_16x16x32_bf16 v[80:83], a[152:155], v[168:171], v[80:83]
  v_mfma_f32_16x16x32_bf16 v[84:87], a[156:159], v[168:171], v[84:87]
  s_waitcnt lgkmcnt(4)
  v_mfma_f32_16x16x32_bf16 v[88:91], a[152:155], v[172:175], v[88:91]
  v_mfma_f32_16x16x32_bf16 v[92:95], a[156:159], v[172:175], v[92:95]
  s_waitcnt lgkmcnt(3)
  v_mfma_f32_16x16x32_bf16 v[96:99], a[152:155], v[176:179], v[96:99]
  v_mfma_f32_16x16x32_bf16 v[100:103], a[156:159], v[176:179], v[100:103]
  s_waitcnt lgkmcnt(2)
  v_mfma_f32_16x16x32_bf16 v[104:107], a[152:155], v[180:183], v[104:107]
  v_mfma_f32_16x16x32_bf16 v[108:111], a[156:159], v[180:183], v[108:111]
  s_waitcnt lgkmcnt(1)
  v_mfma_f32_16x16x32_bf16 v[112:115], a[152:155], v[184:187], v[112:115]
  v_mfma_f32_16x16x32_bf16 v[116:119], a[156:159], v[184:187], v[116:119]
  s_waitcnt lgkmcnt(0)
  v_mfma_f32_16x16x32_bf16 v[120:123], a[152:155], v[188:191], v[120:123]
  v_mfma_f32_16x16x32_bf16 v[124:127], a[156:159], v[188:191], v[124:127]
  v_cvt_pk_bf16_f32 v192, v64, v65
  v_cvt_pk_bf16_f32 v193, v66, v67
  v_cvt_pk_bf16_f32 v194, v68, v69
  v_cvt_pk_bf16_f32 v195, v70, v71
  v_and_b32 v194, v19, v194
  v_and_b32 v195, v19, v195
  s_mov_b32 s75, s65
  buffer_store_dwordx4 v[192:195], v18, s[44:47], s75 offen sc1
  v_cvt_pk_bf16_f32 v196, v72, v73
  v_cvt_pk_bf16_f32 v197, v74, v75
  v_cvt_pk_bf16_f32 v198, v76, v77
  v_cvt_pk_bf16_f32 v199, v78, v79
  v_and_b32 v198, v19, v198
  v_and_b32 v199, v19, v199
  s_add_u32 s75, s65, s67
  s_add_u32 s65, s65, s66
  buffer_store_dwordx4 v[196:199], v18, s[44:47], s75 offen sc1
  v_cvt_pk_bf16_f32 v200, v80, v81
  v_cvt_pk_bf16_f32 v201, v82, v83
  v_cvt_pk_bf16_f32 v202, v84, v85
  v_cvt_pk_bf16_f32 v203, v86, v87
  v_and_b32 v202, v19, v202
  v_and_b32 v203, v19, v203
  s_mov_b32 s75, s65
  buffer_store_dwordx4 v[200:203], v18, s[44:47], s75 offen sc1
  v_cvt_pk_bf16_f32 v204, v88, v89
  v_cvt_pk_bf16_f32 v205, v90, v91
  v_cvt_pk_bf16_f32 v206, v92, v93
  v_cvt_pk_bf16_f32 v207, v94, v95
  v_and_b32 v206, v19, v206
  v_and_b32 v207, v19, v207
  s_add_u32 s75, s65, s67
  s_add_u32 s65, s65, s66
  buffer_store_dwordx4 v[204:207], v18, s[44:47], s75 offen sc1
  v_cvt_pk_bf16_f32 v192, v96, v97
  v_cvt_pk_bf16_f32 v193, v98, v99
  v_cvt_pk_bf16_f32 v194, v100, v101
  v_cvt_pk_bf16_f32 v195, v102, v103
  v_and_b32 v194, v19, v194
  v_and_b32 v195, v19, v195
  s_mov_b32 s75, s65
  buffer_store_dwordx4 v[192:195], v18, s[44:47], s75 offen sc1
  v_cvt_pk_bf16_f32 v196, v104, v105
  v_cvt_pk_bf16_f32 v197, v106, v107
  v_cvt_pk_bf16_f32 v198, v108, v109
  v_cvt_pk_bf16_f32 v199, v110, v111
  v_and_b32 v198, v19, v198
  v_and_b32 v199, v19, v199
  s_add_u32 s75, s65, s67
  s_add_u32 s65, s65, s66
  buffer_store_dwordx4 v[196:199], v18, s[44:47], s75 offen sc1
  v_cvt_pk_bf16_f32 v200, v112, v113
  v_cvt_pk_bf16_f32 v201, v114, v115
  v_cvt_pk_bf16_f32 v202, v116, v117
  v_cvt_pk_bf16_f32 v203, v118, v119
  v_and_b32 v202, v19, v202
  v_and_b32 v203, v19, v203
  s_mov_b32 s75, s65
  buffer_store_dwordx4 v[200:203], v18, s[44:47], s75 offen sc1
  v_cvt_pk_bf16_f32 v204, v120, v121
  v_cvt_pk_bf16_f32 v205, v122, v123
  v_cvt_pk_bf16_f32 v206, v124, v125
  v_cvt_pk_bf16_f32 v207, v126, v127
  v_and_b32 v206, v19, v206
  v_and_b32 v207, v19, v207
  s_add_u32 s75, s65, s67
  s_add_u32 s65, s65, s66
  buffer_store_dwordx4 v[204:207], v18, s[44:47], s75 offen sc1
  v_mov_b32 v45, 0
  s_movk_i32 s71, 16
  s_mov_b64 exec, 1
  s_mov_b32 s70, 0
SP_2:
  buffer_load_dword v44, v45, s[52:55], 0 offen sc1
  s_waitcnt vmcnt(0)
  v_cmp_gt_u32 vcc, s71, v44
  s_cbranch_vccz SD_3
  s_sleep 4
  s_add_u32 s70, s70, 1
  s_cmp_lt_u32 s70, 539568
  s_cbranch_scc1 SP_2
  s_endpgm
SD_3:
  s_mov_b64 exec, -1
  s_barrier
  s_mov_b64 exec, 1
  v_mov_b32 v20, 1
  buffer_store_dword v20, v21, s[32:35], 0 offen sc1
  s_mov_b64 exec, -1
  s_add_u32 s75, s73, 0
  s_add_u32 m0, s74, 0
  s_nop 0
  buffer_load_dwordx4 v2, s[36:39], s75 offen lds
  s_add_u32 s75, s73, 0
  s_add_u32 m0, s74, 1024
  s_nop 0
  buffer_load_dwordx4 v3, s[36:39], s75 offen lds
  s_add_u32 s75, s73, 0
  s_add_u32 m0, s74, 2048
  s_nop 0
  buffer_load_dwordx4 v4, s[36:39], s75 offen lds
  s_add_u32 s75, s73, 0
  s_add_u32 m0, s74, 3072
  s_nop 0
  buffer_load_dwordx4 v5, s[36:39], s75 offen lds
  s_add_u32 s75, s73, 20480
  s_add_u32 m0, s74, 4096
  s_nop 0
  buffer_load_dwordx4 v2, s[36:39], s75 offen lds
  s_add_u32 s75, s73, 20480
  s_add_u32 m0, s74, 5120
  s_nop 0
  buffer_load_dwordx4 v3, s[36:39], s75 offen lds
  s_add_u32 s75, s73, 20480
  s_add_u32 m0, s74, 6144
  s_nop 0
  buffer_load_dwordx4 v4, s[36:39], s75 offen lds
  s_add_u32 s75, s73, 20480
  s_add_u32 m0, s74, 7168
  s_nop 0
  buffer_load_dwordx4 v5, s[36:39], s75 offen lds
  s_add_u32 s75, s73, 256
  s_add_u32 m0, s74, 32768
  s_nop 0
  buffer_load_dwordx4 v2, s[36:39], s75 offen lds
  s_add_u32 s75, s73, 256
  s_add_u32 m0, s74, 33792
  s_nop 0
  buffer_load_dwordx4 v3, s[36:39], s75 offen lds
  s_add_u32 s75, s73, 256
  s_add_u32 m0, s74, 34816
  s_nop 0
  buffer_load_dwordx4 v4, s[36:39], s75 offen lds
  s_add_u32 s75, s73, 256
  s_add_u32 m0, s74, 35840
  s_nop 0
  buffer_load_dwordx4 v5, s[36:39], s75 offen lds
  s_add_u32 s75, s73, 20736
  s_add_u32 m0, s74, 36864
  s_nop 0
  buffer_load_dwordx4 v2, s[36:39], s75 offen lds
  s_add_u32 s75, s73, 20736
  s_add_u32 m0, s74, 37888
  s_nop 0
  buffer_load_dwordx4 v3, s[36:39], s75 offen lds
  s_add_u32 s75, s73, 20736
  s_add_u32 m0, s74, 38912
  s_nop 0
  buffer_load_dwordx4 v4, s[36:39], s75 offen lds
  s_add_u32 s75, s73, 20736
  s_add_u32 m0, s74, 39936
  s_nop 0
  buffer_load_dwordx4 v5, s[36:39], s75 offen lds
  s_add_u32 s75, s73, 512
  s_add_u32 m0, s74, 65536
  s_nop 0
  buffer_load_dwordx4 v2, s[36:39], s75 offen lds
  s_add_u32 s75, s73, 512
  s_add_u32 m0, s74, 66560
  s_nop 0
  buffer_load_dwordx4 v3, s[36:39], s75 offen lds
  s_add_u32 s75, s73, 512
  s_add_u32 m0, s74, 67584
  s_nop 0
  buffer_load_dwordx4 v4, s[36:39], s75 offen lds
  s_add_u32 s75, s73, 512
  s_add_u32 m0, s74, 68608
  s_nop 0
  buffer_load_dwordx4 v5, s[36:39], s75 offen lds
  s_add_u32 s75, s73, 20992
  s_add_u32 m0, s74, 69632
  s_nop 0
  buffer_load_dwordx4 v2, s[36:39], s75 offen lds
  s_add_u32 s75, s73, 20992
  s_add_u32 m0, s74, 70656
  s_nop 0
  buffer_load_dwordx4 v3, s[36:39], s75 offen lds
  s_add_u32 s75, s73, 20992
  s_add_u32 m0, s74, 71680
  s_nop 0
  buffer_load_dwordx4 v4, s[36:39], s75 offen lds
  s_add_u32 s75, s73, 20992
  s_add_u32 m0, s74, 72704
  s_nop 0
  buffer_load_dwordx4 v5, s[36:39], s75 offen lds
  s_add_u32 s75, s73, 768
  s_add_u32 m0, s74, 98304
  s_nop 0
  buffer_load_dwordx4 v2, s[36:39], s75 offen lds
  s_add_u32 s75, s73, 768
  s_add_u32 m0, s74, 99328
  s_nop 0
  buffer_load_dwordx4 v3, s[36:39], s75 offen lds
  s_add_u32 s75, s73, 768
  s_add_u32 m0, s74, 100352
  s_nop 0
  buffer_load_dwordx4 v4, s[36:39], s75 offen lds
  s_add_u32 s75, s73, 768
  s_add_u32 m0, s74, 101376
  s_nop 0
  buffer_load_dwordx4 v5, s[36:39], s75 offen lds
  s_add_u32 s75, s73, 21248
  s_add_u32 m0, s74, 102400
  s_nop 0
  buffer_load_dwordx4 v2, s[36:39], s75 offen lds
  s_add_u32 s75, s73, 21248
  s_add_u32 m0, s74, 103424
  s_nop 0
  buffer_load_dwordx4 v3, s[36:39], s75 offen lds
  s_add_u32 s75, s73, 21248
  s_add_u32 m0, s74, 104448
  s_nop 0
  buffer_load_dwordx4 v4, s[36:39], s75 offen lds
  s_add_u32 s75, s73, 21248
  s_add_u32 m0, s74, 105472
  s_nop 0
  buffer_load_dwordx4 v5, s[36:39], s75 offen lds
  s_mov_b32 s72, s73
  s_add_u32 s73, s73, 163840
  s_mov_b32 s79, 1
  s_waitcnt vmcnt(24)
  s_barrier
  s_cmp_le_u32 s69, 1
  s_cbranch_scc1 L_pwTdone
  ds_read_b128 v[128:131], v30 offset:0
  ds_read_b128 v[132:135], v30 offset:4096
  ds_read_b128 v[136:139], v30 offset:8192
  ds_read_b128 v[140:143], v30 offset:12288
  ds_read_b128 v[144:147], v30 offset:16384
  ds_read_b128 v[148:151], v30 offset:20480
  ds_read_b128 v[152:155], v30 offset:24576
  ds_read_b128 v[156:159], v30 offset:28672
PWL_1:
  s_waitcnt lgkmcnt(7)
  v_mfma_f32_16x16x32_bf16 v[64:67], a[0:3], v[128:131], 0
  v_mfma_f32_16x16x32_bf16 v[68:71], a[4:7], v[128:131], 0
  ds_read_b128 v[160:163], v31 offset:0
  s_waitcnt lgkmcnt(7)
  v_mfma_f32_16x16x32_bf16 v[72:75], a[0:3], v[132:135], 0
  v_mfma_f32_16x16x32_bf16 v[76:79], a[4:7], v[132:135], 0
  ds_read_b128 v[164:167], v31 offset:4096
  s_waitcnt lgkmcnt(7)
  v_mfma_f32_16x16x32_bf16 v[80:83], a[0:3], v[136:139], 0
  v_mfma_f32_16x16x32_bf16 v[84:87], a[4:7], v[136:139], 0
  ds_read_b128 v[168:171], v31 offset:8192
  s_add_u32 s75, s72, 768
  s_add_u32 m0, s74, 100352
  s_nop 0
  buffer_load_dwordx4 v4, s[36:39], s75 offen lds
  s_waitcnt lgkmcnt(7)
  v_mfma_f32_16x16x32_bf16 v[88:91], a[0:3], v[140:143], 0
  v_mfma_f32_16x16x32_bf16 v[92:95], a[4:7], v[140:143], 0
  ds_read_b128 v[172:175], v31 offset:12288
  s_waitcnt lgkmcnt(7)
  v_mfma_f32_16x16x32_bf16 v[96:99], a[0:3], v[144:147], 0
  v_mfma_f32_16x16x32_bf16 v[100:103], a[4:7], v[144:147], 0
  ds_read_b128 v[176:179], v31 offset:16384
  s_waitcnt lgkmcnt(7)
  v_mfma_f32_16x16x32_bf16 v[104:107], a[0:3], v[148:151], 0
  v_mfma_f32_16x16x32_bf16 v[108:111], a[4:7], v[148:151], 0
  ds_read_b128 v[180:183], v31 offset:20480
  s_waitcnt lgkmcnt(7)
  v_mfma_f32_16x16x32_bf16 v[112:115], a[0:3], v[152:155], 0
  v_mfma_f32_16x16x32_bf16 v[116:119], a[4:7], v[152:155], 0
  ds_read_b128 v[184:187], v31 offset:24576
  s_add_u32 s75, s72, 768
  s_add_u32 m0, s74, 101376
  s_nop 0
  buffer_load_dwordx4 v5, s[36:39], s75 offen lds
  s_waitcnt lgkmcnt(7)
  v_mfma_f32_16x16x32_bf16 v[120:123], a[0:3], v[156:159], 0
  v_mfma_f32_16x16x32_bf16 v[124:127], a[4:7], v[156:159], 0
  ds_read_b128 v[188:191], v31 offset:28672
  s_waitcnt lgkmcnt(7)
  v_mfma_f32_16x16x32_bf16 v[64:67], a[8:11], v[160:163], v[64:67]
  v_mfma_f32_16x16x32_bf16 v[68:71], a[12:15], v[160:163], v[68:71]
  ds_read_b128 v[128:131], v32 offset:0
  s_waitcnt lgkmcnt(7)
  v_mfma_f32_16x16x32_bf16 v[72:75], a[8:11], v[164:167], v[72:75]
  v_mfma_f32_16x16x32_bf16 v[76:79], a[12:15], v[164:167], v[76:79]
  ds_read_b128 v[132:135], v32 offset:4096
  s_waitcnt lgkmcnt(7)
  v_mfma_f32_16x16x32_bf16 v[80:83], a[8:11], v[168:171], v[80:83]
  v_mfma_f32_16x16x32_bf16 v[84:87], a[12:15], v[168:171], v[84:87]
  ds_read_b128 v[136:139], v32 offset:8192
  s_add_u32 s75, s72, 21248
  s_add_u32 m0, s74, 102400
  s_nop 0
  buffer_load_dwordx4 v2, s[36:39], s75 offen lds
  s_waitcnt lgkmcnt(7)
  v_mfma_f32_16x16x32_bf16 v[88:91], a[8:11], v[172:175], v[88:91]
  v_mfma_f32_16x16x32_bf16 v[92:95], a[12:15], v[172:175], v[92:95]
  ds_read_b128 v[140:143], v32 offset:12288
  s_waitcnt lgkmcnt(7)
  v_mfma_f32_16x16x32_bf16 v[96:99], a[8:11], v[176:179], v[96:99]
  v_mfma_f32_16x16x32_bf16 v[100:103], a[12:15], v[176:179], v[100:103]
  ds_read_b128 v[144:147], v32 offset:16384
  s_waitcnt lgkmcnt(7)
  v_mfma_f32_16x16x32_bf16 v[104:107], a[8:11], v[180:183], v[104:107]
  v_mfma_f32_16x16x32_bf16 v[108:111], a[12:15], v[180:183], v[108:111]
  ds_read_b128 v[148:151], v32 offset:20480
  s_waitcnt lgkmcnt(7)
  v_mfma_f32_16x16x32_bf16 v[112:115], a[8:11], v[184:187], v[112:115]
  v_mfma_f32_16x16x32_bf16 v[116:119], a[12:15], v[184:187], v[116:119]
  ds_read_b128 v[152:155], v32 offset:24576
  s_add_u32 s75, s72, 21248
  s_add_u32 m0, s74, 103424
  s_nop 0
  buffer_load_dwordx4 v3, s[36:39], s75 offen lds
  s_waitcnt lgkmcnt(7)
  v_mfma_f32_16x16x32_bf16 v[120:123], a[8:11], v[188:191], v[120:123]
  v_mfma_f32_16x16x32_bf16 v[124:127], a[12:15], v[188:191], v[124:127]
  ds_read_b128 v[156:159], v32 offset:28672
  s_waitcnt lgkmcnt(7)
  v_mfma_f32_16x16x32_bf16 v[64:67], a[16:19], v[128:131], v[64:67]
  v_mfma_f32_16x16x32_bf16 v[68:71], a[20:23], v[128:131], v[68:71]
  ds_read_b128 v[160:163], v33 offset:0
  s_waitcnt lgkmcnt(7)
  v_mfma_f32_16x16x32_bf16 v[72:75], a[16:19], v[132:135], v[72:75]
  v_mfma_f32_16x16x32_bf16 v[76:79], a[20:23], v[132:135], v[76:79]
  ds_read_b128 v[164:167], v33 offset:4096
  s_waitcnt lgkmcnt(7)
  v_mfma_f32_16x16x32_bf16 v[80:83], a[16:19], v[136:139], v[80:83]
  v_mfma_f32_16x16x32_bf16 v[84:87], a[20:23], v[136:139], v[84:87]
  ds_read_b128 v[168:171], v33 offset:8192
  s_add_u32 s75, s72, 21248
  s_add_u32 m0, s74, 104448
  s_nop 0
  buffer_load_dwordx4 v4, s[36:39], s75 offen lds
  s_waitcnt lgkmcnt(7)
  v_mfma_f32_16x16x32_bf16 v[88:91], a[16:19], v[140:143], v[88:91]
  v_mfma_f32_16x16x32_bf16 v[92:95], a[20:23], v[140:143], v[92:95]
  ds_read_b128 v[172:175], v33 offset:12288
  s_waitcnt lgkmcnt(7)
  v_mfma_f32_16x16x32_bf16 v[96:99], a[16:19], v[144:147], v[96:99]
  v_mfma_f32_16x16x32_bf16 v[100:103], a[20:23], v[144:147], v[100:103]
  ds_read_b128 v[176:179], v33 offset:16384
  s_waitcnt lgkmcnt(7)
  v_mfma_f32_16x16x32_bf16 v[104:107], a[16:19], v[148:151], v[104:107]
  v_mfma_f32_16x16x32_bf16 v[108:111], a[20:23], v[148:151], v[108:111]
  ds_read_b128 v[180:183], v33 offset:20480
  s_waitcnt lgkmcnt(7)
  v_mfma_f32_16x16x32_bf16 v[112:115], a[16:19], v[152:155], v[112:115]
  v_mfma_f32_16x16x32_bf16 v[116:119], a[20:23], v[152:155], v[116:119]
  ds_read_b128 v[184:187], v33 offset:24576
  s_add_u32 s75, s72, 21248
  s_add_u32 m0, s74, 105472
  s_nop 0
  buffer_load_dwordx4 v5, s[36:39], s75 offen lds
  s_waitcnt lgkmcnt(7)
  v_mfma_f32_16x16x32_bf16 v[120:123], a[16:19], v[156:159], v[120:123]
  v_mfma_f32_16x16x32_bf16 v[124:127], a[20:23], v[156:159], v[124:127]
  ds_read_b128 v[188:191], v33 offset:28672
  s_waitcnt vmcnt(16)
  s_barrier
  s_waitcnt lgkmcnt(7)
  v_mfma_f32_16x16x32_bf16 v[64:67], a[24:27], v[160:163], v[64:67]
  v_mfma_f32_16x16x32_bf16 v[68:71], a[28:31], v[160:163], v[68:71]
  ds_read_b128 v[128:131], v30 offset:32768
  s_waitcnt lgkmcnt(7)
  v_mfma_f32_16x16x32_bf16 v[72:75], a[24:27], v[164:167], v[72:75]
  v_mfma_f32_16x16x32_bf16 v[76:79], a[28:31], v[164:167], v[76:79]
  ds_read_b128 v[132:135], v30 offset:36864
  s_waitcnt lgkmcnt(7)
  v_mfma_f32_16x16x32_bf16 v[80:83], a[24:27], v[168:171], v[80:83]
  v_mfma_f32_16x16x32_bf16 v[84:87], a[28:31], v[168:171], v[84:87]
  ds_read_b128 v[136:139], v30 offset:40960
  s_add_u32 s75, s72, 1024
  s_add_u32 m0, s74, 131072
  s_nop 0
  buffer_load_dwordx4 v2, s[36:39], s75 offen lds
  s_waitcnt lgkmcnt(7)
  v_mfma_f32_16x16x32_bf16 v[88:91], a[24:27], v[172:175], v[88:91]
  v_mfma_f32_16x16x32_bf16 v[92:95], a[28:31], v[172:175], v[92:95]
  ds_read_b128 v[140:143], v30 offset:45056
  s_waitcnt lgkmcnt(7)
  v_mfma_f32_16x16x32_bf16 v[96:99], a[24:27], v[176:179], v[96:99]
  v_mfma_f32_16x16x32_bf16 v[100:103], a[28:31], v[176:179], v[100:103]
  ds_read_b128 v[144:147], v30 offset:49152
  s_waitcnt lgkmcnt(7)
  v_mfma_f32_16x16x32_bf16 v[104:107], a[24:27], v[180:183], v[104:107]
  v_mfma_f32_16x16x32_bf16 v[108:111], a[28:31], v[180:183], v[108:111]
  ds_read_b128 v[148:151], v30 offset:53248
  s_waitcnt lgkmcnt(7)
  v_mfma_f32_16x16x32_bf16 v[112:115], a[24:27], v[184:187], v[112:115]
  v_mfma_f32_16x16x32_bf16 v[116:119], a[28:31], v[184:187], v[116:119]
  ds_read_b128 v[152:155], v30 offset:57344
  s_add_u32 s75, s72, 1024
  s_add_u32 m0, s74, 132096
  s_nop 0
  buffer_load_dwordx4 v3, s[36:39], s75 offen lds
  s_waitcnt lgkmcnt(7)
  v_mfma_f32_16x16x32_bf16 v[120:123], a[24:27], v[188:191], v[120:123]
  v_mfma_f32_16x16x32_bf16 v[124:127], a[28:31], v[188:191], v[124:127]
  ds_read_b128 v[156:159], v30 offset:61440
  s_waitcnt lgkmcnt(7)
  v_mfma_f32_16x16x32_bf16 v[64:67], a[32:35], v[128:131], v[64:67]
  v_mfma_f32_16x16x32_bf16 v[68:71], a[36:39], v[128:131], v[68:71]
  ds_read_b128 v[160:163], v31 offset:32768
  buffer_load_dwordx4 v[208:211], v46, s[36:39], s85 offen
  s_add_u32 s85, s85, 1024
  s_waitcnt lgkmcnt(7)
  v_mfma_f32_16x16x32_bf16 v[72:75], a[32:35], v[132:135], v[72:75]
  v_mfma_f32_16x16x32_bf16 v[76:79], a[36:39], v[132:135], v[76:79]
  ds_read_b128 v[164:167], v31 offset:36864
  buffer_load_dwordx4 v[212:215], v46, s[36:39], s85 offen
  s_add_u32 s85, s85, 1024
  s_waitcnt lgkmcnt(7)
  v_mfma_f32_16x16x32_bf16 v[80:83], a[32:35], v[136:139], v[80:83]
  v_mfma_f32_16x16x32_bf16 v[84:87], a[36:39], v[136:139], v[84:87]
  ds_read_b128 v[168:171], v31 offset:40960
  s_add_u32 s75, s72, 1024
  s_add_u32 m0, s74, 133120
  s_nop 0
  buffer_load_dwordx4 v4, s[36:39], s75 offen lds
  buffer_load_dwordx4 v[216:219], v46, s[36:39], s85 offen
  s_add_u32 s85, s85, 1024
  s_waitcnt lgkmcnt(7)
  v_mfma_f32_16x16x32_bf16 v[88:91], a[32:35], v[140:143], v[88:91]
  v_mfma_f32_16x16x32_bf16 v[92:95], a[36:39], v[140:143], v[92:95]
  ds_read_b128 v[172:175], v31 offset:45056
  buffer_load_dwordx4 v[220:223], v46, s[36:39], s85 offen
  s_add_u32 s85, s85, 1024
  s_waitcnt lgkmcnt(7)
  v_mfma_f32_16x16x32_bf16 v[96:99], a[32:35], v[144:147], v[96:99]
  v_mfma_f32_16x16x32_bf16 v[100:103], a[36:39], v[144:147], v[100:103]
  ds_read_b128 v[176:179], v31 offset:49152
  buffer_load_dwordx4 v[224:227], v46, s[36:39], s85 offen
  s_add_u32 s85, s85, 1024
  s_waitcnt lgkmcnt(7)
  v_mfma_f32_16x16x32_bf16 v[104:107], a[32:35], v[148:151], v[104:107]
  v_mfma_f32_16x16x32_bf16 v[108:111], a[36:39], v[148:151], v[108:111]
  ds_read_b128 v[180:183], v31 offset:53248
  buffer_load_dwordx4 v[228:231], v46, s[36:39], s85 offen
  s_add_u32 s85, s85, 1024
  s_waitcnt lgkmcnt(7)
  v_mfma_f32_16x16x32_bf16 v[112:115], a[32:35], v[152:155], v[112:115]
  v_mfma_f32_16x16x32_bf16 v[116:119], a[36:39], v[152:155], v[116:119]
  ds_read_b128 v[184:187], v31 offset:57344
  s_add_u32 s75, s72, 1024
  s_add_u32 m0, s74, 134144
  s_nop 0
  buffer_load_dwordx4 v5, s[36:39], s75 offen lds
  buffer_load_dwordx4 v[232:235], v46, s[36:39], s85 offen
  s_add_u32 s85, s85, 157696
  s_waitcnt lgkmcnt(7)
  v_mfma_f32_16x16x32_bf16 v[120:123], a[32:35], v[156:159], v[120:123]
  v_mfma_f32_16x16x32_bf16 v[124:127], a[36:39], v[156:159], v[124:127]
  ds_read_b128 v[188:191], v31 offset:61440
  s_waitcnt lgkmcnt(7)
  v_mfma_f32_16x16x32_bf16 v[64:67], a[40:43], v[160:163], v[64:67]
  v_mfma_f32_16x16x32_bf16 v[68:71], a[44:47], v[160:163], v[68:71]
  ds_read_b128 v[128:131], v32 offset:32768
  s_waitcnt lgkmcnt(7)
  v_mfma_f32_16x16x32_bf16 v[72:75], a[40:43], v[164:167], v[72:75]
  v_mfma_f32_16x16x32_bf16 v[76:79], a[44:47], v[164:167], v[76:79]
  ds_read_b128 v[132:135], v32 offset:36864
  s_waitcnt lgkmcnt(7)
  v_mfma_f32_16x16x32_bf16 v[80:83], a[40:43], v[168:171], v[80:83]
  v_mfma_f32_16x16x32_bf16 v[84:87], a[44:47], v[168:171], v[84:87]
  ds_read_b128 v[136:139], v32 offset:40960
  s_add_u32 s75, s72, 21504
  s_add_u32 m0, s74, 135168
  s_nop 0
  buffer_load_dwordx4 v2, s[36:39], s75 offen lds
  s_waitcnt lgkmcnt(7)
  v_mfma_f32_16x16x32_bf16 v[88:91], a[40:43], v[172:175], v[88:91]
  v_mfma_f32_16x16x32_bf16 v[92:95], a[44:47], v[172:175], v[92:95]
  ds_read_b128 v[140:143], v32 offset:45056
  s_waitcnt lgkmcnt(7)
  v_mfma_f32_16x16x32_bf16 v[96:99], a[40:43], v[176:179], v[96:99]
  v_mfma_f32_16x16x32_bf16 v[100:103], a[44:47], v[176:179], v[100:103]
  ds_read_b128 v[144:147], v32 offset:49152
  s_waitcnt lgkmcnt(7)
  v_mfma_f32_16x16x32_bf16 v[104:107], a[40:43], v[180:183], v[104:107]
  v_mfma_f32_16x16x32_bf16 v[108:111], a[44:47], v[180:183], v[108:111]
  ds_read_b128 v[148:151], v32 offset:53248
  s_waitcnt lgkmcnt(7)
  v_mfma_f32_16x16x32_bf16 v[112:115], a[40:43], v[184:187], v[112:115]
  v_mfma_f32_16x16x32_bf16 v[116:119], a[44:47], v[184:187], v[116:119]
  ds_read_b128 v[152:155], v32 offset:57344
  s_add_u32 s75, s72, 21504
  s_add_u32 m0, s74, 136192
  s_nop 0
  buffer_load_dwordx4 v3, s[36:39], s75 offen lds
  s_waitcnt lgkmcnt(7)
  v_mfma_f32_16x16x32_bf16 v[120:123], a[40:43], v[188:191], v[120:123]
  v_mfma_f32_16x16x32_bf16 v[124:127], a[44:47], v[188:191], v[124:127]
  ds_read_b128 v[156:159], v32 offset:61440
  s_waitcnt lgkmcnt(7)
  v_mfma_f32_16x16x32_bf16 v[64:67], a[48:51], v[128:131], v[64:67]
  v_mfma_f32_16x16x32_bf16 v[68:71], a[52:55], v[128:131], v[68:71]
  ds_read_b128 v[160:163], v33 offset:32768
  s_waitcnt lgkmcnt(7)
  v_mfma_f32_16x16x32_bf16 v[72:75], a[48:51], v[132:135], v[72:75]
  v_mfma_f32_16x16x32_bf16 v[76:79], a[52:55], v[132:135], v[76:79]
  ds_read_b128 v[164:167], v33 offset:36864
  s_waitcnt lgkmcnt(7)
  v_mfma_f32_16x16x32_bf16 v[80:83], a[48:51], v[136:139], v[80:83]
  v_mfma_f32_16x16x32_bf16 v[84:87], a[52:55], v[136:139], v[84:87]
  ds_read_b128 v[168:171], v33 offset:40960
  s_add_u32 s75, s72, 21504
  s_add_u32 m0, s74, 137216
  s_nop 0
  buffer_load_dwordx4 v4, s[36:39], s75 offen lds
  s_waitcnt lgkmcnt(7)
  v_mfma_f32_16x16x32_bf16 v[88:91], a[48:51], v[140:143], v[88:91]
  v_mfma_f32_16x16x32_bf16 v[92:95], a[52:55], v[140:143], v[92:95]
  ds_read_b128 v[172:175], v33 offset:45056
  s_waitcnt lgkmcnt(7)
  v_mfma_f32_16x16x32_bf16 v[96:99], a[48:51], v[144:147], v[96:99]
  v_mfma_f32_16x16x32_bf16 v[100:103], a[52:55], v[144:147], v[100:103]
  ds_read_b128 v[176:179], v33 offset:49152
  s_waitcnt lgkmcnt(7)
  v_mfma_f32_16x16x32_bf16 v[104:107], a[48:51], v[148:151], v[104:107]
  v_mfma_f32_16x16x32_bf16 v[108:111], a[52:55], v[148:151], v[108:111]
  ds_read_b128 v[180:183], v33 offset:53248
  s_waitcnt lgkmcnt(7)
  v_mfma_f32_16x16x32_bf16 v[112:115], a[48:51], v[152:155], v[112:115]
  v_mfma_f32_16x16x32_bf16 v[116:119], a[52:55], v[152:155], v[116:119]
  ds_read_b128 v[184:187], v33 offset:57344
  s_add_u32 s75, s72, 21504
  s_add_u32 m0, s74, 138240
  s_nop 0
  buffer_load_dwordx4 v5, s[36:39], s75 offen lds
  s_waitcnt lgkmcnt(7)
  v_mfma_f32_16x16x32_bf16 v[120:123], a[48:51], v[156:159], v[120:123]
  v_mfma_f32_16x16x32_bf16 v[124:127], a[52:55], v[156:159], v[124:127]
  ds_read_b128 v[188:191], v33 offset:61440
  s_waitcnt vmcnt(23)
  s_barrier
  s_waitcnt lgkmcnt(7)
  v_mfma_f32_16x16x32_bf16 v[64:67], a[56:59], v[160:163], v[64:67]
  v_mfma_f32_16x16x32_bf16 v[68:71], a[60:63], v[160:163], v[68:71]
  ds_read_b128 v[128:131], v34 offset:0
  s_waitcnt lgkmcnt(7)
  v_mfma_f32_16x16x32_bf16 v[72:75], a[56:59], v[164:167], v[72:75]
  v_mfma_f32_16x16x32_bf16 v[76:79], a[60:63], v[164:167], v[76:79]
  ds_read_b128 v[132:135], v34 offset:4096
  s_waitcnt lgkmcnt(7)
  v_mfma_f32_16x16x32_bf16 v[80:83], a[56:59], v[168:171], v[80:83]
  v_mfma_f32_16x16x32_bf16 v[84:87], a[60:63], v[168:171], v[84:87]
  ds_read_b128 v[136:139], v34 offset:8192
  s_add_u32 s75, s73, 0
  s_add_u32 m0, s74, 0
  s_nop 0
  buffer_load_dwordx4 v2, s[36:39], s75 offen lds
  s_waitcnt lgkmcnt(7)
  v_mfma_f32_16x16x32_bf16 v[88:91], a[56:59], v[172:175], v[88:91]
  v_mfma_f32_16x16x32_bf16 v[92:95], a[60:63], v[172:175], v[92:95]
  ds_read_b128 v[140:143], v34 offset:12288
  s_waitcnt lgkmcnt(7)
  v_mfma_f32_16x16x32_bf16 v[96:99], a[56:59], v[176:179], v[96:99]
  v_mfma_f32_16x16x32_bf16 v[100:103], a[60:63], v[176:179], v[100:103]
  ds_read_b128 v[144:147], v34 offset:16384
  s_waitcnt lgkmcnt(7)
  v_mfma_f32_16x16x32_bf16 v[104:107], a[56:59], v[180:183], v[104:107]
  v_mfma_f32_16x16x32_bf16 v[108:111], a[60:63], v[180:183], v[108:111]
  ds_read_b128 v[148:151], v34 offset:20480
  s_waitcnt lgkmcnt(7)
  v_mfma_f32_16x16x32_bf16 v[112:115], a[56:59], v[184:187], v[112:115]
  v_mfma_f32_16x16x32_bf16 v[116:119], a[60:63], v[184:187], v[116:119]
  ds_read_b128 v[152:155], v34 offset:24576
  s_add_u32 s75, s73, 0
  s_add_u32 m0, s74, 1024
  s_nop 0
  buffer_load_dwordx4 v3, s[36:39], s75 offen lds
  s_waitcnt lgkmcnt(7)
  v_mfma_f32_16x16x32_bf16 v[120:123], a[56:59], v[188:191], v[120:123]
  v_mfma_f32_16x16x32_bf16 v[124:127], a[60:63], v[188:191], v[124:127]
  ds_read_b128 v[156:159], v34 offset:28672
  s_waitcnt lgkmcnt(7)
  v_mfma_f32_16x16x32_bf16 v[64:67], a[64:67], v[128:131], v[64:67]
  v_mfma_f32_16x16x32_bf16 v[68:71], a[68:71], v[128:131], v[68:71]
  ds_read_b128 v[160:163], v35 offset:0
  s_waitcnt lgkmcnt(7)
  v_mfma_f32_16x16x32_bf16 v[72:75], a[64:67], v[132:135], v[72:75]
  v_mfma_f32_16x16x32_bf16 v[76:79], a[68:71], v[132:135], v[76:79]
  ds_read_b128 v[164:167], v35 offset:4096
  s_waitcnt lgkmcnt(7)
  v_mfma_f32_16x16x32_bf16 v[80:83], a[64:67], v[136:139], v[80:83]
  v_mfma_f32_16x16x32_bf16 v[84:87], a[68:71], v[136:139], v[84:87]
  ds_read_b128 v[168:171], v35 offset:8192
  s_add_u32 s75, s73, 0
  s_add_u32 m0, s74, 2048
  s_nop 0
  buffer_load_dwordx4 v4, s[36:39], s75 offen lds
  s_waitcnt lgkmcnt(7)
  v_mfma_f32_16x16x32_bf16 v[88:91], a[64:67], v[140:143], v[88:91]
  v_mfma_f32_16x16x32_bf16 v[92:95], a[68:71], v[140:143], v[92:95]
  ds_read_b128 v[172:175], v35 offset:12288
  s_waitcnt lgkmcnt(7)
  v_mfma_f32_16x16x32_bf16 v[96:99], a[64:67], v[144:147], v[96:99]
  v_mfma_f32_16x16x32_bf16 v[100:103], a[68:71], v[144:147], v[100:103]
  ds_read_b128 v[176:179], v35 offset:16384
  s_waitcnt lgkmcnt(7)
  v_mfma_f32_16x16x32_bf16 v[104:107], a[64:67], v[148:151], v[104:107]
  v_mfma_f32_16x16x32_bf16 v[108:111], a[68:71], v[148:151], v[108:111]
  ds_read_b128 v[180:183], v35 offset:20480
  s_waitcnt lgkmcnt(7)
  v_mfma_f32_16x16x32_bf16 v[112:115], a[64:67], v[152:155], v[112:115]
  v_mfma_f32_16x16x32_bf16 v[116:119], a[68:71], v[152:155], v[116:119]
  ds_read_b128 v[184:187], v35 offset:24576
  s_add_u32 s75, s73, 0
  s_add_u32 m0, s74, 3072
  s_nop 0
  buffer_load_dwordx4 v5, s[36:39], s75 offen lds
  s_waitcnt lgkmcnt(7)
  v_mfma_f32_16x16x32_bf16 v[120:123], a[64:67], v[156:159], v[120:123]
  v_mfma_f32_16x16x32_bf16 v[124:127], a[68:71], v[156:159], v[124:127]
  ds_read_b128 v[188:191], v35 offset:28672
  s_waitcnt lgkmcnt(7)
  v_mfma_f32_16x16x32_bf16 v[64:67], a[72:75], v[160:163], v[64:67]
  v_mfma_f32_16x16x32_bf16 v[68:71], a[76:79], v[160:163], v[68:71]
  ds_read_b128 v[128:131], v36 offset:0
  s_waitcnt lgkmcnt(7)
  v_mfma_f32_16x16x32_bf16 v[72:75], a[72:75], v[164:167], v[72:75]
  v_mfma_f32_16x16x32_bf16 v[76:79], a[76:79], v[164:167], v[76:79]
  ds_read_b128 v[132:135], v36 offset:4096
  s_waitcnt lgkmcnt(7)
  v_mfma_f32_16x16x32_bf16 v[80:83], a[72:75], v[168:171], v[80:83]
  v_mfma_f32_16x16x32_bf16 v[84:87], a[76:79], v[168:171], v[84:87]
  ds_read_b128 v[136:139], v36 offset:8192
  s_add_u32 s75, s73, 20480
  s_add_u32 m0, s74, 4096
  s_nop 0
  buffer_load_dwordx4 v2, s[36:39], s75 offen lds
  s_waitcnt lgkmcnt(7)
  v_mfma_f32_16x16x32_bf16 v[88:91], a[72:75], v[172:175], v[88:91]
  v_mfma_f32_16x16x32_bf16 v[92:95], a[76:79], v[172:175], v[92:95]
  ds_read_b128 v[140:143], v36 offset:12288
  s_waitcnt lgkmcnt(7)
  v_mfma_f32_16x16x32_bf16 v[96:99], a[72:75], v[176:179], v[96:99]
  v_mfma_f32_16x16x32_bf16 v[100:103], a[76:79], v[176:179], v[100:103]
  ds_read_b128 v[144:147], v36 offset:16384
  s_waitcnt lgkmcnt(7)
  v_mfma_f32_16x16x32_bf16 v[104:107], a[72:75], v[180:183], v[104:107]
  v_mfma_f32_16x16x32_bf16 v[108:111], a[76:79], v[180:183], v[108:111]
  ds_read_b128 v[148:151], v36 offset:20480
  s_waitcnt lgkmcnt(7)
  v_mfma_f32_16x16x32_bf16 v[112:115], a[72:75], v[184:187], v[112:115]
  v_mfma_f32_16x16x32_bf16 v[116:119], a[76:79], v[184:187], v[116:119]
  ds_read_b128 v[152:155], v36 offset:24576
  s_add_u32 s75, s73, 20480
  s_add_u32 m0, s74, 5120
  s_nop 0
  buffer_load_dwordx4 v3, s[36:39], s75 offen lds
  s_waitcnt lgkmcnt(7)
  v_mfma_f32_16x16x32_bf16 v[120:123], a[72:75], v[188:191], v[120:123]
  v_mfma_f32_16x16x32_bf16 v[124:127], a[76:79], v[188:191], v[124:127]
  ds_read_b128 v[156:159], v36 offset:28672
  s_waitcnt lgkmcnt(7)
  v_mfma_f32_16x16x32_bf16 v[64:67], a[80:83], v[128:131], v[64:67]
  v_mfma_f32_16x16x32_bf16 v[68:71], a[84:87], v[128:131], v[68:71]
  ds_read_b128 v[160:163], v37 offset:0
  s_waitcnt lgkmcnt(7)
  v_mfma_f32_16x16x32_bf16 v[72:75], a[80:83], v[132:135], v[72:75]
  v_mfma_f32_16x16x32_bf16 v[76:79], a[84:87], v[132:135], v[76:79]
  ds_read_b128 v[164:167], v37 offset:4096
  s_waitcnt lgkmcnt(7)
  v_mfma_f32_16x16x32_bf16 v[80:83], a[80:83], v[136:139], v[80:83]
  v_mfma_f32_16x16x32_bf16 v[84:87], a[84:87], v[136:139], v[84:87]
  ds_read_b128 v[168:171], v37 offset:8192
  s_add_u32 s75, s73, 20480
  s_add_u32 m0, s74, 6144
  s_nop 0
  buffer_load_dwordx4 v4, s[36:39], s75 offen lds
  s_waitcnt lgkmcnt(7)
  v_mfma_f32_16x16x32_bf16 v[88:91], a[80:83], v[140:143], v[88:91]
  v_mfma_f32_16x16x32_bf16 v[92:95], a[84:87], v[140:143], v[92:95]
  ds_read_b128 v[172:175], v37 offset:12288
  s_waitcnt lgkmcnt(7)
  v_mfma_f32_16x16x32_bf16 v[96:99], a[80:83], v[144:147], v[96:99]
  v_mfma_f32_16x16x32_bf16 v[100:103], a[84:87], v[144:147], v[100:103]
  ds_read_b128 v[176:179], v37 offset:16384
  s_waitcnt lgkmcnt(7)
  v_mfma_f32_16x16x32_bf16 v[104:107], a[80:83], v[148:151], v[104:107]
  v_mfma_f32_16x16x32_bf16 v[108:111], a[84:87], v[148:151], v[108:111]
  ds_read_b128 v[180:183], v37 offset:20480
  s_waitcnt lgkmcnt(7)
  v_mfma_f32_16x16x32_bf16 v[112:115], a[80:83], v[152:155], v[112:115]
  v_mfma_f32_16x16x32_bf16 v[116:119], a[84:87], v[152:155], v[116:119]
  ds_read_b128 v[184:187], v37 offset:24576
  s_add_u32 s75, s73, 20480
  s_add_u32 m0, s74, 7168
  s_nop 0
  buffer_load_dwordx4 v5, s[36:39], s75 offen lds
  s_waitcnt lgkmcnt(7)
  v_mfma_f32_16x16x32_bf16 v[120:123], a[80:83], v[156:159], v[120:123]
  v_mfma_f32_16x16x32_bf16 v[124:127], a[84:87], v[156:159], v[124:127]
  ds_read_b128 v[188:191], v37 offset:28672
  s_waitcnt vmcnt(23)
  s_barrier
  s_mov_b64 exec, 1
  v_mov_b32 v20, s79
  buffer_store_dword v20, v21, s[32:35], 0 offen sc1
  s_mov_b64 exec, -1
  s_waitcnt lgkmcnt(7)
  v_mfma_f32_16x16x32_bf16 v[64:67], a[88:91], v[160:163], v[64:67]
  v_mfma_f32_16x16x32_bf16 v[68:71], a[92:95], v[160:163], v[68:71]
  ds_read_b128 v[128:131], v34 offset:32768
  s_waitcnt lgkmcnt(7)
  v_mfma_f32_16x16x32_bf16 v[72:75], a[88:91], v[164:167], v[72:75]
  v_mfma_f32_16x16x32_bf16 v[76:79], a[92:95], v[164:167], v[76:79]
  ds_read_b128 v[132:135], v34 offset:36864
  s_waitcnt lgkmcnt(7)
  v_mfma_f32_16x16x32_bf16 v[80:83], a[88:91], v[168:171], v[80:83]
  v_mfma_f32_16x16x32_bf16 v[84:87], a[92:95], v[168:171], v[84:87]
  ds_read_b128 v[136:139], v34 offset:40960
  s_add_u32 s75, s73, 256
  s_add_u32 m0, s74, 32768
  s_nop 0
  buffer_load_dwordx4 v2, s[36:39], s75 offen lds
  s_waitcnt lgkmcnt(7)
  v_mfma_f32_16x16x32_bf16 v[88:91], a[88:91], v[172:175], v[88:91]
  v_mfma_f32_16x16x32_bf16 v[92:95], a[92:95], v[172:175], v[92:95]
  ds_read_b128 v[140:143], v34 offset:45056
  s_waitcnt lgkmcnt(7)
  v_mfma_f32_16x16x32_bf16 v[96:99], a[88:91], v[176:179], v[96:99]
  v_mfma_f32_16x16x32_bf16 v[100:103], a[92:95], v[176:179], v[100:103]
  ds_read_b128 v[144:147], v34 offset:49152
  s_waitcnt lgkmcnt(7)
  v_mfma_f32_16x16x32_bf16 v[104:107], a[88:91], v[180:183], v[104:107]
  v_mfma_f32_16x16x32_bf16 v[108:111], a[92:95], v[180:183], v[108:111]
  ds_read_b128 v[148:151], v34 offset:53248
  s_waitcnt lgkmcnt(7)
  v_mfma_f32_16x16x32_bf16 v[112:115], a[88:91], v[184:187], v[112:115]
  v_mfma_f32_16x16x32_bf16 v[116:119], a[92:95], v[184:187], v[116:119]
  ds_read_b128 v[152:155], v34 offset:57344
  s_add_u32 s75, s73, 256
  s_add_u32 m0, s74, 33792
  s_nop 0
  buffer_load_dwordx4 v3, s[36:39], s75 offen lds
  s_waitcnt lgkmcnt(7)
  v_mfma_f32_16x16x32_bf16 v[120:123], a[88:91], v[188:191], v[120:123]
  v_mfma_f32_16x16x32_bf16 v[124:127], a[92:95], v[188:191], v[124:127]
  ds_read_b128 v[156:159], v34 offset:61440
  s_waitcnt lgkmcnt(7)
  v_mfma_f32_16x16x32_bf16 v[64:67], a[96:99], v[128:131], v[64:67]
  v_mfma_f32_16x16x32_bf16 v[68:71], a[100:103], v[128:131], v[68:71]
  ds_read_b128 v[160:163], v35 offset:32768
  s_waitcnt lgkmcnt(7)
  v_mfma_f32_16x16x32_bf16 v[72:75], a[96:99], v[132:135], v[72:75]
  v_mfma_f32_16x16x32_bf16 v[76:79], a[100:103], v[132:135], v[76:79]
  ds_read_b128 v[164:167], v35 offset:36864
  s_waitcnt lgkmcnt(7)
  v_mfma_f32_16x16x32_bf16 v[80:83], a[96:99], v[136:139], v[80:83]
  v_mfma_f32_16x16x32_bf16 v[84:87], a[100:103], v[136:139], v[84:87]
  ds_read_b128 v[168:171], v35 offset:40960
  s_add_u32 s75, s73, 256
  s_add_u32 m0, s74, 34816
  s_nop 0
  buffer_load_dwordx4 v4, s[36:39], s75 offen lds
  s_waitcnt lgkmcnt(7)
  v_mfma_f32_16x16x32_bf16 v[88:91], a[96:99], v[140:143], v[88:91]
  v_mfma_f32_16x16x32_bf16 v[92:95], a[100:103], v[140:143], v[92:95]
  ds_read_b128 v[172:175], v35 offset:45056
  s_waitcnt lgkmcnt(7)
  v_mfma_f32_16x16x32_bf16 v[96:99], a[96:99], v[144:147], v[96:99]
  v_mfma_f32_16x16x32_bf16 v[100:103], a[100:103], v[144:147], v[100:103]
  ds_read_b128 v[176:179], v35 offset:49152
  s_waitcnt lgkmcnt(7)
  v_mfma_f32_16x16x32_bf16 v[104:107], a[96:99], v[148:151], v[104:107]
  v_mfma_f32_16x16x32_bf16 v[108:111], a[100:103], v[148:151], v[108:111]
  ds_read_b128 v[180:183], v35 offset:53248
  s_waitcnt lgkmcnt(7)
  v_mfma_f32_16x16x32_bf16 v[112:115], a[96:99], v[152:155], v[112:115]
  v_mfma_f32_16x16x32_bf16 v[116:119], a[100:103], v[152:155], v[116:119]
  ds_read_b128 v[184:187], v35 offset:57344
  s_add_u32 s75, s73, 256
  s_add_u32 m0, s74, 35840
  s_nop 0
  buffer_load_dwordx4 v5, s[36:39], s75 offen lds
  s_waitcnt lgkmcnt(7)
  v_mfma_f32_16x16x32_bf16 v[120:123], a[96:99], v[156:159], v[120:123]
  v_mfma_f32_16x16x32_bf16 v[124:127], a[100:103], v[156:159], v[124:127]
  ds_read_b128 v[188:191], v35 offset:61440
  s_waitcnt lgkmcnt(7)
  v_mfma_f32_16x16x32_bf16 v[64:67], a[104:107], v[160:163], v[64:67]
  v_mfma_f32_16x16x32_bf16 v[68:71], a[108:111], v[160:163], v[68:71]
  ds_read_b128 v[128:131], v36 offset:32768
  s_waitcnt lgkmcnt(7)
  v_mfma_f32_16x16x32_bf16 v[72:75], a[104:107], v[164:167], v[72:75]
  v_mfma_f32_16x16x32_bf16 v[76:79], a[108:111], v[164:167], v[76:79]
  ds_read_b128 v[132:135], v36 offset:36864
  s_waitcnt lgkmcnt(7)
  v_mfma_f32_16x16x32_bf16 v[80:83], a[104:107], v[168:171], v[80:83]
  v_mfma_f32_16x16x32_bf16 v[84:87], a[108:111], v[168:171], v[84:87]
  ds_read_b128 v[136:139], v36 offset:40960
  s_add_u32 s75, s73, 20736
  s_add_u32 m0, s74, 36864
  s_nop 0
  buffer_load_dwordx4 v2, s[36:39], s75 offen lds
  s_waitcnt lgkmcnt(7)
  v_mfma_f32_16x16x32_bf16 v[88:91], a[104:107], v[172:175], v[88:91]
  v_mfma_f32_16x16x32_bf16 v[92:95], a[108:111], v[172:175], v[92:95]
  ds_read_b128 v[140:143], v36 offset:45056
  s_waitcnt lgkmcnt(7)
  v_mfma_f32_16x16x32_bf16 v[96:99], a[104:107], v[176:179], v[96:99]
  v_mfma_f32_16x16x32_bf16 v[100:103], a[108:111], v[176:179], v[100:103]
  ds_read_b128 v[144:147], v36 offset:49152
  s_waitcnt lgkmcnt(7)
  v_mfma_f32_16x16x32_bf16 v[104:107], a[104:107], v[180:183], v[104:107]
  v_mfma_f32_16x16x32_bf16 v[108:111], a[108:111], v[180:183], v[108:111]
  ds_read_b128 v[148:151], v36 offset:53248
  s_waitcnt lgkmcnt(7)
  v_mfma_f32_16x16x32_bf16 v[112:115], a[104:107], v[184:187], v[112:115]
  v_mfma_f32_16x16x32_bf16 v[116:119], a[108:111], v[184:187], v[116:119]
  ds_read_b128 v[152:155], v36 offset:57344
  s_add_u32 s75, s73, 20736
  s_add_u32 m0, s74, 37888
  s_nop 0
  buffer_load_dwordx4 v3, s[36:39], s75 offen lds
  s_waitcnt lgkmcnt(7)
  v_mfma_f32_16x16x32_bf16 v[120:123], a[104:107], v[188:191], v[120:123]
  v_mfma_f32_16x16x32_bf16 v[124:127], a[108:111], v[188:191], v[124:127]
  ds_read_b128 v[156:159], v36 offset:61440
  s_waitcnt lgkmcnt(7)
  v_mfma_f32_16x16x32_bf16 v[64:67], a[112:115], v[128:131], v[64:67]
  v_mfma_f32_16x16x32_bf16 v[68:71], a[116:119], v[128:131], v[68:71]
  ds_read_b128 v[160:163], v37 offset:32768
  s_waitcnt lgkmcnt(7)
  v_mfma_f32_16x16x32_bf16 v[72:75], a[112:115], v[132:135], v[72:75]
  v_mfma_f32_16x16x32_bf16 v[76:79], a[116:119], v[132:135], v[76:79]
  ds_read_b128 v[164:167], v37 offset:36864
  s_waitcnt lgkmcnt(7)
  v_mfma_f32_16x16x32_bf16 v[80:83], a[112:115], v[136:139], v[80:83]
  v_mfma_f32_16x16x32_bf16 v[84:87], a[116:119], v[136:139], v[84:87]
  ds_read_b128 v[168:171], v37 offset:40960
  s_add_u32 s75, s73, 20736
  s_add_u32 m0, s74, 38912
  s_nop 0
  buffer_load_dwordx4 v4, s[36:39], s75 offen lds
  s_waitcnt lgkmcnt(7)
  v_mfma_f32_16x16x32_bf16 v[88:91], a[112:115], v[140:143], v[88:91]
  v_mfma_f32_16x16x32_bf16 v[92:95], a[116:119], v[140:143], v[92:95]
  ds_read_b128 v[172:175], v37 offset:45056
  s_waitcnt lgkmcnt(7)
  v_mfma_f32_16x16x32_bf16 v[96:99], a[112:115], v[144:147], v[96:99]
  v_mfma_f32_16x16x32_bf16 v[100:103], a[116:119], v[144:147], v[100:103]
  ds_read_b128 v[176:179], v37 offset:49152
  s_waitcnt lgkmcnt(7)
  v_mfma_f32_16x16x32_bf16 v[104:107], a[112:115], v[148:151], v[104:107]
  v_mfma_f32_16x16x32_bf16 v[108:111], a[116:119], v[148:151], v[108:111]
  ds_read_b128 v[180:183], v37 offset:53248
  s_waitcnt lgkmcnt(7)
  v_mfma_f32_16x16x32_bf16 v[112:115], a[112:115], v[152:155], v[112:115]
  v_mfma_f32_16x16x32_bf16 v[116:119], a[116:119], v[152:155], v[116:119]
  ds_read_b128 v[184:187], v37 offset:57344
  s_add_u32 s75, s73, 20736
  s_add_u32 m0, s74, 39936
  s_nop 0
  buffer_load_dwordx4 v5, s[36:39], s75 offen lds
  s_waitcnt lgkmcnt(7)
  v_mfma_f32_16x16x32_bf16 v[120:123], a[112:115], v[156:159], v[120:123]
  v_mfma_f32_16x16x32_bf16 v[124:127], a[116:119], v[156:159], v[124:127]
  ds_read_b128 v[188:191], v37 offset:61440
  s_waitcnt vmcnt(16)
  s_barrier
  s_waitcnt lgkmcnt(7)
  v_mfma_f32_16x16x32_bf16 v[64:67], a[120:123], v[160:163], v[64:67]
  v_mfma_f32_16x16x32_bf16 v[68:71], a[124:127], v[160:163], v[68:71]
  ds_read_b128 v[128:131], v38 offset:0
  s_waitcnt lgkmcnt(7)
  v_mfma_f32_16x16x32_bf16 v[72:75], a[120:123], v[164:167], v[72:75]
  v_mfma_f32_16x16x32_bf16 v[76:79], a[124:127], v[164:167], v[76:79]
  ds_read_b128 v[132:135], v38 offset:4096
  s_waitcnt lgkmcnt(7)
  v_mfma_f32_16x16x32_bf16 v[80:83], a[120:123], v[168:171], v[80:83]
  v_mfma_f32_16x16x32_bf16 v[84:87], a[124:127], v[168:171], v[84:87]
  ds_read_b128 v[136:139], v38 offset:8192
  s_add_u32 s75, s73, 512
  s_add_u32 m0, s74, 65536
  s_nop 0
  buffer_load_dwordx4 v2, s[36:39], s75 offen lds
  s_waitcnt lgkmcnt(7)
  v_mfma_f32_16x16x32_bf16 v[88:91], a[120:123], v[172:175], v[88:91]
  v_mfma_f32_16x16x32_bf16 v[92:95], a[124:127], v[172:175], v[92:95]
  ds_read_b128 v[140:143], v38 offset:12288
  s_waitcnt lgkmcnt(7)
  v_mfma_f32_16x16x32_bf16 v[96:99], a[120:123], v[176:179], v[96:99]
  v_mfma_f32_16x16x32_bf16 v[100:103], a[124:127], v[176:179], v[100:103]
  ds_read_b128 v[144:147], v38 offset:16384
  s_waitcnt lgkmcnt(7)
  v_mfma_f32_16x16x32_bf16 v[104:107], a[120:123], v[180:183], v[104:107]
  v_mfma_f32_16x16x32_bf16 v[108:111], a[124:127], v[180:183], v[108:111]
  ds_read_b128 v[148:151], v38 offset:20480
  s_waitcnt lgkmcnt(7)
  v_mfma_f32_16x16x32_bf16 v[112:115], a[120:123], v[184:187], v[112:115]
  v_mfma_f32_16x16x32_bf16 v[116:119], a[124:127], v[184:187], v[116:119]
  ds_read_b128 v[152:155], v38 offset:24576
  s_add_u32 s75, s73, 512
  s_add_u32 m0, s74, 66560
  s_nop 0
  buffer_load_dwordx4 v3, s[36:39], s75 offen lds
  s_waitcnt lgkmcnt(7)
  v_mfma_f32_16x16x32_bf16 v[120:123], a[120:123], v[188:191], v[120:123]
  v_mfma_f32_16x16x32_bf16 v[124:127], a[124:127], v[188:191], v[124:127]
  ds_read_b128 v[156:159], v38 offset:28672
  s_waitcnt lgkmcnt(7)
  v_mfma_f32_16x16x32_bf16 v[64:67], a[128:131], v[128:131], v[64:67]
  v_mfma_f32_16x16x32_bf16 v[68:71], a[132:135], v[128:131], v[68:71]
  ds_read_b128 v[160:163], v39 offset:0
  s_waitcnt lgkmcnt(7)
  v_mfma_f32_16x16x32_bf16 v[72:75], a[128:131], v[132:135], v[72:75]
  v_mfma_f32_16x16x32_bf16 v[76:79], a[132:135], v[132:135], v[76:79]
  ds_read_b128 v[164:167], v39 offset:4096
  s_waitcnt lgkmcnt(7)
  v_mfma_f32_16x16x32_bf16 v[80:83], a[128:131], v[136:139], v[80:83]
  v_mfma_f32_16x16x32_bf16 v[84:87], a[132:135], v[136:139], v[84:87]
  ds_read_b128 v[168:171], v39 offset:8192
  s_add_u32 s75, s73, 512
  s_add_u32 m0, s74, 67584
  s_nop 0
  buffer_load_dwordx4 v4, s[36:39], s75 offen lds
  s_waitcnt lgkmcnt(7)
  v_mfma_f32_16x16x32_bf16 v[88:91], a[128:131], v[140:143], v[88:91]
  v_mfma_f32_16x16x32_bf16 v[92:95], a[132:135], v[140:143], v[92:95]
  ds_read_b128 v[172:175], v39 offset:12288
  s_waitcnt lgkmcnt(7)
  v_mfma_f32_16x16x32_bf16 v[96:99], a[128:131], v[144:147], v[96:99]
  v_mfma_f32_16x16x32_bf16 v[100:103], a[132:135], v[144:147], v[100:103]
  ds_read_b128 v[176:179], v39 offset:16384
  s_waitcnt lgkmcnt(7)
  v_mfma_f32_16x16x32_bf16 v[104:107], a[128:131], v[148:151], v[104:107]
  v_mfma_f32_16x16x32_bf16 v[108:111], a[132:135], v[148:151], v[108:111]
  ds_read_b128 v[180:183], v39 offset:20480
  s_waitcnt lgkmcnt(7)
  v_mfma_f32_16x16x32_bf16 v[112:115], a[128:131], v[152:155], v[112:115]
  v_mfma_f32_16x16x32_bf16 v[116:119], a[132:135], v[152:155], v[116:119]
  ds_read_b128 v[184:187], v39 offset:24576
  s_add_u32 s75, s73, 512
  s_add_u32 m0, s74, 68608
  s_nop 0
  buffer_load_dwordx4 v5, s[36:39], s75 offen lds
  s_waitcnt lgkmcnt(7)
  v_mfma_f32_16x16x32_bf16 v[120:123], a[128:131], v[156:159], v[120:123]
  v_mfma_f32_16x16x32_bf16 v[124:127], a[132:135], v[156:159], v[124:127]
  ds_read_b128 v[188:191], v39 offset:28672
  s_waitcnt lgkmcnt(7)
  v_mfma_f32_16x16x32_bf16 v[64:67], a[136:139], v[160:163], v[64:67]
  v_mfma_f32_16x16x32_bf16 v[68:71], a[140:143], v[160:163], v[68:71]
  ds_read_b128 v[128:131], v40 offset:0
  s_waitcnt lgkmcnt(7)
  v_mfma_f32_16x16x32_bf16 v[72:75], a[136:139], v[164:167], v[72:75]
  v_mfma_f32_16x16x32_bf16 v[76:79], a[140:143], v[164:167], v[76:79]
  ds_read_b128 v[132:135], v40 offset:4096
  s_waitcnt lgkmcnt(7)
  v_mfma_f32_16x16x32_bf16 v[80:83], a[136:139], v[168:171], v[80:83]
  v_mfma_f32_16x16x32_bf16 v[84:87], a[140:143], v[168:171], v[84:87]
  ds_read_b128 v[136:139], v40 offset:8192
  s_add_u32 s75, s73, 20992
  s_add_u32 m0, s74, 69632
  s_nop 0
  buffer_load_dwordx4 v2, s[36:39], s75 offen lds
  s_waitcnt lgkmcnt(7)
  v_mfma_f32_16x16x32_bf16 v[88:91], a[136:139], v[172:175], v[88:91]
  v_mfma_f32_16x16x32_bf16 v[92:95], a[140:143], v[172:175], v[92:95]
  ds_read_b128 v[140:143], v40 offset:12288
  s_waitcnt lgkmcnt(7)
  v_mfma_f32_16x16x32_bf16 v[96:99], a[136:139], v[176:179], v[96:99]
  v_mfma_f32_16x16x32_bf16 v[100:103], a[140:143], v[176:179], v[100:103]
  ds_read_b128 v[144:147], v40 offset:16384
  s_waitcnt lgkmcnt(7)
  v_mfma_f32_16x16x32_bf16 v[104:107], a[136:139], v[180:183], v[104:107]
  v_mfma_f32_16x16x32_bf16 v[108:111], a[140:143], v[180:183], v[108:111]
  ds_read_b128 v[148:151], v40 offset:20480
  s_waitcnt lgkmcnt(7)
  v_mfma_f32_16x16x32_bf16 v[112:115], a[136:139], v[184:187], v[112:115]
  v_mfma_f32_16x16x32_bf16 v[116:119], a[140:143], v[184:187], v[116:119]
  ds_read_b128 v[152:155], v40 offset:24576
  s_add_u32 s75, s73, 20992
  s_add_u32 m0, s74, 70656
  s_nop 0
  buffer_load_dwordx4 v3, s[36:39], s75 offen lds
  s_waitcnt lgkmcnt(7)
  v_mfma_f32_16x16x32_bf16 v[120:123], a[136:139], v[188:191], v[120:123]
  v_mfma_f32_16x16x32_bf16 v[124:127], a[140:143], v[188:191], v[124:127]
  ds_read_b128 v[156:159], v40 offset:28672
  s_waitcnt lgkmcnt(7)
  v_mfma_f32_16x16x32_bf16 v[64:67], a[144:147], v[128:131], v[64:67]
  v_mfma_f32_16x16x32_bf16 v[68:71], a[148:151], v[128:131], v[68:71]
  ds_read_b128 v[160:163], v41 offset:0
  s_waitcnt lgkmcnt(7)
  v_mfma_f32_16x16x32_bf16 v[72:75], a[144:147], v[132:135], v[72:75]
  v_mfma_f32_16x16x32_bf16 v[76:79], a[148:151], v[132:135], v[76:79]
  ds_read_b128 v[164:167], v41 offset:4096
  s_waitcnt lgkmcnt(7)
  v_mfma_f32_16x16x32_bf16 v[80:83], a[144:147], v[136:139], v[80:83]
  v_mfma_f32_16x16x32_bf16 v[84:87], a[148:151], v[136:139], v[84:87]
  ds_read_b128 v[168:171], v41 offset:8192
  s_add_u32 s75, s73, 20992
  s_add_u32 m0, s74, 71680
  s_nop 0
  buffer_load_dwordx4 v4, s[36:39], s75 offen lds
  s_waitcnt lgkmcnt(7)
  v_mfma_f32_16x16x32_bf16 v[88:91], a[144:147], v[140:143], v[88:91]
  v_mfma_f32_16x16x32_bf16 v[92:95], a[148:151], v[140:143], v[92:95]
  ds_read_b128 v[172:175], v41 offset:12288
  s_waitcnt lgkmcnt(7)
  v_mfma_f32_16x16x32_bf16 v[96:99], a[144:147], v[144:147], v[96:99]
  v_mfma_f32_16x16x32_bf16 v[100:103], a[148:151], v[144:147], v[100:103]
  ds_read_b128 v[176:179], v41 offset:16384
  s_waitcnt lgkmcnt(7)
  v_mfma_f32_16x16x32_bf16 v[104:107], a[144:147], v[148:151], v[104:107]
  v_mfma_f32_16x16x32_bf16 v[108:111], a[148:151], v[148:151], v[108:111]
  ds_read_b128 v[180:183], v41 offset:20480
  s_waitcnt lgkmcnt(7)
  v_mfma_f32_16x16x32_bf16 v[112:115], a[144:147], v[152:155], v[112:115]
  v_mfma_f32_16x16x32_bf16 v[116:119], a[148:151], v[152:155], v[116:119]
  ds_read_b128 v[184:187], v41 offset:24576
  s_add_u32 s75, s73, 20992
  s_add_u32 m0, s74, 72704
  s_nop 0
  buffer_load_dwordx4 v5, s[36:39], s75 offen lds
  s_waitcnt lgkmcnt(7)
  v_mfma_f32_16x16x32_bf16 v[120:123], a[144:147], v[156:159], v[120:123]
  v_mfma_f32_16x16x32_bf16 v[124:127], a[148:151], v[156:159], v[124:127]
  ds_read_b128 v[188:191], v41 offset:28672
  s_waitcnt vmcnt(16)
  s_barrier
  s_waitcnt lgkmcnt(7)
  v_mfma_f32_16x16x32_bf16 v[64:67], a[152:155], v[160:163], v[64:67]
  v_mfma_f32_16x16x32_bf16 v[68:71], a[156:159], v[160:163], v[68:71]
  ds_read_b128 v[128:131], v30 offset:0
  s_waitcnt lgkmcnt(7)
  v_mfma_f32_16x16x32_bf16 v[72:75], a[152:155], v[164:167], v[72:75]
  v_mfma_f32_16x16x32_bf16 v[76:79], a[156:159], v[164:167], v[76:79]
  ds_read_b128 v[132:135], v30 offset:4096
  s_waitcnt lgkmcnt(7)
  v_mfma_f32_16x16x32_bf16 v[80:83], a[152:155], v[168:171], v[80:83]
  v_mfma_f32_16x16x32_bf16 v[84:87], a[156:159], v[168:171], v[84:87]
  ds_read_b128 v[136:139], v30 offset:8192
  s_add_u32 s75, s73, 768
  s_add_u32 m0, s74, 98304
  s_nop 0
  buffer_load_dwordx4 v2, s[36:39], s75 offen lds
  s_waitcnt lgkmcnt(7)
  v_mfma_f32_16x16x32_bf16 v[88:91], a[152:155], v[172:175], v[88:91]
  v_mfma_f32_16x16x32_bf16 v[92:95], a[156:159], v[172:175], v[92:95]
  ds_read_b128 v[140:143], v30 offset:12288
  s_waitcnt lgkmcnt(7)
  v_mfma_f32_16x16x32_bf16 v[96:99], a[152:155], v[176:179], v[96:99]
  v_mfma_f32_16x16x32_bf16 v[100:103], a[156:159], v[176:179], v[100:103]
  ds_read_b128 v[144:147], v30 offset:16384
  s_waitcnt lgkmcnt(7)
  v_mfma_f32_16x16x32_bf16 v[104:107], a[152:155], v[180:183], v[104:107]
  v_mfma_f32_16x16x32_bf16 v[108:111], a[156:159], v[180:183], v[108:111]
  ds_read_b128 v[148:151], v30 offset:20480
  s_waitcnt lgkmcnt(7)
  v_mfma_f32_16x16x32_bf16 v[112:115], a[152:155], v[184:187], v[112:115]
  v_mfma_f32_16x16x32_bf16 v[116:119], a[156:159], v[184:187], v[116:119]
  ds_read_b128 v[152:155], v30 offset:24576
  s_add_u32 s75, s73, 768
  s_add_u32 m0, s74, 99328
  s_nop 0
  buffer_load_dwordx4 v3, s[36:39], s75 offen lds
  s_waitcnt lgkmcnt(7)
  v_mfma_f32_16x16x32_bf16 v[120:123], a[152:155], v[188:191], v[120:123]
  v_mfma_f32_16x16x32_bf16 v[124:127], a[156:159], v[188:191], v[124:127]
  ds_read_b128 v[156:159], v30 offset:28672
  v_cvt_pk_bf16_f32 v192, v64, v65
  v_cvt_pk_bf16_f32 v193, v66, v67
  v_cvt_pk_bf16_f32 v194, v68, v69
  v_cvt_pk_bf16_f32 v195, v70, v71
  v_and_b32 v194, v19, v194
  v_and_b32 v195, v19, v195
  s_mov_b32 s75, s65
  buffer_store_dwordx4 v[192:195], v18, s[44:47], s75 offen sc1
  v_cvt_pk_bf16_f32 v196, v72, v73
  v_cvt_pk_bf16_f32 v197, v74, v75
  v_cvt_pk_bf16_f32 v198, v76, v77
  v_cvt_pk_bf16_f32 v199, v78, v79
  v_and_b32 v198, v19, v198
  v_and_b32 v199, v19, v199
  s_add_u32 s75, s65, s67
  s_add_u32 s65, s65, s66
  buffer_store_dwordx4 v[196:199], v18, s[44:47], s75 offen sc1
  v_cvt_pk_bf16_f32 v200, v80, v81
  v_cvt_pk_bf16_f32 v201, v82, v83
  v_cvt_pk_bf16_f32 v202, v84, v85
  v_cvt_pk_bf16_f32 v203, v86, v87
  v_and_b32 v202, v19, v202
  v_and_b32 v203, v19, v203
  s_mov_b32 s75, s65
  buffer_store_dwordx4 v[200:203], v18, s[44:47], s75 offen sc1
  v_cvt_pk_bf16_f32 v204, v88, v89
  v_cvt_pk_bf16_f32 v205, v90, v91
  v_cvt_pk_bf16_f32 v206, v92, v93
  v_cvt_pk_bf16_f32 v207, v94, v95
  v_and_b32 v206, v19, v206
  v_and_b32 v207, v19, v207
  s_add_u32 s75, s65, s67
  s_add_u32 s65, s65, s66
  buffer_store_dwordx4 v[204:207], v18, s[44:47], s75 offen sc1
  v_cvt_pk_bf16_f32 v192, v96, v97
  v_cvt_pk_bf16_f32 v193, v98, v99
  v_cvt_pk_bf16_f32 v194, v100, v101
  v_cvt_pk_bf16_f32 v195, v102, v103
  v_and_b32 v194, v19, v194
  v_and_b32 v195, v19, v195
  s_mov_b32 s75, s65
  buffer_store_dwordx4 v[192:195], v18, s[44:47], s75 offen sc1
  v_cvt_pk_bf16_f32 v196, v104, v105
  v_cvt_pk_bf16_f32 v197, v106, v107
  v_cvt_pk_bf16_f32 v198, v108, v109
  v_cvt_pk_bf16_f32 v199, v110, v111
  v_and_b32 v198, v19, v198
  v_and_b32 v199, v19, v199
  s_add_u32 s75, s65, s67
  s_add_u32 s65, s65, s66
  buffer_store_dwordx4 v[196:199], v18, s[44:47], s75 offen sc1
  v_cvt_pk_bf16_f32 v200, v112, v113
  v_cvt_pk_bf16_f32 v201, v114, v115
  v_cvt_pk_bf16_f32 v202, v116, v117
  v_cvt_pk_bf16_f32 v203, v118, v119
  v_and_b32 v202, v19, v202
  v_and_b32 v203, v19, v203
  s_mov_b32 s75, s65
  buffer_store_dwordx4 v[200:203], v18, s[44:47], s75 offen sc1
  v_cvt_pk_bf16_f32 v204, v120, v121
  v_cvt_pk_bf16_f32 v205, v122, v123
  v_cvt_pk_bf16_f32 v206, v124, v125
  v_cvt_pk_bf16_f32 v207, v126, v127
  v_and_b32 v206, v19, v206
  v_and_b32 v207, v19, v207
  s_add_u32 s75, s65, s67
  s_add_u32 s65, s65, s66
  buffer_store_dwordx4 v[204:207], v18, s[44:47], s75 offen sc1
  s_mov_b32 s72, s73
  s_add_u32 s73, s73, 163840
  s_add_u32 s79, s79, 1
  s_cmp_lt_u32 s79, s69
  s_cbranch_scc1 PWL_1
  s_waitcnt vmcnt(0) lgkmcnt(0)
  s_barrier
  s_mov_b64 exec, 1
  v_mov_b32 v20, s79
  buffer_store_dword v20, v21, s[32:35], 0 offen sc1
  s_mov_b64 exec, -1
  s_branch L_pwTdone
L_pwN:
  s_waitcnt vmcnt(16)
  s_waitcnt vmcnt(8)
  s_barrier
  v_add_u32 v44, 65536, v8
  v_add_u32 v45, 65536, v9
  ds_read_b64_tr_b16 a[0:1], v44 offset:0
  ds_read_b64_tr_b16 a[2:3], v44 offset:1024
  ds_read_b64_tr_b16 a[4:5], v45 offset:0
  ds_read_b64_tr_b16 a[6:7], v45 offset:1024
  ds_read_b64_tr_b16 a[8:9], v44 offset:8192
  ds_read_b64_tr_b16 a[10:11], v44 offset:9216
  ds_read_b64_tr_b16 a[12:13], v45 offset:8192
  ds_read_b64_tr_b16 a[14:15], v45 offset:9216
  ds_read_b64_tr_b16 a[16:17], v44 offset:16384
  ds_read_b64_tr_b16 a[18:19], v44 offset:17408
  ds_read_b64_tr_b16 a[20:21], v45 offset:16384
  ds_read_b64_tr_b16 a[22:23], v45 offset:17408
  ds_read_b64_tr_b16 a[24:25], v44 offset:24576
  ds_read_b64_tr_b16 a[26:27], v44 offset:25600
  ds_read_b64_tr_b16 a[28:29], v45 offset:24576
  ds_read_b64_tr_b16 a[30:31], v45 offset:25600
  s_waitcnt lgkmcnt(0)
  ds_read_b128 v[128:131], v30 offset:0
  ds_read_b128 v[132:135], v30 offset:4096
  ds_read_b128 v[136:139], v30 offset:8192
  ds_read_b128 v[140:143], v30 offset:12288
  ds_read_b128 v[144:147], v30 offset:16384
  ds_read_b128 v[148:151], v30 offset:20480
  ds_read_b128 v[152:155], v30 offset:24576
  ds_read_b128 v[156:159], v30 offset:28672
  s_waitcnt lgkmcnt(7)
  v_mfma_f32_16x16x32_bf16 v[64:67], v[128:131], a[0:3], 0
  v_mfma_f32_16x16x32_bf16 v[68:71], v[128:131], a[4:7], 0
  ds_read_b128 v[160:163], v31 offset:0
  s_waitcnt lgkmcnt(7)
  v_mfma_f32_16x16x32_bf16 v[72:75], v[132:135], a[0:3], 0
  v_mfma_f32_16x16x32_bf16 v[76:79], v[132:135], a[4:7], 0
  ds_read_b128 v[164:167], v31 offset:4096
  s_add_u32 s75, s72, 256
  s_add_u32 m0, s74, 32768
  s_nop 0
  buffer_load_dwordx4 v2, s[36:39], s75 offen lds
  s_waitcnt lgkmcnt(7)
  v_mfma_f32_16x16x32_bf16 v[80:83], v[136:139], a[0:3], 0
  v_mfma_f32_16x16x32_bf16 v[84:87], v[136:139], a[4:7], 0
  ds_read_b128 v[168:171], v31 offset:8192
  s_waitcnt lgkmcnt(7)
  v_mfma_f32_16x16x32_bf16 v[88:91], v[140:143], a[0:3], 0
  v_mfma_f32_16x16x32_bf16 v[92:95], v[140:143], a[4:7], 0
  ds_read_b128 v[172:175], v31 offset:12288
  s_add_u32 s75, s72, 256
  s_add_u32 m0, s74, 33792
  s_nop 0
  buffer_load_dwordx4 v3, s[36:39], s75 offen lds
  s_waitcnt lgkmcnt(7)
  v_mfma_f32_16x16x32_bf16 v[96:99], v[144:147], a[0:3], 0
  v_mfma_f32_16x16x32_bf16 v[100:103], v[144:147], a[4:7], 0
  ds_read_b128 v[176:179], v31 offset:16384
  s_waitcnt lgkmcnt(7)
  v_mfma_f32_16x16x32_bf16 v[104:107], v[148:151], a[0:3], 0
  v_mfma_f32_16x16x32_bf16 v[108:111], v[148:151], a[4:7], 0
  ds_read_b128 v[180:183], v31 offset:20480
  s_add_u32 s75, s72, 256
  s_add_u32 m0, s74, 34816
  s_nop 0
  buffer_load_dwordx4 v4, s[36:39], s75 offen lds
  s_waitcnt lgkmcnt(7)
  v_mfma_f32_16x16x32_bf16 v[112:115], v[152:155], a[0:3], 0
  v_mfma_f32_16x16x32_bf16 v[116:119], v[152:155], a[4:7], 0
  ds_read_b128 v[184:187], v31 offset:24576
  s_waitcnt lgkmcnt(7)
  v_mfma_f32_16x16x32_bf16 v[120:123], v[156:159], a[0:3], 0
  v_mfma_f32_16x16x32_bf16 v[124:127], v[156:159], a[4:7], 0
  ds_read_b128 v[188:191], v31 offset:28672
  s_add_u32 s75, s72, 256
  s_add_u32 m0, s74, 35840
  s_nop 0
  buffer_load_dwordx4 v5, s[36:39], s75 offen lds
  s_waitcnt lgkmcnt(7)
  v_mfma_f32_16x16x32_bf16 v[64:67], v[160:163], a[8:11], v[64:67]
  v_mfma_f32_16x16x32_bf16 v[68:71], v[160:163], a[12:15], v[68:71]
  ds_read_b128 v[128:131], v32 offset:0
  s_waitcnt lgkmcnt(7)
  v_mfma_f32_16x16x32_bf16 v[72:75], v[164:167], a[8:11], v[72:75]
  v_mfma_f32_16x16x32_bf16 v[76:79], v[164:167], a[12:15], v[76:79]
  ds_read_b128 v[132:135], v32 offset:4096
  s_add_u32 s75, s72, 20736
  s_add_u32 m0, s74, 36864
  s_nop 0
  buffer_load_dwordx4 v2, s[36:39], s75 offen lds
  s_waitcnt lgkmcnt(7)
  v_mfma_f32_16x16x32_bf16 v[80:83], v[168:171], a[8:11], v[80:83]
  v_mfma_f32_16x16x32_bf16 v[84:87], v[168:171], a[12:15], v[84:87]
  ds_read_b128 v[136:139], v32 offset:8192
  s_waitcnt lgkmcnt(7)
  v_mfma_f32_16x16x32_bf16 v[88:91], v[172:175], a[8:11], v[88:91]
  v_mfma_f32_16x16x32_bf16 v[92:95], v[172:175], a[12:15], v[92:95]
  ds_read_b128 v[140:143], v32 offset:12288
  s_add_u32 s75, s72, 20736
  s_add_u32 m0, s74, 37888
  s_nop 0
  buffer_load_dwordx4 v3, s[36:39], s75 offen lds
  s_waitcnt lgkmcnt(7)
  v_mfma_f32_16x16x32_bf16 v[96:99], v[176:179], a[8:11], v[96:99]
  v_mfma_f32_16x16x32_bf16 v[100:103], v[176:179], a[12:15], v[100:103]
  ds_read_b128 v[144:147], v32 offset:16384
  s_waitcnt lgkmcnt(7)
  v_mfma_f32_16x16x32_bf16 v[104:107], v[180:183], a[8:11], v[104:107]
  v_mfma_f32_16x16x32_bf16 v[108:111], v[180:183], a[12:15], v[108:111]
  ds_read_b128 v[148:151], v32 offset:20480
  s_add_u32 s75, s72, 20736
  s_add_u32 m0, s74, 38912
  s_nop 0
  buffer_load_dwordx4 v4, s[36:39], s75 offen lds
  s_waitcnt lgkmcnt(7)
  v_mfma_f32_16x16x32_bf16 v[112:115], v[184:187], a[8:11], v[112:115]
  v_mfma_f32_16x16x32_bf16 v[116:119], v[184:187], a[12:15], v[116:119]
  ds_read_b128 v[152:155], v32 offset:24576
  s_waitcnt lgkmcnt(7)
  v_mfma_f32_16x16x32_bf16 v[120:123], v[188:191], a[8:11], v[120:123]
  v_mfma_f32_16x16x32_bf16 v[124:127], v[188:191], a[12:15], v[124:127]
  ds_read_b128 v[156:159], v32 offset:28672
  s_add_u32 s75, s72, 20736
  s_add_u32 m0, s74, 39936
  s_nop 0
  buffer_load_dwordx4 v5, s[36:39], s75 offen lds
  s_waitcnt lgkmcnt(7)
  v_mfma_f32_16x16x32_bf16 v[64:67], v[128:131], a[16:19], v[64:67]
  v_mfma_f32_16x16x32_bf16 v[68:71], v[128:131], a[20:23], v[68:71]
  ds_read_b128 v[160:163], v33 offset:0
  s_waitcnt lgkmcnt(7)
  v_mfma_f32_16x16x32_bf16 v[72:75], v[132:135], a[16:19], v[72:75]
  v_mfma_f32_16x16x32_bf16 v[76:79], v[132:135], a[20:23], v[76:79]
  ds_read_b128 v[164:167], v33 offset:4096
  s_add_u32 m0, s74, 131072
  s_nop 0
  buffer_load_dwordx4 v6, s[40:43], s76 offen  lds
  s_add_u32 s76, s76, s77
  s_waitcnt lgkmcnt(7)
  v_mfma_f32_16x16x32_bf16 v[80:83], v[136:139], a[16:19], v[80:83]
  v_mfma_f32_16x16x32_bf16 v[84:87], v[136:139], a[20:23], v[84:87]
  ds_read_b128 v[168:171], v33 offset:8192
  s_waitcnt lgkmcnt(7)
  v_mfma_f32_16x16x32_bf16 v[88:91], v[140:143], a[16:19], v[88:91]
  v_mfma_f32_16x16x32_bf16 v[92:95], v[140:143], a[20:23], v[92:95]
  ds_read_b128 v[172:175], v33 offset:12288
  s_add_u32 m0, s74, 132096
  s_nop 0
  buffer_load_dwordx4 v6, s[40:43], s76 offen  lds
  s_add_u32 s76, s76, s77
  s_waitcnt lgkmcnt(7)
  v_mfma_f32_16x16x32_bf16 v[96:99], v[144:147], a[16:19], v[96:99]
  v_mfma_f32_16x16x32_bf16 v[100:103], v[144:147], a[20:23], v[100:103]
  ds_read_b128 v[176:179], v33 offset:16384
  s_waitcnt lgkmcnt(7)
  v_mfma_f32_16x16x32_bf16 v[104:107], v[148:151], a[16:19], v[104:107]
  v_mfma_f32_16x16x32_bf16 v[108:111], v[148:151], a[20:23], v[108:111]
  ds_read_b128 v[180:183], v33 offset:20480
  s_add_u32 m0, s74, 133120
  s_nop 0
  buffer_load_dwordx4 v7, s[40:43], s76 offen  lds
  s_add_u32 s76, s76, s77
  s_waitcnt lgkmcnt(7)
  v_mfma_f32_16x16x32_bf16 v[112:115], v[152:155], a[16:19], v[112:115]
  v_mfma_f32_16x16x32_bf16 v[116:119], v[152:155], a[20:23], v[116:119]
  ds_read_b128 v[184:187], v33 offset:24576
  s_waitcnt lgkmcnt(7)
  v_mfma_f32_16x16x32_bf16 v[120:123], v[156:159], a[16:19], v[120:123]
  v_mfma_f32_16x16x32_bf16 v[124:127], v[156:159], a[20:23], v[124:127]
  ds_read_b128 v[188:191], v33 offset:28672
  s_add_u32 m0, s74, 134144
  s_nop 0
  buffer_load_dwordx4 v7, s[40:43], s76 offen  lds
  s_add_u32 s76, s76, s77
  s_waitcnt lgkmcnt(7)
  v_mfma_f32_16x16x32_bf16 v[64:67], v[160:163], a[24:27], v[64:67]
  v_mfma_f32_16x16x32_bf16 v[68:71], v[160:163], a[28:31], v[68:71]
  s_waitcnt lgkmcnt(6)
  v_mfma_f32_16x16x32_bf16 v[72:75], v[164:167], a[24:27], v[72:75]
  v_mfma_f32_16x16x32_bf16 v[76:79], v[164:167], a[28:31], v[76:79]
  s_add_u32 m0, s74, 135168
  s_nop 0
  buffer_load_dwordx4 v6, s[40:43], s76 offen  lds
  s_add_u32 s76, s76, s77
  s_waitcnt lgkmcnt(5)
  v_mfma_f32_16x16x32_bf16 v[80:83], v[168:171], a[24:27], v[80:83]
  v_mfma_f32_16x16x32_bf16 v[84:87], v[168:171], a[28:31], v[84:87]
  s_waitcnt lgkmcnt(4)
  v_mfma_f32_16x16x32_bf16 v[88:91], v[172:175], a[24:27], v[88:91]
  v_mfma_f32_16x16x32_bf16 v[92:95], v[172:175], a[28:31], v[92:95]
  s_add_u32 m0, s74, 136192
  s_nop 0
  buffer_load_dwordx4 v6, s[40:43], s76 offen  lds
  s_add_u32 s76, s76, s77
  s_waitcnt lgkmcnt(3)
  v_mfma_f32_16x16x32_bf16 v[96:99], v[176:179], a[24:27], v[96:99]
  v_mfma_f32_16x16x32_bf16 v[100:103], v[176:179], a[28:31], v[100:103]
  s_waitcnt lgkmcnt(2)
  v_mfma_f32_16x16x32_bf16 v[104:107], v[180:183], a[24:27], v[104:107]
  v_mfma_f32_16x16x32_bf16 v[108:111], v[180:183], a[28:31], v[108:111]
  s_add_u32 m0, s74, 137216
  s_nop 0
  buffer_load_dwordx4 v7, s[40:43], s76 offen  lds
  s_add_u32 s76, s76, s77
  s_waitcnt lgkmcnt(1)
  v_mfma_f32_16x16x32_bf16 v[112:115], v[184:187], a[24:27], v[112:115]
  v_mfma_f32_16x16x32_bf16 v[116:119], v[184:187], a[28:31], v[116:119]
  s_waitcnt lgkmcnt(0)
  v_mfma_f32_16x16x32_bf16 v[120:123], v[188:191], a[24:27], v[120:123]
  v_mfma_f32_16x16x32_bf16 v[124:127], v[188:191], a[28:31], v[124:127]
  s_add_u32 m0, s74, 138240
  s_nop 0
  buffer_load_dwordx4 v7, s[40:43], s76 offen  lds
  s_add_u32 s76, s76, s77
  s_add_u32 s76, s76, s78
  s_waitcnt vmcnt(16)
  s_waitcnt vmcnt(8)
  s_barrier
  v_add_u32 v44, 98304, v8
  v_add_u32 v45, 98304, v9
  ds_read_b64_tr_b16 a[32:33], v44 offset:0
  ds_read_b64_tr_b16 a[34:35], v44 offset:1024
  ds_read_b64_tr_b16 a[36:37], v45 offset:0
  ds_read_b64_tr_b16 a[38:39], v45 offset:1024
  ds_read_b64_tr_b16 a[40:41], v44 offset:8192
  ds_read_b64_tr_b16 a[42:43], v44 offset:9216
  ds_read_b64_tr_b16 a[44:45], v45 offset:8192
  ds_read_b64_tr_b16 a[46:47], v45 offset:9216
  ds_read_b64_tr_b16 a[48:49], v44 offset:16384
  ds_read_b64_tr_b16 a[50:51], v44 offset:17408
  ds_read_b64_tr_b16 a[52:53], v45 offset:16384
  ds_read_b64_tr_b16 a[54:55], v45 offset:17408
  ds_read_b64_tr_b16 a[56:57], v44 offset:24576
  ds_read_b64_tr_b16 a[58:59], v44 offset:25600
  ds_read_b64_tr_b16 a[60:61], v45 offset:24576
  ds_read_b64_tr_b16 a[62:63], v45 offset:25600
  s_waitcnt lgkmcnt(0)
  ds_read_b128 v[128:131], v30 offset:32768
  ds_read_b128 v[132:135], v30 offset:36864
  ds_read_b128 v[136:139], v30 offset:40960
  ds_read_b128 v[140:143], v30 offset:45056
  ds_read_b128 v[144:147], v30 offset:49152
  ds_read_b128 v[148:151], v30 offset:53248
  ds_read_b128 v[152:155], v30 offset:57344
  ds_read_b128 v[156:159], v30 offset:61440
  s_waitcnt lgkmcnt(7)
  v_mfma_f32_16x16x32_bf16 v[64:67], v[128:131], a[32:35], v[64:67]
  v_mfma_f32_16x16x32_bf16 v[68:71], v[128:131], a[36:39], v[68:71]
  ds_read_b128 v[160:163], v31 offset:32768
  s_waitcnt lgkmcnt(7)
  v_mfma_f32_16x16x32_bf16 v[72:75], v[132:135], a[32:35], v[72:75]
  v_mfma_f32_16x16x32_bf16 v[76:79], v[132:135], a[36:39], v[76:79]
  ds_read_b128 v[164:167], v31 offset:36864
  s_add_u32 s75, s72, 512
  s_add_u32 m0, s74, 0
  s_nop 0
  buffer_load_dwordx4 v2, s[36:39], s75 offen lds
  s_waitcnt lgkmcnt(7)
  v_mfma_f32_16x16x32_bf16 v[80:83], v[136:139], a[32:35], v[80:83]
  v_mfma_f32_16x16x32_bf16 v[84:87], v[136:139], a[36:39], v[84:87]
  ds_read_b128 v[168:171], v31 offset:40960
  s_waitcnt lgkmcnt(7)
  v_mfma_f32_16x16x32_bf16 v[88:91], v[140:143], a[32:35], v[88:91]
  v_mfma_f32_16x16x32_bf16 v[92:95], v[140:143], a[36:39], v[92:95]
  ds_read_b128 v[172:175], v31 offset:45056
  s_add_u32 s75, s72, 512
  s_add_u32 m0, s74, 1024
  s_nop 0
  buffer_load_dwordx4 v3, s[36:39], s75 offen lds
  s_waitcnt lgkmcnt(7)
  v_mfma_f32_16x16x32_bf16 v[96:99], v[144:147], a[32:35], v[96:99]
  v_mfma_f32_16x16x32_bf16 v[100:103], v[144:147], a[36:39], v[100:103]
  ds_read_b128 v[176:179], v31 offset:49152
  s_waitcnt lgkmcnt(7)
  v_mfma_f32_16x16x32_bf16 v[104:107], v[148:151], a[32:35], v[104:107]
  v_mfma_f32_16x16x32_bf16 v[108:111], v[148:151], a[36:39], v[108:111]
  ds_read_b128 v[180:183], v31 offset:53248
  s_add_u32 s75, s72, 512
  s_add_u32 m0, s74, 2048
  s_nop 0
  buffer_load_dwordx4 v4, s[36:39], s75 offen lds
  s_waitcnt lgkmcnt(7)
  v_mfma_f32_16x16x32_bf16 v[112:115], v[152:155], a[32:35], v[112:115]
  v_mfma_f32_16x16x32_bf16 v[116:119], v[152:155], a[36:39], v[116:119]
  ds_read_b128 v[184:187], v31 offset:57344
  s_waitcnt lgkmcnt(7)
  v_mfma_f32_16x16x32_bf16 v[120:123], v[156:159], a[32:35], v[120:123]
  v_mfma_f32_16x16x32_bf16 v[124:127], v[156:159], a[36:39], v[124:127]
  ds_read_b128 v[188:191], v31 offset:61440
  s_add_u32 s75, s72, 512
  s_add_u32 m0, s74, 3072
  s_nop 0
  buffer_load_dwordx4 v5, s[36:39], s75 offen lds
  s_waitcnt lgkmcnt(7)
  v_mfma_f32_16x16x32_bf16 v[64:67], v[160:163], a[40:43], v[64:67]
  v_mfma_f32_16x16x32_bf16 v[68:71], v[160:163], a[44:47], v[68:71]
  ds_read_b128 v[128:131], v32 offset:32768
  s_waitcnt lgkmcnt(7)
  v_mfma_f32_16x16x32_bf16 v[72:75], v[164:167], a[40:43], v[72:75]
  v_mfma_f32_16x16x32_bf16 v[76:79], v[164:167], a[44:47], v[76:79]
  ds_read_b128 v[132:135], v32 offset:36864
  s_add_u32 s75, s72, 20992
  s_add_u32 m0, s74, 4096
  s_nop 0
  buffer_load_dwordx4 v2, s[36:39], s75 offen lds
  s_waitcnt lgkmcnt(7)
  v_mfma_f32_16x16x32_bf16 v[80:83], v[168:171], a[40:43], v[80:83]
  v_mfma_f32_16x16x32_bf16 v[84:87], v[168:171], a[44:47], v[84:87]
  ds_read_b128 v[136:139], v32 offset:40960
  s_waitcnt lgkmcnt(7)
  v_mfma_f32_16x16x32_bf16 v[88:91], v[172:175], a[40:43], v[88:91]
  v_mfma_f32_16x16x32_bf16 v[92:95], v[172:175], a[44:47], v[92:95]
  ds_read_b128 v[140:143], v32 offset:45056
  s_add_u32 s75, s72, 20992
  s_add_u32 m0, s74, 5120
  s_nop 0
  buffer_load_dwordx4 v3, s[36:39], s75 offen lds
  s_waitcnt lgkmcnt(7)
  v_mfma_f32_16x16x32_bf16 v[96:99], v[176:179], a[40:43], v[96:99]
  v_mfma_f32_16x16x32_bf16 v[100:103], v[176:179], a[44:47], v[100:103]
  ds_read_b128 v[144:147], v32 offset:49152
  s_waitcnt lgkmcnt(7)
  v_mfma_f32_16x16x32_bf16 v[104:107], v[180:183], a[40:43], v[104:107]
  v_mfma_f32_16x16x32_bf16 v[108:111], v[180:183], a[44:47], v[108:111]
  ds_read_b128 v[148:151], v32 offset:53248
  s_add_u32 s75, s72, 20992
  s_add_u32 m0, s74, 6144
  s_nop 0
  buffer_load_dwordx4 v4, s[36:39], s75 offen lds
  s_waitcnt lgkmcnt(7)
  v_mfma_f32_16x16x32_bf16 v[112:115], v[184:187], a[40:43], v[112:115]
  v_mfma_f32_16x16x32_bf16 v[116:119], v[184:187], a[44:47], v[116:119]
  ds_read_b128 v[152:155], v32 offset:57344
  s_waitcnt lgkmcnt(7)
  v_mfma_f32_16x16x32_bf16 v[120:123], v[188:191], a[40:43], v[120:123]
  v_mfma_f32_16x16x32_bf16 v[124:127], v[188:191], a[44:47], v[124:127]
  ds_read_b128 v[156:159], v32 offset:61440
  s_add_u32 s75, s72, 20992
  s_add_u32 m0, s74, 7168
  s_nop 0
  buffer_load_dwordx4 v5, s[36:39], s75 offen lds
  s_waitcnt lgkmcnt(7)
  v_mfma_f32_16x16x32_bf16 v[64:67], v[128:131], a[48:51], v[64:67]
  v_mfma_f32_16x16x32_bf16 v[68:71], v[128:131], a[52:55], v[68:71]
  ds_read_b128 v[160:163], v33 offset:32768
  s_waitcnt lgkmcnt(7)
  v_mfma_f32_16x16x32_bf16 v[72:75], v[132:135], a[48:51], v[72:75]
  v_mfma_f32_16x16x32_bf16 v[76:79], v[132:135], a[52:55], v[76:79]
  ds_read_b128 v[164:167], v33 offset:36864
  s_add_u32 m0, s74, 65536
  s_nop 0
  buffer_load_dwordx4 v6, s[40:43], s76 offen  lds
  s_add_u32 s76, s76, s77
  s_waitcnt lgkmcnt(7)
  v_mfma_f32_16x16x32_bf16 v[80:83], v[136:139], a[48:51], v[80:83]
  v_mfma_f32_16x16x32_bf16 v[84:87], v[136:139], a[52:55], v[84:87]
  ds_read_b128 v[168:171], v33 offset:40960
  s_waitcnt lgkmcnt(7)
  v_mfma_f32_16x16x32_bf16 v[88:91], v[140:143], a[48:51], v[88:91]
  v_mfma_f32_16x16x32_bf16 v[92:95], v[140:143], a[52:55], v[92:95]
  ds_read_b128 v[172:175], v33 offset:45056
  s_add_u32 m0, s74, 66560
  s_nop 0
  buffer_load_dwordx4 v6, s[40:43], s76 offen  lds
  s_add_u32 s76, s76, s77
  s_waitcnt lgkmcnt(7)
  v_mfma_f32_16x16x32_bf16 v[96:99], v[144:147], a[48:51], v[96:99]
  v_mfma_f32_16x16x32_bf16 v[100:103], v[144:147], a[52:55], v[100:103]
  ds_read_b128 v[176:179], v33 offset:49152
  s_waitcnt lgkmcnt(7)
  v_mfma_f32_16x16x32_bf16 v[104:107], v[148:151], a[48:51], v[104:107]
  v_mfma_f32_16x16x32_bf16 v[108:111], v[148:151], a[52:55], v[108:111]
  ds_read_b128 v[180:183], v33 offset:53248
  s_add_u32 m0, s74, 67584
  s_nop 0
  buffer_load_dwordx4 v7, s[40:43], s76 offen  lds
  s_add_u32 s76, s76, s77
  s_waitcnt lgkmcnt(7)
  v_mfma_f32_16x16x32_bf16 v[112:115], v[152:155], a[48:51], v[112:115]
  v_mfma_f32_16x16x32_bf16 v[116:119], v[152:155], a[52:55], v[116:119]
  ds_read_b128 v[184:187], v33 offset:57344
  s_waitcnt lgkmcnt(7)
  v_mfma_f32_16x16x32_bf16 v[120:123], v[156:159], a[48:51], v[120:123]
  v_mfma_f32_16x16x32_bf16 v[124:127], v[156:159], a[52:55], v[124:127]
  ds_read_b128 v[188:191], v33 offset:61440
  s_add_u32 m0, s74, 68608
  s_nop 0
  buffer_load_dwordx4 v7, s[40:43], s76 offen  lds
  s_add_u32 s76, s76, s77
  s_waitcnt lgkmcnt(7)
  v_mfma_f32_16x16x32_bf16 v[64:67], v[160:163], a[56:59], v[64:67]
  v_mfma_f32_16x16x32_bf16 v[68:71], v[160:163], a[60:63], v[68:71]
  s_waitcnt lgkmcnt(6)
  v_mfma_f32_16x16x32_bf16 v[72:75], v[164:167], a[56:59], v[72:75]
  v_mfma_f32_16x16x32_bf16 v[76:79], v[164:167], a[60:63], v[76:79]
  s_add_u32 m0, s74, 69632
  s_nop 0
  buffer_load_dwordx4 v6, s[40:43], s76 offen  lds
  s_add_u32 s76, s76, s77
  s_waitcnt lgkmcnt(5)
  v_mfma_f32_16x16x32_bf16 v[80:83], v[168:171], a[56:59], v[80:83]
  v_mfma_f32_16x16x32_bf16 v[84:87], v[168:171], a[60:63], v[84:87]
  s_waitcnt lgkmcnt(4)
  v_mfma_f32_16x16x32_bf16 v[88:91], v[172:175], a[56:59], v[88:91]
  v_mfma_f32_16x16x32_bf16 v[92:95], v[172:175], a[60:63], v[92:95]
  s_add_u32 m0, s74, 70656
  s_nop 0
  buffer_load_dwordx4 v6, s[40:43], s76 offen  lds
  s_add_u32 s76, s76, s77
  s_waitcnt lgkmcnt(3)
  v_mfma_f32_16x16x32_bf16 v[96:99], v[176:179], a[56:59], v[96:99]
  v_mfma_f32_16x16x32_bf16 v[100:103], v[176:179], a[60:63], v[100:103]
  s_waitcnt lgkmcnt(2)
  v_mfma_f32_16x16x32_bf16 v[104:107], v[180:183], a[56:59], v[104:107]
  v_mfma_f32_16x16x32_bf16 v[108:111], v[180:183], a[60:63], v[108:111]
  s_add_u32 m0, s74, 71680
  s_nop 0
  buffer_load_dwordx4 v7, s[40:43], s76 offen  lds
  s_add_u32 s76, s76, s77
  s_waitcnt lgkmcnt(1)
  v_mfma_f32_16x16x32_bf16 v[112:115], v[184:187], a[56:59], v[112:115]
  v_mfma_f32_16x16x32_bf16 v[116:119], v[184:187], a[60:63], v[116:119]
  s_waitcnt lgkmcnt(0)
  v_mfma_f32_16x16x32_bf16 v[120:123], v[188:191], a[56:59], v[120:123]
  v_mfma_f32_16x16x32_bf16 v[124:127], v[188:191], a[60:63], v[124:127]
  s_add_u32 m0, s74, 72704
  s_nop 0
  buffer_load_dwordx4 v7, s[40:43], s76 offen  lds
  s_add_u32 s76, s76, s77
  s_add_u32 s76, s76, s78
  s_waitcnt vmcnt(16)
  s_waitcnt vmcnt(8)
  s_barrier
  v_add_u32 v44, 131072, v8
  v_add_u32 v45, 131072, v9
  ds_read_b64_tr_b16 a[64:65], v44 offset:0
  ds_read_b64_tr_b16 a[66:67], v44 offset:1024
  ds_read_b64_tr_b16 a[68:69], v45 offset:0
  ds_read_b64_tr_b16 a[70:71], v45 offset:1024
  ds_read_b64_tr_b16 a[72:73], v44 offset:8192
  ds_read_b64_tr_b16 a[74:75], v44 offset:9216
  ds_read_b64_tr_b16 a[76:77], v45 offset:8192
  ds_read_b64_tr_b16 a[78:79], v45 offset:9216
  ds_read_b64_tr_b16 a[80:81], v44 offset:16384
  ds_read_b64_tr_b16 a[82:83], v44 offset:17408
  ds_read_b64_tr_b16 a[84:85], v45 offset:16384
  ds_read_b64_tr_b16 a[86:87], v45 offset:17408
  ds_read_b64_tr_b16 a[88:89], v44 offset:24576
  ds_read_b64_tr_b16 a[90:91], v44 offset:25600
  ds_read_b64_tr_b16 a[92:93], v45 offset:24576
  ds_read_b64_tr_b16 a[94:95], v45 offset:25600
  s_waitcnt lgkmcnt(0)
  ds_read_b128 v[128:131], v30 offset:0
  ds_read_b128 v[132:135], v30 offset:4096
  ds_read_b128 v[136:139], v30 offset:8192
  ds_read_b128 v[140:143], v30 offset:12288
  ds_read_b128 v[144:147], v30 offset:16384
  ds_read_b128 v[148:151], v30 offset:20480
  ds_read_b128 v[152:155], v30 offset:24576
  ds_read_b128 v[156:159], v30 offset:28672
  s_waitcnt lgkmcnt(7)
  v_mfma_f32_16x16x32_bf16 v[64:67], v[128:131], a[64:67], v[64:67]
  v_mfma_f32_16x16x32_bf16 v[68:71], v[128:131], a[68:71], v[68:71]
  ds_read_b128 v[160:163], v31 offset:0
  s_waitcnt lgkmcnt(7)
  v_mfma_f32_16x16x32_bf16 v[72:75], v[132:135], a[64:67], v[72:75]
  v_mfma_f32_16x16x32_bf16 v[76:79], v[132:135], a[68:71], v[76:79]
  ds_read_b128 v[164:167], v31 offset:4096
  s_add_u32 s75, s72, 768
  s_add_u32 m0, s74, 32768
  s_nop 0
  buffer_load_dwordx4 v2, s[36:39], s75 offen lds
  s_waitcnt lgkmcnt(7)
  v_mfma_f32_16x16x32_bf16 v[80:83], v[136:139], a[64:67], v[80:83]
  v_mfma_f32_16x16x32_bf16 v[84:87], v[136:139], a[68:71], v[84:87]
  ds_read_b128 v[168:171], v31 offset:8192
  s_waitcnt lgkmcnt(7)
  v_mfma_f32_16x16x32_bf16 v[88:91], v[140:143], a[64:67], v[88:91]
  v_mfma_f32_16x16x32_bf16 v[92:95], v[140:143], a[68:71], v[92:95]
  ds_read_b128 v[172:175], v31 offset:12288
  s_add_u32 s75, s72, 768
  s_add_u32 m0, s74, 33792
  s_nop 0
  buffer_load_dwordx4 v3, s[36:39], s75 offen lds
  s_waitcnt lgkmcnt(7)
  v_mfma_f32_16x16x32_bf16 v[96:99], v[144:147], a[64:67], v[96:99]
  v_mfma_f32_16x16x32_bf16 v[100:103], v[144:147], a[68:71], v[100:103]
  ds_read_b128 v[176:179], v31 offset:16384
  s_waitcnt lgkmcnt(7)
  v_mfma_f32_16x16x32_bf16 v[104:107], v[148:151], a[64:67], v[104:107]
  v_mfma_f32_16x16x32_bf16 v[108:111], v[148:151], a[68:71], v[108:111]
  ds_read_b128 v[180:183], v31 offset:20480
  s_add_u32 s75, s72, 768
  s_add_u32 m0, s74, 34816
  s_nop 0
  buffer_load_dwordx4 v4, s[36:39], s75 offen lds
  s_waitcnt lgkmcnt(7)
  v_mfma_f32_16x16x32_bf16 v[112:115], v[152:155], a[64:67], v[112:115]
  v_mfma_f32_16x16x32_bf16 v[116:119], v[152:155], a[68:71], v[116:119]
  ds_read_b128 v[184:187], v31 offset:24576
  s_waitcnt lgkmcnt(7)
  v_mfma_f32_16x16x32_bf16 v[120:123], v[156:159], a[64:67], v[120:123]
  v_mfma_f32_16x16x32_bf16 v[124:127], v[156:159], a[68:71], v[124:127]
  ds_read_b128 v[188:191], v31 offset:28672
  s_add_u32 s75, s72, 768
  s_add_u32 m0, s74, 35840
  s_nop 0
  buffer_load_dwordx4 v5, s[36:39], s75 offen lds
  s_waitcnt lgkmcnt(7)
  v_mfma_f32_16x16x32_bf16 v[64:67], v[160:163], a[72:75], v[64:67]
  v_mfma_f32_16x16x32_bf16 v[68:71], v[160:163], a[76:79], v[68:71]
  ds_read_b128 v[128:131], v32 offset:0
  s_waitcnt lgkmcnt(7)
  v_mfma_f32_16x16x32_bf16 v[72:75], v[164:167], a[72:75], v[72:75]
  v_mfma_f32_16x16x32_bf16 v[76:79], v[164:167], a[76:79], v[76:79]
  ds_read_b128 v[132:135], v32 offset:4096
  s_add_u32 s75, s72, 21248
  s_add_u32 m0, s74, 36864
  s_nop 0
  buffer_load_dwordx4 v2, s[36:39], s75 offen lds
  s_waitcnt lgkmcnt(7)
  v_mfma_f32_16x16x32_bf16 v[80:83], v[168:171], a[72:75], v[80:83]
  v_mfma_f32_16x16x32_bf16 v[84:87], v[168:171], a[76:79], v[84:87]
  ds_read_b128 v[136:139], v32 offset:8192
  s_waitcnt lgkmcnt(7)
  v_mfma_f32_16x16x32_bf16 v[88:91], v[172:175], a[72:75], v[88:91]
  v_mfma_f32_16x16x32_bf16 v[92:95], v[172:175], a[76:79], v[92:95]
  ds_read_b128 v[140:143], v32 offset:12288
  s_add_u32 s75, s72, 21248
  s_add_u32 m0, s74, 37888
  s_nop 0
  buffer_load_dwordx4 v3, s[36:39], s75 offen lds
  s_waitcnt lgkmcnt(7)
  v_mfma_f32_16x16x32_bf16 v[96:99], v[176:179], a[72:75], v[96:99]
  v_mfma_f32_16x16x32_bf16 v[100:103], v[176:179], a[76:79], v[100:103]
  ds_read_b128 v[144:147], v32 offset:16384
  s_waitcnt lgkmcnt(7)
  v_mfma_f32_16x16x32_bf16 v[104:107], v[180:183], a[72:75], v[104:107]
  v_mfma_f32_16x16x32_bf16 v[108:111], v[180:183], a[76:79], v[108:111]
  ds_read_b128 v[148:151], v32 offset:20480
  s_add_u32 s75, s72, 21248
  s_add_u32 m0, s74, 38912
  s_nop 0
  buffer_load_dwordx4 v4, s[36:39], s75 offen lds
  s_waitcnt lgkmcnt(7)
  v_mfma_f32_16x16x32_bf16 v[112:115], v[184:187], a[72:75], v[112:115]
  v_mfma_f32_16x16x32_bf16 v[116:119], v[184:187], a[76:79], v[116:119]
  ds_read_b128 v[152:155], v32 offset:24576
  s_waitcnt lgkmcnt(7)
  v_mfma_f32_16x16x32_bf16 v[120:123], v[188:191], a[72:75], v[120:123]
  v_mfma_f32_16x16x32_bf16 v[124:127], v[188:191], a[76:79], v[124:127]
  ds_read_b128 v[156:159], v32 offset:28672
  s_add_u32 s75, s72, 21248
  s_add_u32 m0, s74, 39936
  s_nop 0
  buffer_load_dwordx4 v5, s[36:39], s75 offen lds
  s_waitcnt lgkmcnt(7)
  v_mfma_f32_16x16x32_bf16 v[64:67], v[128:131], a[80:83], v[64:67]
  v_mfma_f32_16x16x32_bf16 v[68:71], v[128:131], a[84:87], v[68:71]
  ds_read_b128 v[160:163], v33 offset:0
  s_waitcnt lgkmcnt(7)
  v_mfma_f32_16x16x32_bf16 v[72:75], v[132:135], a[80:83], v[72:75]
  v_mfma_f32_16x16x32_bf16 v[76:79], v[132:135], a[84:87], v[76:79]
  ds_read_b128 v[164:167], v33 offset:4096
  s_add_u32 m0, s74, 98304
  s_nop 0
  buffer_load_dwordx4 v6, s[40:43], s76 offen  lds
  s_add_u32 s76, s76, s77
  s_waitcnt lgkmcnt(7)
  v_mfma_f32_16x16x32_bf16 v[80:83], v[136:139], a[80:83], v[80:83]
  v_mfma_f32_16x16x32_bf16 v[84:87], v[136:139], a[84:87], v[84:87]
  ds_read_b128 v[168:171], v33 offset:8192
  s_waitcnt lgkmcnt(7)
  v_mfma_f32_16x16x32_bf16 v[88:91], v[140:143], a[80:83], v[88:91]
  v_mfma_f32_16x16x32_bf16 v[92:95], v[140:143], a[84:87], v[92:95]
  ds_read_b128 v[172:175], v33 offset:12288
  s_add_u32 m0, s74, 99328
  s_nop 0
  buffer_load_dwordx4 v6, s[40:43], s76 offen  lds
  s_add_u32 s76, s76, s77
  s_waitcnt lgkmcnt(7)
  v_mfma_f32_16x16x32_bf16 v[96:99], v[144:147], a[80:83], v[96:99]
  v_mfma_f32_16x16x32_bf16 v[100:103], v[144:147], a[84:87], v[100:103]
  ds_read_b128 v[176:179], v33 offset:16384
  s_waitcnt lgkmcnt(7)
  v_mfma_f32_16x16x32_bf16 v[104:107], v[148:151], a[80:83], v[104:107]
  v_mfma_f32_16x16x32_bf16 v[108:111], v[148:151], a[84:87], v[108:111]
  ds_read_b128 v[180:183], v33 offset:20480
  s_add_u32 m0, s74, 100352
  s_nop 0
  buffer_load_dwordx4 v7, s[40:43], s76 offen  lds
  s_add_u32 s76, s76, s77
  s_waitcnt lgkmcnt(7)
  v_mfma_f32_16x16x32_bf16 v[112:115], v[152:155], a[80:83], v[112:115]
  v_mfma_f32_16x16x32_bf16 v[116:119], v[152:155], a[84:87], v[116:119]
  ds_read_b128 v[184:187], v33 offset:24576
  s_waitcnt lgkmcnt(7)
  v_mfma_f32_16x16x32_bf16 v[120:123], v[156:159], a[80:83], v[120:123]
  v_mfma_f32_16x16x32_bf16 v[124:127], v[156:159], a[84:87], v[124:127]
  ds_read_b128 v[188:191], v33 offset:28672
  s_add_u32 m0, s74, 101376
  s_nop 0
  buffer_load_dwordx4 v7, s[40:43], s76 offen  lds
  s_add_u32 s76, s76, s77
  s_waitcnt lgkmcnt(7)
  v_mfma_f32_16x16x32_bf16 v[64:67], v[160:163], a[88:91], v[64:67]
  v_mfma_f32_16x16x32_bf16 v[68:71], v[160:163], a[92:95], v[68:71]
  s_waitcnt lgkmcnt(6)
  v_mfma_f32_16x16x32_bf16 v[72:75], v[164:167], a[88:91], v[72:75]
  v_mfma_f32_16x16x32_bf16 v[76:79], v[164:167], a[92:95], v[76:79]
  s_add_u32 m0, s74, 102400
  s_nop 0
  buffer_load_dwordx4 v6, s[40:43], s76 offen  lds
  s_add_u32 s76, s76, s77
  s_waitcnt lgkmcnt(5)
  v_mfma_f32_16x16x32_bf16 v[80:83], v[168:171], a[88:91], v[80:83]
  v_mfma_f32_16x16x32_bf16 v[84:87], v[168:171], a[92:95], v[84:87]
  s_waitcnt lgkmcnt(4)
  v_mfma_f32_16x16x32_bf16 v[88:91], v[172:175], a[88:91], v[88:91]
  v_mfma_f32_16x16x32_bf16 v[92:95], v[172:175], a[92:95], v[92:95]
  s_add_u32 m0, s74, 103424
  s_nop 0
  buffer_load_dwordx4 v6, s[40:43], s76 offen  lds
  s_add_u32 s76, s76, s77
  s_waitcnt lgkmcnt(3)
  v_mfma_f32_16x16x32_bf16 v[96:99], v[176:179], a[88:91], v[96:99]
  v_mfma_f32_16x16x32_bf16 v[100:103], v[176:179], a[92:95], v[100:103]
  s_waitcnt lgkmcnt(2)
  v_mfma_f32_16x16x32_bf16 v[104:107], v[180:183], a[88:91], v[104:107]
  v_mfma_f32_16x16x32_bf16 v[108:111], v[180:183], a[92:95], v[108:111]
  s_add_u32 m0, s74, 104448
  s_nop 0
  buffer_load_dwordx4 v7, s[40:43], s76 offen  lds
  s_add_u32 s76, s76, s77
  s_waitcnt lgkmcnt(1)
  v_mfma_f32_16x16x32_bf16 v[112:115], v[184:187], a[88:91], v[112:115]
  v_mfma_f32_16x16x32_bf16 v[116:119], v[184:187], a[92:95], v[116:119]
  s_waitcnt lgkmcnt(0)
  v_mfma_f32_16x16x32_bf16 v[120:123], v[188:191], a[88:91], v[120:123]
  v_mfma_f32_16x16x32_bf16 v[124:127], v[188:191], a[92:95], v[124:127]
  s_add_u32 m0, s74, 105472
  s_nop 0
  buffer_load_dwordx4 v7, s[40:43], s76 offen  lds
  s_add_u32 s76, s76, s77
  s_add_u32 s76, s76, s78
  s_waitcnt vmcnt(16)
  s_waitcnt vmcnt(8)
  s_barrier
  v_add_u32 v44, 65536, v8
  v_add_u32 v45, 65536, v9
  ds_read_b64_tr_b16 a[96:97], v44 offset:0
  ds_read_b64_tr_b16 a[98:99], v44 offset:1024
  ds_read_b64_tr_b16 a[100:101], v45 offset:0
  ds_read_b64_tr_b16 a[102:103], v45 offset:1024
  ds_read_b64_tr_b16 a[104:105], v44 offset:8192
  ds_read_b64_tr_b16 a[106:107], v44 offset:9216
  ds_read_b64_tr_b16 a[108:109], v45 offset:8192
  ds_read_b64_tr_b16 a[110:111], v45 offset:9216
  ds_read_b64_tr_b16 a[112:113], v44 offset:16384
  ds_read_b64_tr_b16 a[114:115], v44 offset:17408
  ds_read_b64_tr_b16 a[116:117], v45 offset:16384
  ds_read_b64_tr_b16 a[118:119], v45 offset:17408
  ds_read_b64_tr_b16 a[120:121], v44 offset:24576
  ds_read_b64_tr_b16 a[122:123], v44 offset:25600
  ds_read_b64_tr_b16 a[124:125], v45 offset:24576
  ds_read_b64_tr_b16 a[126:127], v45 offset:25600
  s_waitcnt lgkmcnt(0)
  ds_read_b128 v[128:131], v30 offset:32768
  ds_read_b128 v[132:135], v30 offset:36864
  ds_read_b128 v[136:139], v30 offset:40960
  ds_read_b128 v[140:143], v30 offset:45056
  ds_read_b128 v[144:147], v30 offset:49152
  ds_read_b128 v[148:151], v30 offset:53248
  ds_read_b128 v[152:155], v30 offset:57344
  ds_read_b128 v[156:159], v30 offset:61440
  s_waitcnt lgkmcnt(7)
  v_mfma_f32_16x16x32_bf16 v[64:67], v[128:131], a[96:99], v[64:67]
  v_mfma_f32_16x16x32_bf16 v[68:71], v[128:131], a[100:103], v[68:71]
  ds_read_b128 v[160:163], v31 offset:32768
  s_waitcnt lgkmcnt(7)
  v_mfma_f32_16x16x32_bf16 v[72:75], v[132:135], a[96:99], v[72:75]
  v_mfma_f32_16x16x32_bf16 v[76:79], v[132:135], a[100:103], v[76:79]
  ds_read_b128 v[164:167], v31 offset:36864
  s_add_u32 s75, s72, 1024
  s_add_u32 m0, s74, 0
  s_nop 0
  buffer_load_dwordx4 v2, s[36:39], s75 offen lds
  s_waitcnt lgkmcnt(7)
  v_mfma_f32_16x16x32_bf16 v[80:83], v[136:139], a[96:99], v[80:83]
  v_mfma_f32_16x16x32_bf16 v[84:87], v[136:139], a[100:103], v[84:87]
  ds_read_b128 v[168:171], v31 offset:40960
  s_waitcnt lgkmcnt(7)
  v_mfma_f32_16x16x32_bf16 v[88:91], v[140:143], a[96:99], v[88:91]
  v_mfma_f32_16x16x32_bf16 v[92:95], v[140:143], a[100:103], v[92:95]
  ds_read_b128 v[172:175], v31 offset:45056
  s_add_u32 s75, s72, 1024
  s_add_u32 m0, s74, 1024
  s_nop 0
  buffer_load_dwordx4 v3, s[36:39], s75 offen lds
  s_waitcnt lgkmcnt(7)
  v_mfma_f32_16x16x32_bf16 v[96:99], v[144:147], a[96:99], v[96:99]
  v_mfma_f32_16x16x32_bf16 v[100:103], v[144:147], a[100:103], v[100:103]
  ds_read_b128 v[176:179], v31 offset:49152
  s_waitcnt lgkmcnt(7)
  v_mfma_f32_16x16x32_bf16 v[104:107], v[148:151], a[96:99], v[104:107]
  v_mfma_f32_16x16x32_bf16 v[108:111], v[148:151], a[100:103], v[108:111]
  ds_read_b128 v[180:183], v31 offset:53248
  s_add_u32 s75, s72, 1024
  s_add_u32 m0, s74, 2048
  s_nop 0
  buffer_load_dwordx4 v4, s[36:39], s75 offen lds
  s_waitcnt lgkmcnt(7)
  v_mfma_f32_16x16x32_bf16 v[112:115], v[152:155], a[96:99], v[112:115]
  v_mfma_f32_16x16x32_bf16 v[116:119], v[152:155], a[100:103], v[116:119]
  ds_read_b128 v[184:187], v31 offset:57344
  s_waitcnt lgkmcnt(7)
  v_mfma_f32_16x16x32_bf16 v[120:123], v[156:159], a[96:99], v[120:123]
  v_mfma_f32_16x16x32_bf16 v[124:127], v[156:159], a[100:103], v[124:127]
  ds_read_b128 v[188:191], v31 offset:61440
  s_add_u32 s75, s72, 1024
  s_add_u32 m0, s74, 3072
  s_nop 0
  buffer_load_dwordx4 v5, s[36:39], s75 offen lds
  s_waitcnt lgkmcnt(7)
  v_mfma_f32_16x16x32_bf16 v[64:67], v[160:163], a[104:107], v[64:67]
  v_mfma_f32_16x16x32_bf16 v[68:71], v[160:163], a[108:111], v[68:71]
  ds_read_b128 v[128:131], v32 offset:32768
  s_waitcnt lgkmcnt(7)
  v_mfma_f32_16x16x32_bf16 v[72:75], v[164:167], a[104:107], v[72:75]
  v_mfma_f32_16x16x32_bf16 v[76:79], v[164:167], a[108:111], v[76:79]
  ds_read_b128 v[132:135], v32 offset:36864
  s_add_u32 s75, s72, 21504
  s_add_u32 m0, s74, 4096
  s_nop 0
  buffer_load_dwordx4 v2, s[36:39], s75 offen lds
  s_waitcnt lgkmcnt(7)
  v_mfma_f32_16x16x32_bf16 v[80:83], v[168:171], a[104:107], v[80:83]
  v_mfma_f32_16x16x32_bf16 v[84:87], v[168:171], a[108:111], v[84:87]
  ds_read_b128 v[136:139], v32 offset:40960
  s_waitcnt lgkmcnt(7)
  v_mfma_f32_16x16x32_bf16 v[88:91], v[172:175], a[104:107], v[88:91]
  v_mfma_f32_16x16x32_bf16 v[92:95], v[172:175], a[108:111], v[92:95]
  ds_read_b128 v[140:143], v32 offset:45056
  s_add_u32 s75, s72, 21504
  s_add_u32 m0, s74, 5120
  s_nop 0
  buffer_load_dwordx4 v3, s[36:39], s75 offen lds
  s_waitcnt lgkmcnt(7)
  v_mfma_f32_16x16x32_bf16 v[96:99], v[176:179], a[104:107], v[96:99]
  v_mfma_f32_16x16x32_bf16 v[100:103], v[176:179], a[108:111], v[100:103]
  ds_read_b128 v[144:147], v32 offset:49152
  s_waitcnt lgkmcnt(7)
  v_mfma_f32_16x16x32_bf16 v[104:107], v[180:183], a[104:107], v[104:107]
  v_mfma_f32_16x16x32_bf16 v[108:111], v[180:183], a[108:111], v[108:111]
  ds_read_b128 v[148:151], v32 offset:53248
  s_add_u32 s75, s72, 21504
  s_add_u32 m0, s74, 6144
  s_nop 0
  buffer_load_dwordx4 v4, s[36:39], s75 offen lds
  s_waitcnt lgkmcnt(7)
  v_mfma_f32_16x16x32_bf16 v[112:115], v[184:187], a[104:107], v[112:115]
  v_mfma_f32_16x16x32_bf16 v[116:119], v[184:187], a[108:111], v[116:119]
  ds_read_b128 v[152:155], v32 offset:57344
  s_waitcnt lgkmcnt(7)
  v_mfma_f32_16x16x32_bf16 v[120:123], v[188:191], a[104:107], v[120:123]
  v_mfma_f32_16x16x32_bf16 v[124:127], v[188:191], a[108:111], v[124:127]
  ds_read_b128 v[156:159], v32 offset:61440
  s_add_u32 s75, s72, 21504
  s_add_u32 m0, s74, 7168
  s_nop 0
  buffer_load_dwordx4 v5, s[36:39], s75 offen lds
  s_waitcnt lgkmcnt(7)
  v_mfma_f32_16x16x32_bf16 v[64:67], v[128:131], a[112:115], v[64:67]
  v_mfma_f32_16x16x32_bf16 v[68:71], v[128:131], a[116:119], v[68:71]
  ds_read_b128 v[160:163], v33 offset:32768
  s_waitcnt lgkmcnt(7)
  v_mfma_f32_16x16x32_bf16 v[72:75], v[132:135], a[112:115], v[72:75]
  v_mfma_f32_16x16x32_bf16 v[76:79], v[132:135], a[116:119], v[76:79]
  ds_read_b128 v[164:167], v33 offset:36864
  s_waitcnt lgkmcnt(7)
  v_mfma_f32_16x16x32_bf16 v[80:83], v[136:139], a[112:115], v[80:83]
  v_mfma_f32_16x16x32_bf16 v[84:87], v[136:139], a[116:119], v[84:87]
  ds_read_b128 v[168:171], v33 offset:40960
  s_waitcnt lgkmcnt(7)
  v_mfma_f32_16x16x32_bf16 v[88:91], v[140:143], a[112:115], v[88:91]
  v_mfma_f32_16x16x32_bf16 v[92:95], v[140:143], a[116:119], v[92:95]
  ds_read_b128 v[172:175], v33 offset:45056
  s_waitcnt lgkmcnt(7)
  v_mfma_f32_16x16x32_bf16 v[96:99], v[144:147], a[112:115], v[96:99]
  v_mfma_f32_16x16x32_bf16 v[100:103], v[144:147], a[116:119], v[100:103]
  ds_read_b128 v[176:179], v33 offset:49152
  s_waitcnt lgkmcnt(7)
  v_mfma_f32_16x16x32_bf16 v[104:107], v[148:151], a[112:115], v[104:107]
  v_mfma_f32_16x16x32_bf16 v[108:111], v[148:151], a[116:119], v[108:111]
  ds_read_b128 v[180:183], v33 offset:53248
  s_waitcnt lgkmcnt(7)
  v_mfma_f32_16x16x32_bf16 v[112:115], v[152:155], a[112:115], v[112:115]
  v_mfma_f32_16x16x32_bf16 v[116:119], v[152:155], a[116:119], v[116:119]
  ds_read_b128 v[184:187], v33 offset:57344
  s_waitcnt lgkmcnt(7)
  v_mfma_f32_16x16x32_bf16 v[120:123], v[156:159], a[112:115], v[120:123]
  v_mfma_f32_16x16x32_bf16 v[124:127], v[156:159], a[116:119], v[124:127]
  ds_read_b128 v[188:191], v33 offset:61440
  s_waitcnt lgkmcnt(7)
  v_mfma_f32_16x16x32_bf16 v[64:67], v[160:163], a[120:123], v[64:67]
  v_mfma_f32_16x16x32_bf16 v[68:71], v[160:163], a[124:127], v[68:71]
  s_waitcnt lgkmcnt(6)
  v_mfma_f32_16x16x32_bf16 v[72:75], v[164:167], a[120:123], v[72:75]
  v_mfma_f32_16x16x32_bf16 v[76:79], v[164:167], a[124:127], v[76:79]
  s_waitcnt lgkmcnt(5)
  v_mfma_f32_16x16x32_bf16 v[80:83], v[168:171], a[120:123], v[80:83]
  v_mfma_f32_16x16x32_bf16 v[84:87], v[168:171], a[124:127], v[84:87]
  s_waitcnt lgkmcnt(4)
  v_mfma_f32_16x16x32_bf16 v[88:91], v[172:175], a[120:123], v[88:91]
  v_mfma_f32_16x16x32_bf16 v[92:95], v[172:175], a[124:127], v[92:95]
  s_waitcnt lgkmcnt(3)
  v_mfma_f32_16x16x32_bf16 v[96:99], v[176:179], a[120:123], v[96:99]
  v_mfma_f32_16x16x32_bf16 v[100:103], v[176:179], a[124:127], v[100:103]
  s_waitcnt lgkmcnt(2)
  v_mfma_f32_16x16x32_bf16 v[104:107], v[180:183], a[120:123], v[104:107]
  v_mfma_f32_16x16x32_bf16 v[108:111], v[180:183], a[124:127], v[108:111]
  s_waitcnt lgkmcnt(1)
  v_mfma_f32_16x16x32_bf16 v[112:115], v[184:187], a[120:123], v[112:115]
  v_mfma_f32_16x16x32_bf16 v[116:119], v[184:187], a[124:127], v[116:119]
  s_waitcnt lgkmcnt(0)
  v_mfma_f32_16x16x32_bf16 v[120:123], v[188:191], a[120:123], v[120:123]
  v_mfma_f32_16x16x32_bf16 v[124:127], v[188:191], a[124:127], v[124:127]
  s_waitcnt vmcnt(8)
  s_waitcnt vmcnt(0)
  s_barrier
  v_add_u32 v44, 98304, v8
  v_add_u32 v45, 98304, v9
  ds_read_b64_tr_b16 a[128:129], v44 offset:0
  ds_read_b64_tr_b16 a[130:131], v44 offset:1024
  ds_read_b64_tr_b16 a[132:133], v45 offset:0
  ds_read_b64_tr_b16 a[134:135], v45 offset:1024
  ds_read_b64_tr_b16 a[136:137], v44 offset:8192
  ds_read_b64_tr_b16 a[138:139], v44 offset:9216
  ds_read_b64_tr_b16 a[140:141], v45 offset:8192
  ds_read_b64_tr_b16 a[142:143], v45 offset:9216
  ds_read_b64_tr_b16 a[144:145], v44 offset:16384
  ds_read_b64_tr_b16 a[146:147], v44 offset:17408
  ds_read_b64_tr_b16 a[148:149], v45 offset:16384
  ds_read_b64_tr_b16 a[150:151], v45 offset:17408
  ds_read_b64_tr_b16 a[152:153], v44 offset:24576
  ds_read_b64_tr_b16 a[154:155], v44 offset:25600
  ds_read_b64_tr_b16 a[156:157], v45 offset:24576
  ds_read_b64_tr_b16 a[158:159], v45 offset:25600
  s_waitcnt lgkmcnt(0)
  ds_read_b128 v[128:131], v30 offset:0
  ds_read_b128 v[132:135], v30 offset:4096
  ds_read_b128 v[136:139], v30 offset:8192
  ds_read_b128 v[140:143], v30 offset:12288
  ds_read_b128 v[144:147], v30 offset:16384
  ds_read_b128 v[148:151], v30 offset:20480
  ds_read_b128 v[152:155], v30 offset:24576
  ds_read_b128 v[156:159], v30 offset:28672
  s_waitcnt lgkmcnt(7)
  v_mfma_f32_16x16x32_bf16 v[64:67], v[128:131], a[128:131], v[64:67]
  v_mfma_f32_16x16x32_bf16 v[68:71], v[128:131], a[132:135], v[68:71]
  ds_read_b128 v[160:163], v31 offset:0
  s_waitcnt lgkmcnt(7)
  v_mfma_f32_16x16x32_bf16 v[72:75], v[132:135], a[128:131], v[72:75]
  v_mfma_f32_16x16x32_bf16 v[76:79], v[132:135], a[132:135], v[76:79]
  ds_read_b128 v[164:167], v31 offset:4096
  s_waitcnt lgkmcnt(7)
  v_mfma_f32_16x16x32_bf16 v[80:83], v[136:139], a[128:131], v[80:83]
  v_mfma_f32_16x16x32_bf16 v[84:87], v[136:139], a[132:135], v[84:87]
  ds_read_b128 v[168:171], v31 offset:8192
  s_waitcnt lgkmcnt(7)
  v_mfma_f32_16x16x32_bf16 v[88:91], v[140:143], a[128:131], v[88:91]
  v_mfma_f32_16x16x32_bf16 v[92:95], v[140:143], a[132:135], v[92:95]
  ds_read_b128 v[172:175], v31 offset:12288
  s_waitcnt lgkmcnt(7)
  v_mfma_f32_16x16x32_bf16 v[96:99], v[144:147], a[128:131], v[96:99]
  v_mfma_f32_16x16x32_bf16 v[100:103], v[144:147], a[132:135], v[100:103]
  ds_read_b128 v[176:179], v31 offset:16384
  s_waitcnt lgkmcnt(7)
  v_mfma_f32_16x16x32_bf16 v[104:107], v[148:151], a[128:131], v[104:107]
  v_mfma_f32_16x16x32_bf16 v[108:111], v[148:151], a[132:135], v[108:111]
  ds_read_b128 v[180:183], v31 offset:20480
  s_waitcnt lgkmcnt(7)
  v_mfma_f32_16x16x32_bf16 v[112:115], v[152:155], a[128:131], v[112:115]
  v_mfma_f32_16x16x32_bf16 v[116:119], v[152:155], a[132:135], v[116:119]
  ds_read_b128 v[184:187], v31 offset:24576
  s_waitcnt lgkmcnt(7)
  v_mfma_f32_16x16x32_bf16 v[120:123], v[156:159], a[128:131], v[120:123]
  v_mfma_f32_16x16x32_bf16 v[124:127], v[156:159], a[132:135], v[124:127]
  ds_read_b128 v[188:191], v31 offset:28672
  s_waitcnt lgkmcnt(7)
  v_mfma_f32_16x16x32_bf16 v[64:67], v[160:163], a[136:139], v[64:67]
  v_mfma_f32_16x16x32_bf16 v[68:71], v[160:163], a[140:143], v[68:71]
  ds_read_b128 v[128:131], v32 offset:0
  s_waitcnt lgkmcnt(7)
  v_mfma_f32_16x16x32_bf16 v[72:75], v[164:167], a[136:139], v[72:75]
  v_mfma_f32_16x16x32_bf16 v[76:79], v[164:167], a[140:143], v[76:79]
  ds_read_b128 v[132:135], v32 offset:4096
  s_waitcnt lgkmcnt(7)
  v_mfma_f32_16x16x32_bf16 v[80:83], v[168:171], a[136:139], v[80:83]
  v_mfma_f32_16x16x32_bf16 v[84:87], v[168:171], a[140:143], v[84:87]
  ds_read_b128 v[136:139], v32 offset:8192
  s_waitcnt lgkmcnt(7)
  v_mfma_f32_16x16x32_bf16 v[88:91], v[172:175], a[136:139], v[88:91]
  v_mfma_f32_16x16x32_bf16 v[92:95], v[172:175], a[140:143], v[92:95]
  ds_read_b128 v[140:143], v32 offset:12288
  s_waitcnt lgkmcnt(7)
  v_mfma_f32_16x16x32_bf16 v[96:99], v[176:179], a[136:139], v[96:99]
  v_mfma_f32_16x16x32_bf16 v[100:103], v[176:179], a[140:143], v[100:103]
  ds_read_b128 v[144:147], v32 offset:16384
  s_waitcnt lgkmcnt(7)
  v_mfma_f32_16x16x32_bf16 v[104:107], v[180:183], a[136:139], v[104:107]
  v_mfma_f32_16x16x32_bf16 v[108:111], v[180:183], a[140:143], v[108:111]
  ds_read_b128 v[148:151], v32 offset:20480
  s_waitcnt lgkmcnt(7)
  v_mfma_f32_16x16x32_bf16 v[112:115], v[184:187], a[136:139], v[112:115]
  v_mfma_f32_16x16x32_bf16 v[116:119], v[184:187], a[140:143], v[116:119]
  ds_read_b128 v[152:155], v32 offset:24576
  s_waitcnt lgkmcnt(7)
  v_mfma_f32_16x16x32_bf16 v[120:123], v[188:191], a[136:139], v[120:123]
  v_mfma_f32_16x16x32_bf16 v[124:127], v[188:191], a[140:143], v[124:127]
  ds_read_b128 v[156:159], v32 offset:28672
  s_waitcnt lgkmcnt(7)
  v_mfma_f32_16x16x32_bf16 v[64:67], v[128:131], a[144:147], v[64:67]
  v_mfma_f32_16x16x32_bf16 v[68:71], v[128:131], a[148:151], v[68:71]
  ds_read_b128 v[160:163], v33 offset:0
  s_waitcnt lgkmcnt(7)
  v_mfma_f32_16x16x32_bf16 v[72:75], v[132:135], a[144:147], v[72:75]
  v_mfma_f32_16x16x32_bf16 v[76:79], v[132:135], a[148:151], v[76:79]
  ds_read_b128 v[164:167], v33 offset:4096
  s_waitcnt lgkmcnt(7)
  v_mfma_f32_16x16x32_bf16 v[80:83], v[136:139], a[144:147], v[80:83]
  v_mfma_f32_16x16x32_bf16 v[84:87], v[136:139], a[148:151], v[84:87]
  ds_read_b128 v[168:171], v33 offset:8192
  s_waitcnt lgkmcnt(7)
  v_mfma_f32_16x16x32_bf16 v[88:91], v[140:143], a[144:147], v[88:91]
  v_mfma_f32_16x16x32_bf16 v[92:95], v[140:143], a[148:151], v[92:95]
  ds_read_b128 v[172:175], v33 offset:12288
  s_waitcnt lgkmcnt(7)
  v_mfma_f32_16x16x32_bf16 v[96:99], v[144:147], a[144:147], v[96:99]
  v_mfma_f32_16x16x32_bf16 v[100:103], v[144:147], a[148:151], v[100:103]
  ds_read_b128 v[176:179], v33 offset:16384
  s_waitcnt lgkmcnt(7)
  v_mfma_f32_16x16x32_bf16 v[104:107], v[148:151], a[144:147], v[104:107]
  v_mfma_f32_16x16x32_bf16 v[108:111], v[148:151], a[148:151], v[108:111]
  ds_read_b128 v[180:183], v33 offset:20480
  s_waitcnt lgkmcnt(7)
  v_mfma_f32_16x16x32_bf16 v[112:115], v[152:155], a[144:147], v[112:115]
  v_mfma_f32_16x16x32_bf16 v[116:119], v[152:155], a[148:151], v[116:119]
  ds_read_b128 v[184:187], v33 offset:24576
  s_waitcnt lgkmcnt(7)
  v_mfma_f32_16x16x32_bf16 v[120:123], v[156:159], a[144:147], v[120:123]
  v_mfma_f32_16x16x32_bf16 v[124:127], v[156:159], a[148:151], v[124:127]
  ds_read_b128 v[188:191], v33 offset:28672
  s_waitcnt lgkmcnt(7)
  v_mfma_f32_16x16x32_bf16 v[64:67], v[160:163], a[152:155], v[64:67]
  v_mfma_f32_16x16x32_bf16 v[68:71], v[160:163], a[156:159], v[68:71]
  s_waitcnt lgkmcnt(6)
  v_mfma_f32_16x16x32_bf16 v[72:75], v[164:167], a[152:155], v[72:75]
  v_mfma_f32_16x16x32_bf16 v[76:79], v[164:167], a[156:159], v[76:79]
  s_waitcnt lgkmcnt(5)
  v_mfma_f32_16x16x32_bf16 v[80:83], v[168:171], a[152:155], v[80:83]
  v_mfma_f32_16x16x32_bf16 v[84:87], v[168:171], a[156:159], v[84:87]
  s_waitcnt lgkmcnt(4)
  v_mfma_f32_16x16x32_bf16 v[88:91], v[172:175], a[152:155], v[88:91]
  v_mfma_f32_16x16x32_bf16 v[92:95], v[172:175], a[156:159], v[92:95]
  s_waitcnt lgkmcnt(3)
  v_mfma_f32_16x16x32_bf16 v[96:99], v[176:179], a[152:155], v[96:99]
  v_mfma_f32_16x16x32_bf16 v[100:103], v[176:179], a[156:159], v[100:103]
  s_waitcnt lgkmcnt(2)
  v_mfma_f32_16x16x32_bf16 v[104:107], v[180:183], a[152:155], v[104:107]
  v_mfma_f32_16x16x32_bf16 v[108:111], v[180:183], a[156:159], v[108:111]
  s_waitcnt lgkmcnt(1)
  v_mfma_f32_16x16x32_bf16 v[112:115], v[184:187], a[152:155], v[112:115]
  v_mfma_f32_16x16x32_bf16 v[116:119], v[184:187], a[156:159], v[116:119]
  s_waitcnt lgkmcnt(0)
  v_mfma_f32_16x16x32_bf16 v[120:123], v[188:191], a[152:155], v[120:123]
  v_mfma_f32_16x16x32_bf16 v[124:127], v[188:191], a[156:159], v[124:127]
  v_cvt_pk_bf16_f32 v192, v64, v65
  v_cvt_pk_bf16_f32 v193, v66, v67
  v_cvt_pk_bf16_f32 v194, v72, v73
  v_cvt_pk_bf16_f32 v195, v74, v75
  s_mov_b32 s75, s65
  buffer_store_dwordx4 v[192:195], v18, s[44:47], s75 offen sc1
  v_cvt_pk_bf16_f32 v196, v68, v69
  v_cvt_pk_bf16_f32 v197, v70, v71
  v_cvt_pk_bf16_f32 v198, v76, v77
  v_cvt_pk_bf16_f32 v199, v78, v79
  v_and_or_b32 v196, v196, v43, v42
  v_and_or_b32 v197, v197, v43, v42
  v_and_or_b32 v198, v198, v43, v42
  v_and_or_b32 v199, v199, v43, v42
  s_add_u32 s75, s65, s67
  s_add_u32 s65, s65, s66
  buffer_store_dwordx4 v[196:199], v18, s[44:47], s75 offen sc1
  v_cvt_pk_bf16_f32 v200, v80, v81
  v_cvt_pk_bf16_f32 v201, v82, v83
  v_cvt_pk_bf16_f32 v202, v88, v89
  v_cvt_pk_bf16_f32 v203, v90, v91
  s_mov_b32 s75, s65
  buffer_store_dwordx4 v[200:203], v18, s[44:47], s75 offen sc1
  v_cvt_pk_bf16_f32 v204, v84, v85
  v_cvt_pk_bf16_f32 v205, v86, v87
  v_cvt_pk_bf16_f32 v206, v92, v93
  v_cvt_pk_bf16_f32 v207, v94, v95
  v_and_or_b32 v204, v204, v43, v42
  v_and_or_b32 v205, v205, v43, v42
  v_and_or_b32 v206, v206, v43, v42
  v_and_or_b32 v207, v207, v43, v42
  s_add_u32 s75, s65, s67
  s_add_u32 s65, s65, s66
  buffer_store_dwordx4 v[204:207], v18, s[44:47], s75 offen sc1
  v_cvt_pk_bf16_f32 v192, v96, v97
  v_cvt_pk_bf16_f32 v193, v98, v99
  v_cvt_pk_bf16_f32 v194, v104, v105
  v_cvt_pk_bf16_f32 v195, v106, v107
  s_mov_b32 s75, s65
  buffer_store_dwordx4 v[192:195], v18, s[44:47], s75 offen sc1
  v_cvt_pk_bf16_f32 v196, v100, v101
  v_cvt_pk_bf16_f32 v197, v102, v103
  v_cvt_pk_bf16_f32 v198, v108, v109
  v_cvt_pk_bf16_f32 v199, v110, v111
  v_and_or_b32 v196, v196, v43, v42
  v_and_or_b32 v197, v197, v43, v42
  v_and_or_b32 v198, v198, v43, v42
  v_and_or_b32 v199, v199, v43, v42
  s_add_u32 s75, s65, s67
  s_add_u32 s65, s65, s66
  buffer_store_dwordx4 v[196:199], v18, s[44:47], s75 offen sc1
  v_cvt_pk_bf16_f32 v200, v112, v113
  v_cvt_pk_bf16_f32 v201, v114, v115
  v_cvt_pk_bf16_f32 v202, v120, v121
  v_cvt_pk_bf16_f32 v203, v122, v123
  s_mov_b32 s75, s65
  buffer_store_dwordx4 v[200:203], v18, s[44:47], s75 offen sc1
  v_cvt_pk_bf16_f32 v204, v116, v117
  v_cvt_pk_bf16_f32 v205, v118, v119
  v_cvt_pk_bf16_f32 v206, v124, v125
  v_cvt_pk_bf16_f32 v207, v126, v127
  v_and_or_b32 v204, v204, v43, v42
  v_and_or_b32 v205, v205, v43, v42
  v_and_or_b32 v206, v206, v43, v42
  v_and_or_b32 v207, v207, v43, v42
  s_add_u32 s75, s65, s67
  s_add_u32 s65, s65, s66
  buffer_store_dwordx4 v[204:207], v18, s[44:47], s75 offen sc1
  v_mov_b32 v45, 0
  s_movk_i32 s71, 16
  s_mov_b64 exec, 1
  s_mov_b32 s70, 0
SP_5:
  buffer_load_dword v44, v45, s[52:55], 0 offen sc1
  s_waitcnt vmcnt(0)
  v_cmp_gt_u32 vcc, s71, v44
  s_cbranch_vccz SD_6
  s_sleep 4
  s_add_u32 s70, s70, 1
  s_cmp_lt_u32 s70, 539568
  s_cbranch_scc1 SP_5
  s_endpgm
SD_6:
  s_mov_b64 exec, -1
  s_barrier
  s_mov_b64 exec, 1
  v_mov_b32 v20, 1
  buffer_store_dword v20, v21, s[32:35], 0 offen sc1
  s_mov_b64 exec, -1
  s_add_u32 s75, s73, 0
  s_add_u32 m0, s74, 0
  s_nop 0
  buffer_load_dwordx4 v2, s[36:39], s75 offen lds
  s_add_u32 s75, s73, 0
  s_add_u32 m0, s74, 1024
  s_nop 0
  buffer_load_dwordx4 v3, s[36:39], s75 offen lds
  s_add_u32 s75, s73, 0
  s_add_u32 m0, s74, 2048
  s_nop 0
  buffer_load_dwordx4 v4, s[36:39], s75 offen lds
  s_add_u32 s75, s73, 0
  s_add_u32 m0, s74, 3072
  s_nop 0
  buffer_load_dwordx4 v5, s[36:39], s75 offen lds
  s_add_u32 s75, s73, 20480
  s_add_u32 m0, s74, 4096
  s_nop 0
  buffer_load_dwordx4 v2, s[36:39], s75 offen lds
  s_add_u32 s75, s73, 20480
  s_add_u32 m0, s74, 5120
  s_nop 0
  buffer_load_dwordx4 v3, s[36:39], s75 offen lds
  s_add_u32 s75, s73, 20480
  s_add_u32 m0, s74, 6144
  s_nop 0
  buffer_load_dwordx4 v4, s[36:39], s75 offen lds
  s_add_u32 s75, s73, 20480
  s_add_u32 m0, s74, 7168
  s_nop 0
  buffer_load_dwordx4 v5, s[36:39], s75 offen lds
  s_add_u32 s75, s73, 256
  s_add_u32 m0, s74, 32768
  s_nop 0
  buffer_load_dwordx4 v2, s[36:39], s75 offen lds
  s_add_u32 s75, s73, 256
  s_add_u32 m0, s74, 33792
  s_nop 0
  buffer_load_dwordx4 v3, s[36:39], s75 offen lds
  s_add_u32 s75, s73, 256
  s_add_u32 m0, s74, 34816
  s_nop 0
  buffer_load_dwordx4 v4, s[36:39], s75 offen lds
  s_add_u32 s75, s73, 256
  s_add_u32 m0, s74, 35840
  s_nop 0
  buffer_load_dwordx4 v5, s[36:39], s75 offen lds
  s_add_u32 s75, s73, 20736
  s_add_u32 m0, s74, 36864
  s_nop 0
  buffer_load_dwordx4 v2, s[36:39], s75 offen lds
  s_add_u32 s75, s73, 20736
  s_add_u32 m0, s74, 37888
  s_nop 0
  buffer_load_dwordx4 v3, s[36:39], s75 offen lds
  s_add_u32 s75, s73, 20736
  s_add_u32 m0, s74, 38912
  s_nop 0
  buffer_load_dwordx4 v4, s[36:39], s75 offen lds
  s_add_u32 s75, s73, 20736
  s_add_u32 m0, s74, 39936
  s_nop 0
  buffer_load_dwordx4 v5, s[36:39], s75 offen lds
  s_add_u32 s75, s73, 512
  s_add_u32 m0, s74, 65536
  s_nop 0
  buffer_load_dwordx4 v2, s[36:39], s75 offen lds
  s_add_u32 s75, s73, 512
  s_add_u32 m0, s74, 66560
  s_nop 0
  buffer_load_dwordx4 v3, s[36:39], s75 offen lds
  s_add_u32 s75, s73, 512
  s_add_u32 m0, s74, 67584
  s_nop 0
  buffer_load_dwordx4 v4, s[36:39], s75 offen lds
  s_add_u32 s75, s73, 512
  s_add_u32 m0, s74, 68608
  s_nop 0
  buffer_load_dwordx4 v5, s[36:39], s75 offen lds
  s_add_u32 s75, s73, 20992
  s_add_u32 m0, s74, 69632
  s_nop 0
  buffer_load_dwordx4 v2, s[36:39], s75 offen lds
  s_add_u32 s75, s73, 20992
  s_add_u32 m0, s74, 70656
  s_nop 0
  buffer_load_dwordx4 v3, s[36:39], s75 offen lds
  s_add_u32 s75, s73, 20992
  s_add_u32 m0, s74, 71680
  s_nop 0
  buffer_load_dwordx4 v4, s[36:39], s75 offen lds
  s_add_u32 s75, s73, 20992
  s_add_u32 m0, s74, 72704
  s_nop 0
  buffer_load_dwordx4 v5, s[36:39], s75 offen lds
  s_add_u32 s75, s73, 768
  s_add_u32 m0, s74, 98304
  s_nop 0
  buffer_load_dwordx4 v2, s[36:39], s75 offen lds
  s_add_u32 s75, s73, 768
  s_add_u32 m0, s74, 99328
  s_nop 0
  buffer_load_dwordx4 v3, s[36:39], s75 offen lds
  s_add_u32 s75, s73, 768
  s_add_u32 m0, s74, 100352
  s_nop 0
  buffer_load_dwordx4 v4, s[36:39], s75 offen lds
  s_add_u32 s75, s73, 768
  s_add_u32 m0, s74, 101376
  s_nop 0
  buffer_load_dwordx4 v5, s[36:39], s75 offen lds
  s_add_u32 s75, s73, 21248
  s_add_u32 m0, s74, 102400
  s_nop 0
  buffer_load_dwordx4 v2, s[36:39], s75 offen lds
  s_add_u32 s75, s73, 21248
  s_add_u32 m0, s74, 103424
  s_nop 0
  buffer_load_dwordx4 v3, s[36:39], s75 offen lds
  s_add_u32 s75, s73, 21248
  s_add_u32 m0, s74, 104448
  s_nop 0
  buffer_load_dwordx4 v4, s[36:39], s75 offen lds
  s_add_u32 s75, s73, 21248
  s_add_u32 m0, s74, 105472
  s_nop 0
  buffer_load_dwordx4 v5, s[36:39], s75 offen lds
  s_mov_b32 s72, s73
  s_add_u32 s73, s73, 163840
  s_mov_b32 s79, 1
  s_waitcnt vmcnt(24)
  s_barrier
  s_cmp_le_u32 s69, 1
  s_cbranch_scc1 L_a2
  ds_read_b128 v[128:131], v30 offset:0
  ds_read_b128 v[132:135], v30 offset:4096
  ds_read_b128 v[136:139], v30 offset:8192
  ds_read_b128 v[140:143], v30 offset:12288
  ds_read_b128 v[144:147], v30 offset:16384
  ds_read_b128 v[148:151], v30 offset:20480
  ds_read_b128 v[152:155], v30 offset:24576
  ds_read_b128 v[156:159], v30 offset:28672
PWL_4:
  s_waitcnt lgkmcnt(7)
  v_mfma_f32_16x16x32_bf16 v[64:67], v[128:131], a[0:3], 0
  v_mfma_f32_16x16x32_bf16 v[68:71], v[128:131], a[4:7], 0
  ds_read_b128 v[160:163], v31 offset:0
  s_waitcnt lgkmcnt(7)
  v_mfma_f32_16x16x32_bf16 v[72:75], v[132:135], a[0:3], 0
  v_mfma_f32_16x16x32_bf16 v[76:79], v[132:135], a[4:7], 0
  ds_read_b128 v[164:167], v31 offset:4096
  s_waitcnt lgkmcnt(7)
  v_mfma_f32_16x16x32_bf16 v[80:83], v[136:139], a[0:3], 0
  v_mfma_f32_16x16x32_bf16 v[84:87], v[136:139], a[4:7], 0
  ds_read_b128 v[168:171], v31 offset:8192
  s_add_u32 s75, s72, 768
  s_add_u32 m0, s74, 100352
  s_nop 0
  buffer_load_dwordx4 v4, s[36:39], s75 offen lds
  s_waitcnt lgkmcnt(7)
  v_mfma_f32_16x16x32_bf16 v[88:91], v[140:143], a[0:3], 0
  v_mfma_f32_16x16x32_bf16 v[92:95], v[140:143], a[4:7], 0
  ds_read_b128 v[172:175], v31 offset:12288
  s_waitcnt lgkmcnt(7)
  v_mfma_f32_16x16x32_bf16 v[96:99], v[144:147], a[0:3], 0
  v_mfma_f32_16x16x32_bf16 v[100:103], v[144:147], a[4:7], 0
  ds_read_b128 v[176:179], v31 offset:16384
  s_waitcnt lgkmcnt(7)
  v_mfma_f32_16x16x32_bf16 v[104:107], v[148:151], a[0:3], 0
  v_mfma_f32_16x16x32_bf16 v[108:111], v[148:151], a[4:7], 0
  ds_read_b128 v[180:183], v31 offset:20480
  s_waitcnt lgkmcnt(7)
  v_mfma_f32_16x16x32_bf16 v[112:115], v[152:155], a[0:3], 0
  v_mfma_f32_16x16x32_bf16 v[116:119], v[152:155], a[4:7], 0
  ds_read_b128 v[184:187], v31 offset:24576
  s_add_u32 s75, s72, 768
  s_add_u32 m0, s74, 101376
  s_nop 0
  buffer_load_dwordx4 v5, s[36:39], s75 offen lds
  s_waitcnt lgkmcnt(7)
  v_mfma_f32_16x16x32_bf16 v[120:123], v[156:159], a[0:3], 0
  v_mfma_f32_16x16x32_bf16 v[124:127], v[156:159], a[4:7], 0
  ds_read_b128 v[188:191], v31 offset:28672
  s_waitcnt lgkmcnt(7)
  v_mfma_f32_16x16x32_bf16 v[64:67], v[160:163], a[8:11], v[64:67]
  v_mfma_f32_16x16x32_bf16 v[68:71], v[160:163], a[12:15], v[68:71]
  ds_read_b128 v[128:131], v32 offset:0
  s_waitcnt lgkmcnt(7)
  v_mfma_f32_16x16x32_bf16 v[72:75], v[164:167], a[8:11], v[72:75]
  v_mfma_f32_16x16x32_bf16 v[76:79], v[164:167], a[12:15], v[76:79]
  ds_read_b128 v[132:135], v32 offset:4096
  s_waitcnt lgkmcnt(7)
  v_mfma_f32_16x16x32_bf16 v[80:83], v[168:171], a[8:11], v[80:83]
  v_mfma_f32_16x16x32_bf16 v[84:87], v[168:171], a[12:15], v[84:87]
  ds_read_b128 v[136:139], v32 offset:8192
  s_add_u32 s75, s72, 21248
  s_add_u32 m0, s74, 102400
  s_nop 0
  buffer_load_dwordx4 v2, s[36:39], s75 offen lds
  s_waitcnt lgkmcnt(7)
  v_mfma_f32_16x16x32_bf16 v[88:91], v[172:175], a[8:11], v[88:91]
  v_mfma_f32_16x16x32_bf16 v[92:95], v[172:175], a[12:15], v[92:95]
  ds_read_b128 v[140:143], v32 offset:12288
  s_waitcnt lgkmcnt(7)
  v_mfma_f32_16x16x32_bf16 v[96:99], v[176:179], a[8:11], v[96:99]
  v_mfma_f32_16x16x32_bf16 v[100:103], v[176:179], a[12:15], v[100:103]
  ds_read_b128 v[144:147], v32 offset:16384
  s_waitcnt lgkmcnt(7)
  v_mfma_f32_16x16x32_bf16 v[104:107], v[180:183], a[8:11], v[104:107]
  v_mfma_f32_16x16x32_bf16 v[108:111], v[180:183], a[12:15], v[108:111]
  ds_read_b128 v[148:151], v32 offset:20480
  s_waitcnt lgkmcnt(7)
  v_mfma_f32_16x16x32_bf16 v[112:115], v[184:187], a[8:11], v[112:115]
  v_mfma_f32_16x16x32_bf16 v[116:119], v[184:187], a[12:15], v[116:119]
  ds_read_b128 v[152:155], v32 offset:24576
  s_add_u32 s75, s72, 21248
  s_add_u32 m0, s74, 103424
  s_nop 0
  buffer_load_dwordx4 v3, s[36:39], s75 offen lds
  s_waitcnt lgkmcnt(7)
  v_mfma_f32_16x16x32_bf16 v[120:123], v[188:191], a[8:11], v[120:123]
  v_mfma_f32_16x16x32_bf16 v[124:127], v[188:191], a[12:15], v[124:127]
  ds_read_b128 v[156:159], v32 offset:28672
  s_waitcnt lgkmcnt(7)
  v_mfma_f32_16x16x32_bf16 v[64:67], v[128:131], a[16:19], v[64:67]
  v_mfma_f32_16x16x32_bf16 v[68:71], v[128:131], a[20:23], v[68:71]
  ds_read_b128 v[160:163], v33 offset:0
  s_waitcnt lgkmcnt(7)
  v_mfma_f32_16x16x32_bf16 v[72:75], v[132:135], a[16:19], v[72:75]
  v_mfma_f32_16x16x32_bf16 v[76:79], v[132:135], a[20:23], v[76:79]
  ds_read_b128 v[164:167], v33 offset:4096
  s_waitcnt lgkmcnt(7)
  v_mfma_f32_16x16x32_bf16 v[80:83], v[136:139], a[16:19], v[80:83]
  v_mfma_f32_16x16x32_bf16 v[84:87], v[136:139], a[20:23], v[84:87]
  ds_read_b128 v[168:171], v33 offset:8192
  s_add_u32 s75, s72, 21248
  s_add_u32 m0, s74, 104448
  s_nop 0
  buffer_load_dwordx4 v4, s[36:39], s75 offen lds
  s_waitcnt lgkmcnt(7)
  v_mfma_f32_16x16x32_bf16 v[88:91], v[140:143], a[16:19], v[88:91]
  v_mfma_f32_16x16x32_bf16 v[92:95], v[140:143], a[20:23], v[92:95]
  ds_read_b128 v[172:175], v33 offset:12288
  s_waitcnt lgkmcnt(7)
  v_mfma_f32_16x16x32_bf16 v[96:99], v[144:147], a[16:19], v[96:99]
  v_mfma_f32_16x16x32_bf16 v[100:103], v[144:147], a[20:23], v[100:103]
  ds_read_b128 v[176:179], v33 offset:16384
  s_waitcnt lgkmcnt(7)
  v_mfma_f32_16x16x32_bf16 v[104:107], v[148:151], a[16:19], v[104:107]
  v_mfma_f32_16x16x32_bf16 v[108:111], v[148:151], a[20:23], v[108:111]
  ds_read_b128 v[180:183], v33 offset:20480
  s_waitcnt lgkmcnt(7)
  v_mfma_f32_16x16x32_bf16 v[112:115], v[152:155], a[16:19], v[112:115]
  v_mfma_f32_16x16x32_bf16 v[116:119], v[152:155], a[20:23], v[116:119]
  ds_read_b128 v[184:187], v33 offset:24576
  s_add_u32 s75, s72, 21248
  s_add_u32 m0, s74, 105472
  s_nop 0
  buffer_load_dwordx4 v5, s[36:39], s75 offen lds
  s_waitcnt lgkmcnt(7)
  v_mfma_f32_16x16x32_bf16 v[120:123], v[156:159], a[16:19], v[120:123]
  v_mfma_f32_16x16x32_bf16 v[124:127], v[156:159], a[20:23], v[124:127]
  ds_read_b128 v[188:191], v33 offset:28672
  s_waitcnt vmcnt(16)
  s_barrier
  s_waitcnt lgkmcnt(7)
  v_mfma_f32_16x16x32_bf16 v[64:67], v[160:163], a[24:27], v[64:67]
  v_mfma_f32_16x16x32_bf16 v[68:71], v[160:163], a[28:31], v[68:71]
  ds_read_b128 v[128:131], v30 offset:32768
  s_waitcnt lgkmcnt(7)
  v_mfma_f32_16x16x32_bf16 v[72:75], v[164:167], a[24:27], v[72:75]
  v_mfma_f32_16x16x32_bf16 v[76:79], v[164:167], a[28:31], v[76:79]
  ds_read_b128 v[132:135], v30 offset:36864
  s_waitcnt lgkmcnt(7)
  v_mfma_f32_16x16x32_bf16 v[80:83], v[168:171], a[24:27], v[80:83]
  v_mfma_f32_16x16x32_bf16 v[84:87], v[168:171], a[28:31], v[84:87]
  ds_read_b128 v[136:139], v30 offset:40960
  s_add_u32 s75, s72, 1024
  s_add_u32 m0, s74, 131072
  s_nop 0
  buffer_load_dwordx4 v2, s[36:39], s75 offen lds
  s_waitcnt lgkmcnt(7)
  v_mfma_f32_16x16x32_bf16 v[88:91], v[172:175], a[24:27], v[88:91]
  v_mfma_f32_16x16x32_bf16 v[92:95], v[172:175], a[28:31], v[92:95]
  ds_read_b128 v[140:143], v30 offset:45056
  s_waitcnt lgkmcnt(7)
  v_mfma_f32_16x16x32_bf16 v[96:99], v[176:179], a[24:27], v[96:99]
  v_mfma_f32_16x16x32_bf16 v[100:103], v[176:179], a[28:31], v[100:103]
  ds_read_b128 v[144:147], v30 offset:49152
  s_waitcnt lgkmcnt(7)
  v_mfma_f32_16x16x32_bf16 v[104:107], v[180:183], a[24:27], v[104:107]
  v_mfma_f32_16x16x32_bf16 v[108:111], v[180:183], a[28:31], v[108:111]
  ds_read_b128 v[148:151], v30 offset:53248
  s_waitcnt lgkmcnt(7)
  v_mfma_f32_16x16x32_bf16 v[112:115], v[184:187], a[24:27], v[112:115]
  v_mfma_f32_16x16x32_bf16 v[116:119], v[184:187], a[28:31], v[116:119]
  ds_read_b128 v[152:155], v30 offset:57344
  s_add_u32 s75, s72, 1024
  s_add_u32 m0, s74, 132096
  s_nop 0
  buffer_load_dwordx4 v3, s[36:39], s75 offen lds
  s_waitcnt lgkmcnt(7)
  v_mfma_f32_16x16x32_bf16 v[120:123], v[188:191], a[24:27], v[120:123]
  v_mfma_f32_16x16x32_bf16 v[124:127], v[188:191], a[28:31], v[124:127]
  ds_read_b128 v[156:159], v30 offset:61440
  s_waitcnt lgkmcnt(7)
  v_mfma_f32_16x16x32_bf16 v[64:67], v[128:131], a[32:35], v[64:67]
  v_mfma_f32_16x16x32_bf16 v[68:71], v[128:131], a[36:39], v[68:71]
  ds_read_b128 v[160:163], v31 offset:32768
  buffer_load_dwordx4 v[208:211], v46, s[36:39], s85 offen
  s_add_u32 s85, s85, 1024
  s_waitcnt lgkmcnt(7)
  v_mfma_f32_16x16x32_bf16 v[72:75], v[132:135], a[32:35], v[72:75]
  v_mfma_f32_16x16x32_bf16 v[76:79], v[132:135], a[36:39], v[76:79]
  ds_read_b128 v[164:167], v31 offset:36864
  buffer_load_dwordx4 v[212:215], v46, s[36:39], s85 offen
  s_add_u32 s85, s85, 1024
  s_waitcnt lgkmcnt(7)
  v_mfma_f32_16x16x32_bf16 v[80:83], v[136:139], a[32:35], v[80:83]
  v_mfma_f32_16x16x32_bf16 v[84:87], v[136:139], a[36:39], v[84:87]
  ds_read_b128 v[168:171], v31 offset:40960
  s_add_u32 s75, s72, 1024
  s_add_u32 m0, s74, 133120
  s_nop 0
  buffer_load_dwordx4 v4, s[36:39], s75 offen lds
  buffer_load_dwordx4 v[216:219], v46, s[36:39], s85 offen
  s_add_u32 s85, s85, 1024
  s_waitcnt lgkmcnt(7)
  v_mfma_f32_16x16x32_bf16 v[88:91], v[140:143], a[32:35], v[88:91]
  v_mfma_f32_16x16x32_bf16 v[92:95], v[140:143], a[36:39], v[92:95]
  ds_read_b128 v[172:175], v31 offset:45056
  buffer_load_dwordx4 v[220:223], v46, s[36:39], s85 offen
  s_add_u32 s85, s85, 1024
  s_waitcnt lgkmcnt(7)
  v_mfma_f32_16x16x32_bf16 v[96:99], v[144:147], a[32:35], v[96:99]
  v_mfma_f32_16x16x32_bf16 v[100:103], v[144:147], a[36:39], v[100:103]
  ds_read_b128 v[176:179], v31 offset:49152
  buffer_load_dwordx4 v[224:227], v46, s[36:39], s85 offen
  s_add_u32 s85, s85, 1024
  s_waitcnt lgkmcnt(7)
  v_mfma_f32_16x16x32_bf16 v[104:107], v[148:151], a[32:35], v[104:107]
  v_mfma_f32_16x16x32_bf16 v[108:111], v[148:151], a[36:39], v[108:111]
  ds_read_b128 v[180:183], v31 offset:53248
  buffer_load_dwordx4 v[228:231], v46, s[36:39], s85 offen
  s_add_u32 s85, s85, 1024
  s_waitcnt lgkmcnt(7)
  v_mfma_f32_16x16x32_bf16 v[112:115], v[152:155], a[32:35], v[112:115]
  v_mfma_f32_16x16x32_bf16 v[116:119], v[152:155], a[36:39], v[116:119]
  ds_read_b128 v[184:187], v31 offset:57344
  s_add_u32 s75, s72, 1024
  s_add_u32 m0, s74, 134144
  s_nop 0
  buffer_load_dwordx4 v5, s[36:39], s75 offen lds
  buffer_load_dwordx4 v[232:235], v46, s[36:39], s85 offen
  s_add_u32 s85, s85, 157696
  s_waitcnt lgkmcnt(7)
  v_mfma_f32_16x16x32_bf16 v[120:123], v[156:159], a[32:35], v[120:123]
  v_mfma_f32_16x16x32_bf16 v[124:127], v[156:159], a[36:39], v[124:127]
  ds_read_b128 v[188:191], v31 offset:61440
  s_waitcnt lgkmcnt(7)
  v_mfma_f32_16x16x32_bf16 v[64:67], v[160:163], a[40:43], v[64:67]
  v_mfma_f32_16x16x32_bf16 v[68:71], v[160:163], a[44:47], v[68:71]
  ds_read_b128 v[128:131], v32 offset:32768
  s_waitcnt lgkmcnt(7)
  v_mfma_f32_16x16x32_bf16 v[72:75], v[164:167], a[40:43], v[72:75]
  v_mfma_f32_16x16x32_bf16 v[76:79], v[164:167], a[44:47], v[76:79]
  ds_read_b128 v[132:135], v32 offset:36864
  s_waitcnt lgkmcnt(7)
  v_mfma_f32_16x16x32_bf16 v[80:83], v[168:171], a[40:43], v[80:83]
  v_mfma_f32_16x16x32_bf16 v[84:87], v[168:171], a[44:47], v[84:87]
  ds_read_b128 v[136:139], v32 offset:40960
  s_add_u32 s75, s72, 21504
  s_add_u32 m0, s74, 135168
  s_nop 0
  buffer_load_dwordx4 v2, s[36:39], s75 offen lds
  s_waitcnt lgkmcnt(7)
  v_mfma_f32_16x16x32_bf16 v[88:91], v[172:175], a[40:43], v[88:91]
  v_mfma_f32_16x16x32_bf16 v[92:95], v[172:175], a[44:47], v[92:95]
  ds_read_b128 v[140:143], v32 offset:45056
  s_waitcnt lgkmcnt(7)
  v_mfma_f32_16x16x32_bf16 v[96:99], v[176:179], a[40:43], v[96:99]
  v_mfma_f32_16x16x32_bf16 v[100:103], v[176:179], a[44:47], v[100:103]
  ds_read_b128 v[144:147], v32 offset:49152
  s_waitcnt lgkmcnt(7)
  v_mfma_f32_16x16x32_bf16 v[104:107], v[180:183], a[40:43], v[104:107]
  v_mfma_f32_16x16x32_bf16 v[108:111], v[180:183], a[44:47], v[108:111]
  ds_read_b128 v[148:151], v32 offset:53248
  s_waitcnt lgkmcnt(7)
  v_mfma_f32_16x16x32_bf16 v[112:115], v[184:187], a[40:43], v[112:115]
  v_mfma_f32_16x16x32_bf16 v[116:119], v[184:187], a[44:47], v[116:119]
  ds_read_b128 v[152:155], v32 offset:57344
  s_add_u32 s75, s72, 21504
  s_add_u32 m0, s74, 136192
  s_nop 0
  buffer_load_dwordx4 v3, s[36:39], s75 offen lds
  s_waitcnt lgkmcnt(7)
  v_mfma_f32_16x16x32_bf16 v[120:123], v[188:191], a[40:43], v[120:123]
  v_mfma_f32_16x16x32_bf16 v[124:127], v[188:191], a[44:47], v[124:127]
  ds_read_b128 v[156:159], v32 offset:61440
  s_waitcnt lgkmcnt(7)
  v_mfma_f32_16x16x32_bf16 v[64:67], v[128:131], a[48:51], v[64:67]
  v_mfma_f32_16x16x32_bf16 v[68:71], v[128:131], a[52:55], v[68:71]
  ds_read_b128 v[160:163], v33 offset:32768
  s_waitcnt lgkmcnt(7)
  v_mfma_f32_16x16x32_bf16 v[72:75], v[132:135], a[48:51], v[72:75]
  v_mfma_f32_16x16x32_bf16 v[76:79], v[132:135], a[52:55], v[76:79]
  ds_read_b128 v[164:167], v33 offset:36864
  s_waitcnt lgkmcnt(7)
  v_mfma_f32_16x16x32_bf16 v[80:83], v[136:139], a[48:51], v[80:83]
  v_mfma_f32_16x16x32_bf16 v[84:87], v[136:139], a[52:55], v[84:87]
  ds_read_b128 v[168:171], v33 offset:40960
  s_add_u32 s75, s72, 21504
  s_add_u32 m0, s74, 137216
  s_nop 0
  buffer_load_dwordx4 v4, s[36:39], s75 offen lds
  s_waitcnt lgkmcnt(7)
  v_mfma_f32_16x16x32_bf16 v[88:91], v[140:143], a[48:51], v[88:91]
  v_mfma_f32_16x16x32_bf16 v[92:95], v[140:143], a[52:55], v[92:95]
  ds_read_b128 v[172:175], v33 offset:45056
  s_waitcnt lgkmcnt(7)
  v_mfma_f32_16x16x32_bf16 v[96:99], v[144:147], a[48:51], v[96:99]
  v_mfma_f32_16x16x32_bf16 v[100:103], v[144:147], a[52:55], v[100:103]
  ds_read_b128 v[176:179], v33 offset:49152
  s_waitcnt lgkmcnt(7)
  v_mfma_f32_16x16x32_bf16 v[104:107], v[148:151], a[48:51], v[104:107]
  v_mfma_f32_16x16x32_bf16 v[108:111], v[148:151], a[52:55], v[108:111]
  ds_read_b128 v[180:183], v33 offset:53248
  s_waitcnt lgkmcnt(7)
  v_mfma_f32_16x16x32_bf16 v[112:115], v[152:155], a[48:51], v[112:115]
  v_mfma_f32_16x16x32_bf16 v[116:119], v[152:155], a[52:55], v[116:119]
  ds_read_b128 v[184:187], v33 offset:57344
  s_add_u32 s75, s72, 21504
  s_add_u32 m0, s74, 138240
  s_nop 0
  buffer_load_dwordx4 v5, s[36:39], s75 offen lds
  s_waitcnt lgkmcnt(7)
  v_mfma_f32_16x16x32_bf16 v[120:123], v[156:159], a[48:51], v[120:123]
  v_mfma_f32_16x16x32_bf16 v[124:127], v[156:159], a[52:55], v[124:127]
  ds_read_b128 v[188:191], v33 offset:61440
  s_waitcnt vmcnt(23)
  s_barrier
  s_waitcnt lgkmcnt(7)
  v_mfma_f32_16x16x32_bf16 v[64:67], v[160:163], a[56:59], v[64:67]
  v_mfma_f32_16x16x32_bf16 v[68:71], v[160:163], a[60:63], v[68:71]
  ds_read_b128 v[128:131], v34 offset:0
  s_waitcnt lgkmcnt(7)
  v_mfma_f32_16x16x32_bf16 v[72:75], v[164:167], a[56:59], v[72:75]
  v_mfma_f32_16x16x32_bf16 v[76:79], v[164:167], a[60:63], v[76:79]
  ds_read_b128 v[132:135], v34 offset:4096
  s_waitcnt lgkmcnt(7)
  v_mfma_f32_16x16x32_bf16 v[80:83], v[168:171], a[56:59], v[80:83]
  v_mfma_f32_16x16x32_bf16 v[84:87], v[168:171], a[60:63], v[84:87]
  ds_read_b128 v[136:139], v34 offset:8192
  s_add_u32 s75, s73, 0
  s_add_u32 m0, s74, 0
  s_nop 0
  buffer_load_dwordx4 v2, s[36:39], s75 offen lds
  s_waitcnt lgkmcnt(7)
  v_mfma_f32_16x16x32_bf16 v[88:91], v[172:175], a[56:59], v[88:91]
  v_mfma_f32_16x16x32_bf16 v[92:95], v[172:175], a[60:63], v[92:95]
  ds_read_b128 v[140:143], v34 offset:12288
  s_waitcnt lgkmcnt(7)
  v_mfma_f32_16x16x32_bf16 v[96:99], v[176:179], a[56:59], v[96:99]
  v_mfma_f32_16x16x32_bf16 v[100:103], v[176:179], a[60:63], v[100:103]
  ds_read_b128 v[144:147], v34 offset:16384
  s_waitcnt lgkmcnt(7)
  v_mfma_f32_16x16x32_bf16 v[104:107], v[180:183], a[56:59], v[104:107]
  v_mfma_f32_16x16x32_bf16 v[108:111], v[180:183], a[60:63], v[108:111]
  ds_read_b128 v[148:151], v34 offset:20480
  s_waitcnt lgkmcnt(7)
  v_mfma_f32_16x16x32_bf16 v[112:115], v[184:187], a[56:59], v[112:115]
  v_mfma_f32_16x16x32_bf16 v[116:119], v[184:187], a[60:63], v[116:119]
  ds_read_b128 v[152:155], v34 offset:24576
  s_add_u32 s75, s73, 0
  s_add_u32 m0, s74, 1024
  s_nop 0
  buffer_load_dwordx4 v3, s[36:39], s75 offen lds
  s_waitcnt lgkmcnt(7)
  v_mfma_f32_16x16x32_bf16 v[120:123], v[188:191], a[56:59], v[120:123]
  v_mfma_f32_16x16x32_bf16 v[124:127], v[188:191], a[60:63], v[124:127]
  ds_read_b128 v[156:159], v34 offset:28672
  s_waitcnt lgkmcnt(7)
  v_mfma_f32_16x16x32_bf16 v[64:67], v[128:131], a[64:67], v[64:67]
  v_mfma_f32_16x16x32_bf16 v[68:71], v[128:131], a[68:71], v[68:71]
  ds_read_b128 v[160:163], v35 offset:0
  s_waitcnt lgkmcnt(7)
  v_mfma_f32_16x16x32_bf16 v[72:75], v[132:135], a[64:67], v[72:75]
  v_mfma_f32_16x16x32_bf16 v[76:79], v[132:135], a[68:71], v[76:79]
  ds_read_b128 v[164:167], v35 offset:4096
  s_waitcnt lgkmcnt(7)
  v_mfma_f32_16x16x32_bf16 v[80:83], v[136:139], a[64:67], v[80:83]
  v_mfma_f32_16x16x32_bf16 v[84:87], v[136:139], a[68:71], v[84:87]
  ds_read_b128 v[168:171], v35 offset:8192
  s_add_u32 s75, s73, 0
  s_add_u32 m0, s74, 2048
  s_nop 0
  buffer_load_dwordx4 v4, s[36:39], s75 offen lds
  s_waitcnt lgkmcnt(7)
  v_mfma_f32_16x16x32_bf16 v[88:91], v[140:143], a[64:67], v[88:91]
  v_mfma_f32_16x16x32_bf16 v[92:95], v[140:143], a[68:71], v[92:95]
  ds_read_b128 v[172:175], v35 offset:12288
  s_waitcnt lgkmcnt(7)
  v_mfma_f32_16x16x32_bf16 v[96:99], v[144:147], a[64:67], v[96:99]
  v_mfma_f32_16x16x32_bf16 v[100:103], v[144:147], a[68:71], v[100:103]
  ds_read_b128 v[176:179], v35 offset:16384
  s_waitcnt lgkmcnt(7)
  v_mfma_f32_16x16x32_bf16 v[104:107], v[148:151], a[64:67], v[104:107]
  v_mfma_f32_16x16x32_bf16 v[108:111], v[148:151], a[68:71], v[108:111]
  ds_read_b128 v[180:183], v35 offset:20480
  s_waitcnt lgkmcnt(7)
  v_mfma_f32_16x16x32_bf16 v[112:115], v[152:155], a[64:67], v[112:115]
  v_mfma_f32_16x16x32_bf16 v[116:119], v[152:155], a[68:71], v[116:119]
  ds_read_b128 v[184:187], v35 offset:24576
  s_add_u32 s75, s73, 0
  s_add_u32 m0, s74, 3072
  s_nop 0
  buffer_load_dwordx4 v5, s[36:39], s75 offen lds
  s_waitcnt lgkmcnt(7)
  v_mfma_f32_16x16x32_bf16 v[120:123], v[156:159], a[64:67], v[120:123]
  v_mfma_f32_16x16x32_bf16 v[124:127], v[156:159], a[68:71], v[124:127]
  ds_read_b128 v[188:191], v35 offset:28672
  s_waitcnt lgkmcnt(7)
  v_mfma_f32_16x16x32_bf16 v[64:67], v[160:163], a[72:75], v[64:67]
  v_mfma_f32_16x16x32_bf16 v[68:71], v[160:163], a[76:79], v[68:71]
  ds_read_b128 v[128:131], v36 offset:0
  s_waitcnt lgkmcnt(7)
  v_mfma_f32_16x16x32_bf16 v[72:75], v[164:167], a[72:75], v[72:75]
  v_mfma_f32_16x16x32_bf16 v[76:79], v[164:167], a[76:79], v[76:79]
  ds_read_b128 v[132:135], v36 offset:4096
  s_waitcnt lgkmcnt(7)
  v_mfma_f32_16x16x32_bf16 v[80:83], v[168:171], a[72:75], v[80:83]
  v_mfma_f32_16x16x32_bf16 v[84:87], v[168:171], a[76:79], v[84:87]
  ds_read_b128 v[136:139], v36 offset:8192
  s_add_u32 s75, s73, 20480
  s_add_u32 m0, s74, 4096
  s_nop 0
  buffer_load_dwordx4 v2, s[36:39], s75 offen lds
  s_waitcnt lgkmcnt(7)
  v_mfma_f32_16x16x32_bf16 v[88:91], v[172:175], a[72:75], v[88:91]
  v_mfma_f32_16x16x32_bf16 v[92:95], v[172:175], a[76:79], v[92:95]
  ds_read_b128 v[140:143], v36 offset:12288
  s_waitcnt lgkmcnt(7)
  v_mfma_f32_16x16x32_bf16 v[96:99], v[176:179], a[72:75], v[96:99]
  v_mfma_f32_16x16x32_bf16 v[100:103], v[176:179], a[76:79], v[100:103]
  ds_read_b128 v[144:147], v36 offset:16384
  s_waitcnt lgkmcnt(7)
  v_mfma_f32_16x16x32_bf16 v[104:107], v[180:183], a[72:75], v[104:107]
  v_mfma_f32_16x16x32_bf16 v[108:111], v[180:183], a[76:79], v[108:111]
  ds_read_b128 v[148:151], v36 offset:20480
  s_waitcnt lgkmcnt(7)
  v_mfma_f32_16x16x32_bf16 v[112:115], v[184:187], a[72:75], v[112:115]
  v_mfma_f32_16x16x32_bf16 v[116:119], v[184:187], a[76:79], v[116:119]
  ds_read_b128 v[152:155], v36 offset:24576
  s_add_u32 s75, s73, 20480
  s_add_u32 m0, s74, 5120
  s_nop 0
  buffer_load_dwordx4 v3, s[36:39], s75 offen lds
  s_waitcnt lgkmcnt(7)
  v_mfma_f32_16x16x32_bf16 v[120:123], v[188:191], a[72:75], v[120:123]
  v_mfma_f32_16x16x32_bf16 v[124:127], v[188:191], a[76:79], v[124:127]
  ds_read_b128 v[156:159], v36 offset:28672
  s_waitcnt lgkmcnt(7)
  v_mfma_f32_16x16x32_bf16 v[64:67], v[128:131], a[80:83], v[64:67]
  v_mfma_f32_16x16x32_bf16 v[68:71], v[128:131], a[84:87], v[68:71]
  ds_read_b128 v[160:163], v37 offset:0
  s_waitcnt lgkmcnt(7)
  v_mfma_f32_16x16x32_bf16 v[72:75], v[132:135], a[80:83], v[72:75]
  v_mfma_f32_16x16x32_bf16 v[76:79], v[132:135], a[84:87], v[76:79]
  ds_read_b128 v[164:167], v37 offset:4096
  s_waitcnt lgkmcnt(7)
  v_mfma_f32_16x16x32_bf16 v[80:83], v[136:139], a[80:83], v[80:83]
  v_mfma_f32_16x16x32_bf16 v[84:87], v[136:139], a[84:87], v[84:87]
  ds_read_b128 v[168:171], v37 offset:8192
  s_add_u32 s75, s73, 20480
  s_add_u32 m0, s74, 6144
  s_nop 0
  buffer_load_dwordx4 v4, s[36:39], s75 offen lds
  s_waitcnt lgkmcnt(7)
  v_mfma_f32_16x16x32_bf16 v[88:91], v[140:143], a[80:83], v[88:91]
  v_mfma_f32_16x16x32_bf16 v[92:95], v[140:143], a[84:87], v[92:95]
  ds_read_b128 v[172:175], v37 offset:12288
  s_waitcnt lgkmcnt(7)
  v_mfma_f32_16x16x32_bf16 v[96:99], v[144:147], a[80:83], v[96:99]
  v_mfma_f32_16x16x32_bf16 v[100:103], v[144:147], a[84:87], v[100:103]
  ds_read_b128 v[176:179], v37 offset:16384
  s_waitcnt lgkmcnt(7)
  v_mfma_f32_16x16x32_bf16 v[104:107], v[148:151], a[80:83], v[104:107]
  v_mfma_f32_16x16x32_bf16 v[108:111], v[148:151], a[84:87], v[108:111]
  ds_read_b128 v[180:183], v37 offset:20480
  s_waitcnt lgkmcnt(7)
  v_mfma_f32_16x16x32_bf16 v[112:115], v[152:155], a[80:83], v[112:115]
  v_mfma_f32_16x16x32_bf16 v[116:119], v[152:155], a[84:87], v[116:119]
  ds_read_b128 v[184:187], v37 offset:24576
  s_add_u32 s75, s73, 20480
  s_add_u32 m0, s74, 7168
  s_nop 0
  buffer_load_dwordx4 v5, s[36:39], s75 offen lds
  s_waitcnt lgkmcnt(7)
  v_mfma_f32_16x16x32_bf16 v[120:123], v[156:159], a[80:83], v[120:123]
  v_mfma_f32_16x16x32_bf16 v[124:127], v[156:159], a[84:87], v[124:127]
  ds_read_b128 v[188:191], v37 offset:28672
  s_waitcnt vmcnt(23)
  s_barrier
  s_mov_b64 exec, 1
  v_mov_b32 v20, s79
  buffer_store_dword v20, v21, s[32:35], 0 offen sc1
  s_mov_b64 exec, -1
  s_waitcnt lgkmcnt(7)
  v_mfma_f32_16x16x32_bf16 v[64:67], v[160:163], a[88:91], v[64:67]
  v_mfma_f32_16x16x32_bf16 v[68:71], v[160:163], a[92:95], v[68:71]
  ds_read_b128 v[128:131], v34 offset:32768
  s_waitcnt lgkmcnt(7)
  v_mfma_f32_16x16x32_bf16 v[72:75], v[164:167], a[88:91], v[72:75]
  v_mfma_f32_16x16x32_bf16 v[76:79], v[164:167], a[92:95], v[76:79]
  ds_read_b128 v[132:135], v34 offset:36864
  s_waitcnt lgkmcnt(7)
  v_mfma_f32_16x16x32_bf16 v[80:83], v[168:171], a[88:91], v[80:83]
  v_mfma_f32_16x16x32_bf16 v[84:87], v[168:171], a[92:95], v[84:87]
  ds_read_b128 v[136:139], v34 offset:40960
  s_add_u32 s75, s73, 256
  s_add_u32 m0, s74, 32768
  s_nop 0
  buffer_load_dwordx4 v2, s[36:39], s75 offen lds
  s_waitcnt lgkmcnt(7)
  v_mfma_f32_16x16x32_bf16 v[88:91], v[172:175], a[88:91], v[88:91]
  v_mfma_f32_16x16x32_bf16 v[92:95], v[172:175], a[92:95], v[92:95]
  ds_read_b128 v[140:143], v34 offset:45056
  s_waitcnt lgkmcnt(7)
  v_mfma_f32_16x16x32_bf16 v[96:99], v[176:179], a[88:91], v[96:99]
  v_mfma_f32_16x16x32_bf16 v[100:103], v[176:179], a[92:95], v[100:103]
  ds_read_b128 v[144:147], v34 offset:49152
  s_waitcnt lgkmcnt(7)
  v_mfma_f32_16x16x32_bf16 v[104:107], v[180:183], a[88:91], v[104:107]
  v_mfma_f32_16x16x32_bf16 v[108:111], v[180:183], a[92:95], v[108:111]
  ds_read_b128 v[148:151], v34 offset:53248
  s_waitcnt lgkmcnt(7)
  v_mfma_f32_16x16x32_bf16 v[112:115], v[184:187], a[88:91], v[112:115]
  v_mfma_f32_16x16x32_bf16 v[116:119], v[184:187], a[92:95], v[116:119]
  ds_read_b128 v[152:155], v34 offset:57344
  s_add_u32 s75, s73, 256
  s_add_u32 m0, s74, 33792
  s_nop 0
  buffer_load_dwordx4 v3, s[36:39], s75 offen lds
  s_waitcnt lgkmcnt(7)
  v_mfma_f32_16x16x32_bf16 v[120:123], v[188:191], a[88:91], v[120:123]
  v_mfma_f32_16x16x32_bf16 v[124:127], v[188:191], a[92:95], v[124:127]
  ds_read_b128 v[156:159], v34 offset:61440
  s_waitcnt lgkmcnt(7)
  v_mfma_f32_16x16x32_bf16 v[64:67], v[128:131], a[96:99], v[64:67]
  v_mfma_f32_16x16x32_bf16 v[68:71], v[128:131], a[100:103], v[68:71]
  ds_read_b128 v[160:163], v35 offset:32768
  s_waitcnt lgkmcnt(7)
  v_mfma_f32_16x16x32_bf16 v[72:75], v[132:135], a[96:99], v[72:75]
  v_mfma_f32_16x16x32_bf16 v[76:79], v[132:135], a[100:103], v[76:79]
  ds_read_b128 v[164:167], v35 offset:36864
  s_waitcnt lgkmcnt(7)
  v_mfma_f32_16x16x32_bf16 v[80:83], v[136:139], a[96:99], v[80:83]
  v_mfma_f32_16x16x32_bf16 v[84:87], v[136:139], a[100:103], v[84:87]
  ds_read_b128 v[168:171], v35 offset:40960
  s_add_u32 s75, s73, 256
  s_add_u32 m0, s74, 34816
  s_nop 0
  buffer_load_dwordx4 v4, s[36:39], s75 offen lds
  s_waitcnt lgkmcnt(7)
  v_mfma_f32_16x16x32_bf16 v[88:91], v[140:143], a[96:99], v[88:91]
  v_mfma_f32_16x16x32_bf16 v[92:95], v[140:143], a[100:103], v[92:95]
  ds_read_b128 v[172:175], v35 offset:45056
  s_waitcnt lgkmcnt(7)
  v_mfma_f32_16x16x32_bf16 v[96:99], v[144:147], a[96:99], v[96:99]
  v_mfma_f32_16x16x32_bf16 v[100:103], v[144:147], a[100:103], v[100:103]
  ds_read_b128 v[176:179], v35 offset:49152
  s_waitcnt lgkmcnt(7)
  v_mfma_f32_16x16x32_bf16 v[104:107], v[148:151], a[96:99], v[104:107]
  v_mfma_f32_16x16x32_bf16 v[108:111], v[148:151], a[100:103], v[108:111]
  ds_read_b128 v[180:183], v35 offset:53248
  s_waitcnt lgkmcnt(7)
  v_mfma_f32_16x16x32_bf16 v[112:115], v[152:155], a[96:99], v[112:115]
  v_mfma_f32_16x16x32_bf16 v[116:119], v[152:155], a[100:103], v[116:119]
  ds_read_b128 v[184:187], v35 offset:57344
  s_add_u32 s75, s73, 256
  s_add_u32 m0, s74, 35840
  s_nop 0
  buffer_load_dwordx4 v5, s[36:39], s75 offen lds
  s_waitcnt lgkmcnt(7)
  v_mfma_f32_16x16x32_bf16 v[120:123], v[156:159], a[96:99], v[120:123]
  v_mfma_f32_16x16x32_bf16 v[124:127], v[156:159], a[100:103], v[124:127]
  ds_read_b128 v[188:191], v35 offset:61440
  s_waitcnt lgkmcnt(7)
  v_mfma_f32_16x16x32_bf16 v[64:67], v[160:163], a[104:107], v[64:67]
  v_mfma_f32_16x16x32_bf16 v[68:71], v[160:163], a[108:111], v[68:71]
  ds_read_b128 v[128:131], v36 offset:32768
  s_waitcnt lgkmcnt(7)
  v_mfma_f32_16x16x32_bf16 v[72:75], v[164:167], a[104:107], v[72:75]
  v_mfma_f32_16x16x32_bf16 v[76:79], v[164:167], a[108:111], v[76:79]
  ds_read_b128 v[132:135], v36 offset:36864
  s_waitcnt lgkmcnt(7)
  v_mfma_f32_16x16x32_bf16 v[80:83], v[168:171], a[104:107], v[80:83]
  v_mfma_f32_16x16x32_bf16 v[84:87], v[168:171], a[108:111], v[84:87]
  ds_read_b128 v[136:139], v36 offset:40960
  s_add_u32 s75, s73, 20736
  s_add_u32 m0, s74, 36864
  s_nop 0
  buffer_load_dwordx4 v2, s[36:39], s75 offen lds
  s_waitcnt lgkmcnt(7)
  v_mfma_f32_16x16x32_bf16 v[88:91], v[172:175], a[104:107], v[88:91]
  v_mfma_f32_16x16x32_bf16 v[92:95], v[172:175], a[108:111], v[92:95]
  ds_read_b128 v[140:143], v36 offset:45056
  s_waitcnt lgkmcnt(7)
  v_mfma_f32_16x16x32_bf16 v[96:99], v[176:179], a[104:107], v[96:99]
  v_mfma_f32_16x16x32_bf16 v[100:103], v[176:179], a[108:111], v[100:103]
  ds_read_b128 v[144:147], v36 offset:49152
  s_waitcnt lgkmcnt(7)
  v_mfma_f32_16x16x32_bf16 v[104:107], v[180:183], a[104:107], v[104:107]
  v_mfma_f32_16x16x32_bf16 v[108:111], v[180:183], a[108:111], v[108:111]
  ds_read_b128 v[148:151], v36 offset:53248
  s_waitcnt lgkmcnt(7)
  v_mfma_f32_16x16x32_bf16 v[112:115], v[184:187], a[104:107], v[112:115]
  v_mfma_f32_16x16x32_bf16 v[116:119], v[184:187], a[108:111], v[116:119]
  ds_read_b128 v[152:155], v36 offset:57344
  s_add_u32 s75, s73, 20736
  s_add_u32 m0, s74, 37888
  s_nop 0
  buffer_load_dwordx4 v3, s[36:39], s75 offen lds
  s_waitcnt lgkmcnt(7)
  v_mfma_f32_16x16x32_bf16 v[120:123], v[188:191], a[104:107], v[120:123]
  v_mfma_f32_16x16x32_bf16 v[124:127], v[188:191], a[108:111], v[124:127]
  ds_read_b128 v[156:159], v36 offset:61440
  s_waitcnt lgkmcnt(7)
  v_mfma_f32_16x16x32_bf16 v[64:67], v[128:131], a[112:115], v[64:67]
  v_mfma_f32_16x16x32_bf16 v[68:71], v[128:131], a[116:119], v[68:71]
  ds_read_b128 v[160:163], v37 offset:32768
  s_waitcnt lgkmcnt(7)
  v_mfma_f32_16x16x32_bf16 v[72:75], v[132:135], a[112:115], v[72:75]
  v_mfma_f32_16x16x32_bf16 v[76:79], v[132:135], a[116:119], v[76:79]
  ds_read_b128 v[164:167], v37 offset:36864
  s_waitcnt lgkmcnt(7)
  v_mfma_f32_16x16x32_bf16 v[80:83], v[136:139], a[112:115], v[80:83]
  v_mfma_f32_16x16x32_bf16 v[84:87], v[136:139], a[116:119], v[84:87]
  ds_read_b128 v[168:171], v37 offset:40960
  s_add_u32 s75, s73, 20736
  s_add_u32 m0, s74, 38912
  s_nop 0
  buffer_load_dwordx4 v4, s[36:39], s75 offen lds
  s_waitcnt lgkmcnt(7)
  v_mfma_f32_16x16x32_bf16 v[88:91], v[140:143], a[112:115], v[88:91]
  v_mfma_f32_16x16x32_bf16 v[92:95], v[140:143], a[116:119], v[92:95]
  ds_read_b128 v[172:175], v37 offset:45056
  s_waitcnt lgkmcnt(7)
  v_mfma_f32_16x16x32_bf16 v[96:99], v[144:147], a[112:115], v[96:99]
  v_mfma_f32_16x16x32_bf16 v[100:103], v[144:147], a[116:119], v[100:103]
  ds_read_b128 v[176:179], v37 offset:49152
  s_waitcnt lgkmcnt(7)
  v_mfma_f32_16x16x32_bf16 v[104:107], v[148:151], a[112:115], v[104:107]
  v_mfma_f32_16x16x32_bf16 v[108:111], v[148:151], a[116:119], v[108:111]
  ds_read_b128 v[180:183], v37 offset:53248
  s_waitcnt lgkmcnt(7)
  v_mfma_f32_16x16x32_bf16 v[112:115], v[152:155], a[112:115], v[112:115]
  v_mfma_f32_16x16x32_bf16 v[116:119], v[152:155], a[116:119], v[116:119]
  ds_read_b128 v[184:187], v37 offset:57344
  s_add_u32 s75, s73, 20736
  s_add_u32 m0, s74, 39936
  s_nop 0
  buffer_load_dwordx4 v5, s[36:39], s75 offen lds
  s_waitcnt lgkmcnt(7)
  v_mfma_f32_16x16x32_bf16 v[120:123], v[156:159], a[112:115], v[120:123]
  v_mfma_f32_16x16x32_bf16 v[124:127], v[156:159], a[116:119], v[124:127]
  ds_read_b128 v[188:191], v37 offset:61440
  s_waitcnt vmcnt(16)
  s_barrier
  s_waitcnt lgkmcnt(7)
  v_mfma_f32_16x16x32_bf16 v[64:67], v[160:163], a[120:123], v[64:67]
  v_mfma_f32_16x16x32_bf16 v[68:71], v[160:163], a[124:127], v[68:71]
  ds_read_b128 v[128:131], v38 offset:0
  s_waitcnt lgkmcnt(7)
  v_mfma_f32_16x16x32_bf16 v[72:75], v[164:167], a[120:123], v[72:75]
  v_mfma_f32_16x16x32_bf16 v[76:79], v[164:167], a[124:127], v[76:79]
  ds_read_b128 v[132:135], v38 offset:4096
  s_waitcnt lgkmcnt(7)
  v_mfma_f32_16x16x32_bf16 v[80:83], v[168:171], a[120:123], v[80:83]
  v_mfma_f32_16x16x32_bf16 v[84:87], v[168:171], a[124:127], v[84:87]
  ds_read_b128 v[136:139], v38 offset:8192
  s_add_u32 s75, s73, 512
  s_add_u32 m0, s74, 65536
  s_nop 0
  buffer_load_dwordx4 v2, s[36:39], s75 offen lds
  s_waitcnt lgkmcnt(7)
  v_mfma_f32_16x16x32_bf16 v[88:91], v[172:175], a[120:123], v[88:91]
  v_mfma_f32_16x16x32_bf16 v[92:95], v[172:175], a[124:127], v[92:95]
  ds_read_b128 v[140:143], v38 offset:12288
  s_waitcnt lgkmcnt(7)
  v_mfma_f32_16x16x32_bf16 v[96:99], v[176:179], a[120:123], v[96:99]
  v_mfma_f32_16x16x32_bf16 v[100:103], v[176:179], a[124:127], v[100:103]
  ds_read_b128 v[144:147], v38 offset:16384
  s_waitcnt lgkmcnt(7)
  v_mfma_f32_16x16x32_bf16 v[104:107], v[180:183], a[120:123], v[104:107]
  v_mfma_f32_16x16x32_bf16 v[108:111], v[180:183], a[124:127], v[108:111]
  ds_read_b128 v[148:151], v38 offset:20480
  s_waitcnt lgkmcnt(7)
  v_mfma_f32_16x16x32_bf16 v[112:115], v[184:187], a[120:123], v[112:115]
  v_mfma_f32_16x16x32_bf16 v[116:119], v[184:187], a[124:127], v[116:119]
  ds_read_b128 v[152:155], v38 offset:24576
  s_add_u32 s75, s73, 512
  s_add_u32 m0, s74, 66560
  s_nop 0
  buffer_load_dwordx4 v3, s[36:39], s75 offen lds
  s_waitcnt lgkmcnt(7)
  v_mfma_f32_16x16x32_bf16 v[120:123], v[188:191], a[120:123], v[120:123]
  v_mfma_f32_16x16x32_bf16 v[124:127], v[188:191], a[124:127], v[124:127]
  ds_read_b128 v[156:159], v38 offset:28672
  s_waitcnt lgkmcnt(7)
  v_mfma_f32_16x16x32_bf16 v[64:67], v[128:131], a[128:131], v[64:67]
  v_mfma_f32_16x16x32_bf16 v[68:71], v[128:131], a[132:135], v[68:71]
  ds_read_b128 v[160:163], v39 offset:0
  s_waitcnt lgkmcnt(7)
  v_mfma_f32_16x16x32_bf16 v[72:75], v[132:135], a[128:131], v[72:75]
  v_mfma_f32_16x16x32_bf16 v[76:79], v[132:135], a[132:135], v[76:79]
  ds_read_b128 v[164:167], v39 offset:4096
  s_waitcnt lgkmcnt(7)
  v_mfma_f32_16x16x32_bf16 v[80:83], v[136:139], a[128:131], v[80:83]
  v_mfma_f32_16x16x32_bf16 v[84:87], v[136:139], a[132:135], v[84:87]
  ds_read_b128 v[168:171], v39 offset:8192
  s_add_u32 s75, s73, 512
  s_add_u32 m0, s74, 67584
  s_nop 0
  buffer_load_dwordx4 v4, s[36:39], s75 offen lds
  s_waitcnt lgkmcnt(7)
  v_mfma_f32_16x16x32_bf16 v[88:91], v[140:143], a[128:131], v[88:91]
  v_mfma_f32_16x16x32_bf16 v[92:95], v[140:143], a[132:135], v[92:95]
  ds_read_b128 v[172:175], v39 offset:12288
  s_waitcnt lgkmcnt(7)
  v_mfma_f32_16x16x32_bf16 v[96:99], v[144:147], a[128:131], v[96:99]
  v_mfma_f32_16x16x32_bf16 v[100:103], v[144:147], a[132:135], v[100:103]
  ds_read_b128 v[176:179], v39 offset:16384
  s_waitcnt lgkmcnt(7)
  v_mfma_f32_16x16x32_bf16 v[104:107], v[148:151], a[128:131], v[104:107]
  v_mfma_f32_16x16x32_bf16 v[108:111], v[148:151], a[132:135], v[108:111]
  ds_read_b128 v[180:183], v39 offset:20480
  s_waitcnt lgkmcnt(7)
  v_mfma_f32_16x16x32_bf16 v[112:115], v[152:155], a[128:131], v[112:115]
  v_mfma_f32_16x16x32_bf16 v[116:119], v[152:155], a[132:135], v[116:119]
  ds_read_b128 v[184:187], v39 offset:24576
  s_add_u32 s75, s73, 512
  s_add_u32 m0, s74, 68608
  s_nop 0
  buffer_load_dwordx4 v5, s[36:39], s75 offen lds
  s_waitcnt lgkmcnt(7)
  v_mfma_f32_16x16x32_bf16 v[120:123], v[156:159], a[128:131], v[120:123]
  v_mfma_f32_16x16x32_bf16 v[124:127], v[156:159], a[132:135], v[124:127]
  ds_read_b128 v[188:191], v39 offset:28672
  s_waitcnt lgkmcnt(7)
  v_mfma_f32_16x16x32_bf16 v[64:67], v[160:163], a[136:139], v[64:67]
  v_mfma_f32_16x16x32_bf16 v[68:71], v[160:163], a[140:143], v[68:71]
  ds_read_b128 v[128:131], v40 offset:0
  s_waitcnt lgkmcnt(7)
  v_mfma_f32_16x16x32_bf16 v[72:75], v[164:167], a[136:139], v[72:75]
  v_mfma_f32_16x16x32_bf16 v[76:79], v[164:167], a[140:143], v[76:79]
  ds_read_b128 v[132:135], v40 offset:4096
  s_waitcnt lgkmcnt(7)
  v_mfma_f32_16x16x32_bf16 v[80:83], v[168:171], a[136:139], v[80:83]
  v_mfma_f32_16x16x32_bf16 v[84:87], v[168:171], a[140:143], v[84:87]
  ds_read_b128 v[136:139], v40 offset:8192
  s_add_u32 s75, s73, 20992
  s_add_u32 m0, s74, 69632
  s_nop 0
  buffer_load_dwordx4 v2, s[36:39], s75 offen lds
  s_waitcnt lgkmcnt(7)
  v_mfma_f32_16x16x32_bf16 v[88:91], v[172:175], a[136:139], v[88:91]
  v_mfma_f32_16x16x32_bf16 v[92:95], v[172:175], a[140:143], v[92:95]
  ds_read_b128 v[140:143], v40 offset:12288
  s_waitcnt lgkmcnt(7)
  v_mfma_f32_16x16x32_bf16 v[96:99], v[176:179], a[136:139], v[96:99]
  v_mfma_f32_16x16x32_bf16 v[100:103], v[176:179], a[140:143], v[100:103]
  ds_read_b128 v[144:147], v40 offset:16384
  s_waitcnt lgkmcnt(7)
  v_mfma_f32_16x16x32_bf16 v[104:107], v[180:183], a[136:139], v[104:107]
  v_mfma_f32_16x16x32_bf16 v[108:111], v[180:183], a[140:143], v[108:111]
  ds_read_b128 v[148:151], v40 offset:20480
  s_waitcnt lgkmcnt(7)
  v_mfma_f32_16x16x32_bf16 v[112:115], v[184:187], a[136:139], v[112:115]
  v_mfma_f32_16x16x32_bf16 v[116:119], v[184:187], a[140:143], v[116:119]
  ds_read_b128 v[152:155], v40 offset:24576
  s_add_u32 s75, s73, 20992
  s_add_u32 m0, s74, 70656
  s_nop 0
  buffer_load_dwordx4 v3, s[36:39], s75 offen lds
  s_waitcnt lgkmcnt(7)
  v_mfma_f32_16x16x32_bf16 v[120:123], v[188:191], a[136:139], v[120:123]
  v_mfma_f32_16x16x32_bf16 v[124:127], v[188:191], a[140:143], v[124:127]
  ds_read_b128 v[156:159], v40 offset:28672
  s_waitcnt lgkmcnt(7)
  v_mfma_f32_16x16x32_bf16 v[64:67], v[128:131], a[144:147], v[64:67]
  v_mfma_f32_16x16x32_bf16 v[68:71], v[128:131], a[148:151], v[68:71]
  ds_read_b128 v[160:163], v41 offset:0
  s_waitcnt lgkmcnt(7)
  v_mfma_f32_16x16x32_bf16 v[72:75], v[132:135], a[144:147], v[72:75]
  v_mfma_f32_16x16x32_bf16 v[76:79], v[132:135], a[148:151], v[76:79]
  ds_read_b128 v[164:167], v41 offset:4096
  s_waitcnt lgkmcnt(7)
  v_mfma_f32_16x16x32_bf16 v[80:83], v[136:139], a[144:147], v[80:83]
  v_mfma_f32_16x16x32_bf16 v[84:87], v[136:139], a[148:151], v[84:87]
  ds_read_b128 v[168:171], v41 offset:8192
  s_add_u32 s75, s73, 20992
  s_add_u32 m0, s74, 71680
  s_nop 0
  buffer_load_dwordx4 v4, s[36:39], s75 offen lds
  s_waitcnt lgkmcnt(7)
  v_mfma_f32_16x16x32_bf16 v[88:91], v[140:143], a[144:147], v[88:91]
  v_mfma_f32_16x16x32_bf16 v[92:95], v[140:143], a[148:151], v[92:95]
  ds_read_b128 v[172:175], v41 offset:12288
  s_waitcnt lgkmcnt(7)
  v_mfma_f32_16x16x32_bf16 v[96:99], v[144:147], a[144:147], v[96:99]
  v_mfma_f32_16x16x32_bf16 v[100:103], v[144:147], a[148:151], v[100:103]
  ds_read_b128 v[176:179], v41 offset:16384
  s_waitcnt lgkmcnt(7)
  v_mfma_f32_16x16x32_bf16 v[104:107], v[148:151], a[144:147], v[104:107]
  v_mfma_f32_16x16x32_bf16 v[108:111], v[148:151], a[148:151], v[108:111]
  ds_read_b128 v[180:183], v41 offset:20480
  s_waitcnt lgkmcnt(7)
  v_mfma_f32_16x16x32_bf16 v[112:115], v[152:155], a[144:147], v[112:115]
  v_mfma_f32_16x16x32_bf16 v[116:119], v[152:155], a[148:151], v[116:119]
  ds_read_b128 v[184:187], v41 offset:24576
  s_add_u32 s75, s73, 20992
  s_add_u32 m0, s74, 72704
  s_nop 0
  buffer_load_dwordx4 v5, s[36:39], s75 offen lds
  s_waitcnt lgkmcnt(7)
  v_mfma_f32_16x16x32_bf16 v[120:123], v[156:159], a[144:147], v[120:123]
  v_mfma_f32_16x16x32_bf16 v[124:127], v[156:159], a[148:151], v[124:127]
  ds_read_b128 v[188:191], v41 offset:28672
  s_waitcnt vmcnt(16)
  s_barrier
  s_waitcnt lgkmcnt(7)
  v_mfma_f32_16x16x32_bf16 v[64:67], v[160:163], a[152:155], v[64:67]
  v_mfma_f32_16x16x32_bf16 v[68:71], v[160:163], a[156:159], v[68:71]
  ds_read_b128 v[128:131], v30 offset:0
  s_waitcnt lgkmcnt(7)
  v_mfma_f32_16x16x32_bf16 v[72:75], v[164:167], a[152:155], v[72:75]
  v_mfma_f32_16x16x32_bf16 v[76:79], v[164:167], a[156:159], v[76:79]
  ds_read_b128 v[132:135], v30 offset:4096
  s_waitcnt lgkmcnt(7)
  v_mfma_f32_16x16x32_bf16 v[80:83], v[168:171], a[152:155], v[80:83]
  v_mfma_f32_16x16x32_bf16 v[84:87], v[168:171], a[156:159], v[84:87]
  ds_read_b128 v[136:139], v30 offset:8192
  s_add_u32 s75, s73, 768
  s_add_u32 m0, s74, 98304
  s_nop 0
  buffer_load_dwordx4 v2, s[36:39], s75 offen lds
  s_waitcnt lgkmcnt(7)
  v_mfma_f32_16x16x32_bf16 v[88:91], v[172:175], a[152:155], v[88:91]
  v_mfma_f32_16x16x32_bf16 v[92:95], v[172:175], a[156:159], v[92:95]
  ds_read_b128 v[140:143], v30 offset:12288
  s_waitcnt lgkmcnt(7)
  v_mfma_f32_16x16x32_bf16 v[96:99], v[176:179], a[152:155], v[96:99]
  v_mfma_f32_16x16x32_bf16 v[100:103], v[176:179], a[156:159], v[100:103]
  ds_read_b128 v[144:147], v30 offset:16384
  s_waitcnt lgkmcnt(7)
  v_mfma_f32_16x16x32_bf16 v[104:107], v[180:183], a[152:155], v[104:107]
  v_mfma_f32_16x16x32_bf16 v[108:111], v[180:183], a[156:159], v[108:111]
  ds_read_b128 v[148:151], v30 offset:20480
  s_waitcnt lgkmcnt(7)
  v_mfma_f32_16x16x32_bf16 v[112:115], v[184:187], a[152:155], v[112:115]
  v_mfma_f32_16x16x32_bf16 v[116:119], v[184:187], a[156:159], v[116:119]
  ds_read_b128 v[152:155], v30 offset:24576
  s_add_u32 s75, s73, 768
  s_add_u32 m0, s74, 99328
  s_nop 0
  buffer_load_dwordx4 v3, s[36:39], s75 offen lds
  s_waitcnt lgkmcnt(7)
  v_mfma_f32_16x16x32_bf16 v[120:123], v[188:191], a[152:155], v[120:123]
  v_mfma_f32_16x16x32_bf16 v[124:127], v[188:191], a[156:159], v[124:127]
  ds_read_b128 v[156:159], v30 offset:28672
  v_cvt_pk_bf16_f32 v192, v64, v65
  v_cvt_pk_bf16_f32 v193, v66, v67
  v_cvt_pk_bf16_f32 v194, v72, v73
  v_cvt_pk_bf16_f32 v195, v74, v75
  s_mov_b32 s75, s65
  buffer_store_dwordx4 v[192:195], v18, s[44:47], s75 offen sc1
  v_cvt_pk_bf16_f32 v196, v68, v69
  v_cvt_pk_bf16_f32 v197, v70, v71
  v_cvt_pk_bf16_f32 v198, v76, v77
  v_cvt_pk_bf16_f32 v199, v78, v79
  v_and_or_b32 v196, v196, v43, v42
  v_and_or_b32 v197, v197, v43, v42
  v_and_or_b32 v198, v198, v43, v42
  v_and_or_b32 v199, v199, v43, v42
  s_add_u32 s75, s65, s67
  s_add_u32 s65, s65, s66
  buffer_store_dwordx4 v[196:199], v18, s[44:47], s75 offen sc1
  v_cvt_pk_bf16_f32 v200, v80, v81
  v_cvt_pk_bf16_f32 v201, v82, v83
  v_cvt_pk_bf16_f32 v202, v88, v89
  v_cvt_pk_bf16_f32 v203, v90, v91
  s_mov_b32 s75, s65
  buffer_store_dwordx4 v[200:203], v18, s[44:47], s75 offen sc1
  v_cvt_pk_bf16_f32 v204, v84, v85
  v_cvt_pk_bf16_f32 v205, v86, v87
  v_cvt_pk_bf16_f32 v206, v92, v93
  v_cvt_pk_bf16_f32 v207, v94, v95
  v_and_or_b32 v204, v204, v43, v42
  v_and_or_b32 v205, v205, v43, v42
  v_and_or_b32 v206, v206, v43, v42
  v_and_or_b32 v207, v207, v43, v42
  s_add_u32 s75, s65, s67
  s_add_u32 s65, s65, s66
  buffer_store_dwordx4 v[204:207], v18, s[44:47], s75 offen sc1
  v_cvt_pk_bf16_f32 v192, v96, v97
  v_cvt_pk_bf16_f32 v193, v98, v99
  v_cvt_pk_bf16_f32 v194, v104, v105
  v_cvt_pk_bf16_f32 v195, v106, v107
  s_mov_b32 s75, s65
  buffer_store_dwordx4 v[192:195], v18, s[44:47], s75 offen sc1
  v_cvt_pk_bf16_f32 v196, v100, v101
  v_cvt_pk_bf16_f32 v197, v102, v103
  v_cvt_pk_bf16_f32 v198, v108, v109
  v_cvt_pk_bf16_f32 v199, v110, v111
  v_and_or_b32 v196, v196, v43, v42
  v_and_or_b32 v197, v197, v43, v42
  v_and_or_b32 v198, v198, v43, v42
  v_and_or_b32 v199, v199, v43, v42
  s_add_u32 s75, s65, s67
  s_add_u32 s65, s65, s66
  buffer_store_dwordx4 v[196:199], v18, s[44:47], s75 offen sc1
  v_cvt_pk_bf16_f32 v200, v112, v113
  v_cvt_pk_bf16_f32 v201, v114, v115
  v_cvt_pk_bf16_f32 v202, v120, v121
  v_cvt_pk_bf16_f32 v203, v122, v123
  s_mov_b32 s75, s65
  buffer_store_dwordx4 v[200:203], v18, s[44:47], s75 offen sc1
  v_cvt_pk_bf16_f32 v204, v116, v117
  v_cvt_pk_bf16_f32 v205, v118, v119
  v_cvt_pk_bf16_f32 v206, v124, v125
  v_cvt_pk_bf16_f32 v207, v126, v127
  v_and_or_b32 v204, v204, v43, v42
  v_and_or_b32 v205, v205, v43, v42
  v_and_or_b32 v206, v206, v43, v42
  v_and_or_b32 v207, v207, v43, v42
  s_add_u32 s75, s65, s67
  s_add_u32 s65, s65, s66
  buffer_store_dwordx4 v[204:207], v18, s[44:47], s75 offen sc1
  s_mov_b32 s72, s73
  s_add_u32 s73, s73, 163840
  s_add_u32 s79, s79, 1
  s_cmp_lt_u32 s79, s69
  s_cbranch_scc1 PWL_4
  s_waitcnt vmcnt(0) lgkmcnt(0)
  s_barrier
  s_mov_b64 exec, 1
  v_mov_b32 v20, s79
  buffer_store_dword v20, v21, s[32:35], 0 offen sc1
  s_mov_b64 exec, -1
  s_branch L_a2
L_pwTdone:
L_a2:
  s_cmp_eq_u32 s84, 0
  s_cbranch_scc1 L_pwA
  s_cmp_lg_u32 s84, 1
  s_cbranch_scc1 L_a2go
  s_waitcnt vmcnt(0)
  s_barrier
  s_cmp_ge_u32 s57, 40
  s_cselect_b32 s75, 63, 64
  s_cselect_b32 s70, 40, 0
  s_sub_u32 s57, s57, s70
  s_mov_b32 s76, s75
  s_branch L_t3entry
L_a2go:

  v_lshrrev_b32 v22, 4, v1
  v_and_b32 v23, 15, v1
  v_lshlrev_b32 v2, 4, v1
  v_mov_b32 v16, 0x3ea52b5c
  v_mov_b32 v17, v16
  v_mov_b32 v60, 0xf149f2ca
  v_cmp_eq_u32 vcc, 1, v22
  v_mov_b32 v61, 0xff7f
  s_nop 0
  v_cndmask_b32 v3, 0, v61, vcc
  v_mov_b32 v61, 0x3f80
  v_cndmask_b32 v4, 0, v61, vcc
  v_mul_u32_u24 v5, 1280, v23
  v_lshl_add_u32 v5, v22, 3, v5
  v_lshlrev_b32 v6, 10, v1

  v_lshl_add_u32 v61, v22, 2, 0
  v_cmp_le_u32 vcc, v61, v23
  s_nop 1
  v_cndmask_b32 v8, v60, 0, vcc
  v_cndmask_b32 v12, 0, v60, vcc
  v_lshl_add_u32 v61, v22, 2, 1
  v_cmp_le_u32 vcc, v61, v23
  s_nop 1
  v_cndmask_b32 v9, v60, 0, vcc
  v_cndmask_b32 v13, 0, v60, vcc
  v_lshl_add_u32 v61, v22, 2, 2
  v_cmp_le_u32 vcc, v61, v23
  s_nop 1
  v_cndmask_b32 v10, v60, 0, vcc
  v_cndmask_b32 v14, 0, v60, vcc
  v_lshl_add_u32 v61, v22, 2, 3
  v_cmp_le_u32 vcc, v61, v23
  s_nop 1
  v_cndmask_b32 v11, v60, 0, vcc
  v_cndmask_b32 v15, 0, v60, vcc
  s_mov_b32 s85, s57
L_a2item:
  s_and_b32 s86, s85, 7
  s_lshr_b32 s87, s85, 3
  s_lshl_b32 s89, s86, 7
  s_add_u32 s89, s89, 88092672

  s_mov_b64 exec, 4095
  s_mov_b32 s70, 0
SP_7:
  buffer_load_dword v62, v6, s[32:35], s89 offen sc1
  s_waitcnt vmcnt(0)
  v_cmp_gt_u32 vcc, 4, v62
  s_cbranch_vccz SD_8
  s_sleep 2
  s_add_u32 s70, s70, 1
  s_cmp_lt_u32 s70, 700934
  s_cbranch_scc1 SP_7
  s_endpgm
SD_8:
  s_mov_b64 exec, -1
  s_lshl_b32 s86, s86, 2
  s_add_u32 s86, s86, s56
  s_lshl_b32 s89, s86, 17
  s_lshl_b32 s90, s87, 2
  s_lshl_b32 s91, s90, 10
  s_add_u32 s91, s91, s89
  s_add_u32 s92, s91, 71303168

  buffer_load_dwordx4 v[144:147], v2, s[32:35], s92 offen offset:0 sc1
  buffer_load_dwordx4 v[148:151], v2, s[32:35], s92 offen offset:1024 sc1
  buffer_load_dwordx4 v[152:155], v2, s[32:35], s92 offen offset:2048 sc1
  buffer_load_dwordx4 v[156:159], v2, s[32:35], s92 offen offset:3072 sc1
  s_add_u32 s92, s91, 75481088
  s_cmp_ge_u32 s90, 16
  s_cselect_b32 s92, s92, 0x7ff00000
  buffer_load_dwordx4 v[64:67], v2, s[32:35], s92 offen sc1
  s_add_u32 s92, s91, 75482112
  s_cmp_ge_u32 s90, 15
  s_cselect_b32 s92, s92, 0x7ff00000
  buffer_load_dwordx4 v[68:71], v2, s[32:35], s92 offen sc1
  s_add_u32 s92, s91, 75483136
  s_cmp_ge_u32 s90, 14
  s_cselect_b32 s92, s92, 0x7ff00000
  buffer_load_dwordx4 v[72:75], v2, s[32:35], s92 offen sc1
  s_add_u32 s92, s91, 75484160
  s_cmp_ge_u32 s90, 13
  s_cselect_b32 s92, s92, 0x7ff00000
  buffer_load_dwordx4 v[76:79], v2, s[32:35], s92 offen sc1
  s_add_u32 s92, s91, 75485184
  s_cmp_ge_u32 s90, 12
  s_cselect_b32 s92, s92, 0x7ff00000
  buffer_load_dwordx4 v[80:83], v2, s[32:35], s92 offen sc1
  s_add_u32 s92, s91, 75486208
  s_cmp_ge_u32 s90, 11
  s_cselect_b32 s92, s92, 0x7ff00000
  buffer_load_dwordx4 v[84:87], v2, s[32:35], s92 offen sc1
  s_add_u32 s92, s91, 75487232
  s_cmp_ge_u32 s90, 10
  s_cselect_b32 s92, s92, 0x7ff00000
  buffer_load_dwordx4 v[88:91], v2, s[32:35], s92 offen sc1
  s_add_u32 s92, s91, 75488256
  s_cmp_ge_u32 s90, 9
  s_cselect_b32 s92, s92, 0x7ff00000
  buffer_load_dwordx4 v[92:95], v2, s[32:35], s92 offen sc1
  s_add_u32 s92, s91, 75489280
  s_cmp_ge_u32 s90, 8
  s_cselect_b32 s92, s92, 0x7ff00000
  buffer_load_dwordx4 v[96:99], v2, s[32:35], s92 offen sc1
  s_add_u32 s92, s91, 75490304
  s_cmp_ge_u32 s90, 7
  s_cselect_b32 s92, s92, 0x7ff00000
  buffer_load_dwordx4 v[100:103], v2, s[32:35], s92 offen sc1
  s_add_u32 s92, s91, 75491328
  s_cmp_ge_u32 s90, 6
  s_cselect_b32 s92, s92, 0x7ff00000
  buffer_load_dwordx4 v[104:107], v2, s[32:35], s92 offen sc1
  s_add_u32 s92, s91, 75492352
  s_cmp_ge_u32 s90, 5
  s_cselect_b32 s92, s92, 0x7ff00000
  buffer_load_dwordx4 v[108:111], v2, s[32:35], s92 offen sc1
  s_add_u32 s92, s91, 75493376
  s_cmp_ge_u32 s90, 4
  s_cselect_b32 s92, s92, 0x7ff00000
  buffer_load_dwordx4 v[112:115], v2, s[32:35], s92 offen sc1
  s_add_u32 s92, s91, 75494400
  s_cmp_ge_u32 s90, 3
  s_cselect_b32 s92, s92, 0x7ff00000
  buffer_load_dwordx4 v[116:119], v2, s[32:35], s92 offen sc1
  s_add_u32 s92, s91, 75495424
  s_cmp_ge_u32 s90, 2
  s_cselect_b32 s92, s92, 0x7ff00000
  buffer_load_dwordx4 v[120:123], v2, s[32:35], s92 offen sc1
  s_add_u32 s92, s91, 75496448
  s_cmp_ge_u32 s90, 1
  s_cselect_b32 s92, s92, 0x7ff00000
  buffer_load_dwordx4 v[124:127], v2, s[32:35], s92 offen sc1
  s_add_u32 s92, s91, 75497472
  buffer_load_dwordx4 v[128:131], v2, s[32:35], s92 offen sc1
  s_add_u32 s92, s91, 75498496
  buffer_load_dwordx4 v[132:135], v2, s[32:35], s92 offen sc1
  s_add_u32 s92, s91, 75499520
  buffer_load_dwordx4 v[136:139], v2, s[32:35], s92 offen sc1
  s_add_u32 s92, s91, 75500544
  buffer_load_dwordx4 v[140:143], v2, s[32:35], s92 offen sc1
  s_add_u32 s92, s91, 79675392
  s_cmp_ge_u32 s90, 16
  s_cselect_b32 s92, s92, 0x7ff00000
  buffer_load_dwordx4 a[0:3], v2, s[32:35], s92 offen offset:0 sc1
  buffer_load_dwordx4 a[4:7], v2, s[32:35], s92 offen offset:1024 sc1
  s_add_u32 s92, s91, 79677440
  s_cmp_ge_u32 s90, 14
  s_cselect_b32 s92, s92, 0x7ff00000
  buffer_load_dwordx4 a[8:11], v2, s[32:35], s92 offen offset:0 sc1
  buffer_load_dwordx4 a[12:15], v2, s[32:35], s92 offen offset:1024 sc1
  s_add_u32 s92, s91, 79679488
  s_cmp_ge_u32 s90, 12
  s_cselect_b32 s92, s92, 0x7ff00000
  buffer_load_dwordx4 a[16:19], v2, s[32:35], s92 offen offset:0 sc1
  buffer_load_dwordx4 a[20:23], v2, s[32:35], s92 offen offset:1024 sc1
  s_add_u32 s92, s91, 79681536
  s_cmp_ge_u32 s90, 10
  s_cselect_b32 s92, s92, 0x7ff00000
  buffer_load_dwordx4 a[24:27], v2, s[32:35], s92 offen offset:0 sc1
  buffer_load_dwordx4 a[28:31], v2, s[32:35], s92 offen offset:1024 sc1
  s_add_u32 s92, s91, 79683584
  s_cmp_ge_u32 s90, 8
  s_cselect_b32 s92, s92, 0x7ff00000
  buffer_load_dwordx4 a[32:35], v2, s[32:35], s92 offen offset:0 sc1
  buffer_load_dwordx4 a[36:39], v2, s[32:35], s92 offen offset:1024 sc1
  s_add_u32 s92, s91, 79685632
  s_cmp_ge_u32 s90, 6
  s_cselect_b32 s92, s92, 0x7ff00000
  buffer_load_dwordx4 a[40:43], v2, s[32:35], s92 offen offset:0 sc1
  buffer_load_dwordx4 a[44:47], v2, s[32:35], s92 offen offset:1024 sc1
  s_add_u32 s92, s91, 79687680
  s_cmp_ge_u32 s90, 4
  s_cselect_b32 s92, s92, 0x7ff00000
  buffer_load_dwordx4 a[48:51], v2, s[32:35], s92 offen offset:0 sc1
  buffer_load_dwordx4 a[52:55], v2, s[32:35], s92 offen offset:1024 sc1
  s_add_u32 s92, s91, 79689728
  s_cmp_ge_u32 s90, 2
  s_cselect_b32 s92, s92, 0x7ff00000
  buffer_load_dwordx4 a[56:59], v2, s[32:35], s92 offen offset:0 sc1
  buffer_load_dwordx4 a[60:63], v2, s[32:35], s92 offen offset:1024 sc1
  s_add_u32 s92, s91, 79691776
  buffer_load_dwordx4 a[64:67], v2, s[32:35], s92 offen offset:0 sc1
  buffer_load_dwordx4 a[68:71], v2, s[32:35], s92 offen offset:1024 sc1
  s_add_u32 s92, s91, 79693824
  buffer_load_dwordx4 a[72:75], v2, s[32:35], s92 offen offset:0 sc1
  buffer_load_dwordx4 a[76:79], v2, s[32:35], s92 offen offset:1024 sc1
  s_waitcnt vmcnt(20)
  v_or_b32 v146, v4, v146
  v_or_b32 v150, v4, v150
  v_or_b32 v154, v4, v154
  v_or_b32 v158, v4, v158
  s_cmp_lt_u32 s90, 16
  s_cselect_b32 s92, -1, 0
  v_and_or_b32 v66, v3, s92, v66
  s_cmp_lt_u32 s90, 15
  s_cselect_b32 s92, -1, 0
  v_and_or_b32 v70, v3, s92, v70
  s_cmp_lt_u32 s90, 14
  s_cselect_b32 s92, -1, 0
  v_and_or_b32 v74, v3, s92, v74
  s_cmp_lt_u32 s90, 13
  s_cselect_b32 s92, -1, 0
  v_and_or_b32 v78, v3, s92, v78
  s_cmp_lt_u32 s90, 12
  s_cselect_b32 s92, -1, 0
  v_and_or_b32 v82, v3, s92, v82
  s_cmp_lt_u32 s90, 11
  s_cselect_b32 s92, -1, 0
  v_and_or_b32 v86, v3, s92, v86
  s_cmp_lt_u32 s90, 10
  s_cselect_b32 s92, -1, 0
  v_and_or_b32 v90, v3, s92, v90
  s_cmp_lt_u32 s90, 9
  s_cselect_b32 s92, -1, 0
  v_and_or_b32 v94, v3, s92, v94
  s_cmp_lt_u32 s90, 8
  s_cselect_b32 s92, -1, 0
  v_and_or_b32 v98, v3, s92, v98
  s_cmp_lt_u32 s90, 7
  s_cselect_b32 s92, -1, 0
  v_and_or_b32 v102, v3, s92, v102
  s_cmp_lt_u32 s90, 6
  s_cselect_b32 s92, -1, 0
  v_and_or_b32 v106, v3, s92, v106
  s_cmp_lt_u32 s90, 5
  s_cselect_b32 s92, -1, 0
  v_and_or_b32 v110, v3, s92, v110
  s_cmp_lt_u32 s90, 4
  s_cselect_b32 s92, -1, 0
  v_and_or_b32 v114, v3, s92, v114
  s_cmp_lt_u32 s90, 3
  s_cselect_b32 s92, -1, 0
  v_and_or_b32 v118, v3, s92, v118
  s_cmp_lt_u32 s90, 2
  s_cselect_b32 s92, -1, 0
  v_and_or_b32 v122, v3, s92, v122
  s_cmp_lt_u32 s90, 1
  s_cselect_b32 s92, -1, 0
  v_and_or_b32 v126, v3, s92, v126
  s_mul_i32 s93, s87, 81920
  s_mul_i32 s92, s86, 40
  s_add_u32 s93, s93, s92
  s_add_u32 s93, s93, 83886080
  v_mfma_f32_16x16x32_bf16 v[160:163], v[64:67], v[144:147], v[12:15]
  v_mfma_f32_16x16x32_bf16 v[164:167], v[68:71], v[144:147], 0
  v_mfma_f32_16x16x32_bf16 v[168:171], v[72:75], v[144:147], 0
  v_mfma_f32_16x16x32_bf16 v[172:175], v[76:79], v[144:147], 0
  v_mfma_f32_16x16x32_bf16 v[176:179], v[80:83], v[144:147], 0
  v_mfma_f32_16x16x32_bf16 v[180:183], v[84:87], v[144:147], 0
  v_mfma_f32_16x16x32_bf16 v[184:187], v[88:91], v[144:147], 0
  v_mfma_f32_16x16x32_bf16 v[188:191], v[92:95], v[144:147], 0
  v_mfma_f32_16x16x32_bf16 v[192:195], v[96:99], v[144:147], 0
  v_mfma_f32_16x16x32_bf16 v[196:199], v[100:103], v[144:147], 0
  v_mfma_f32_16x16x32_bf16 v[200:203], v[104:107], v[144:147], 0
  v_mfma_f32_16x16x32_bf16 v[204:207], v[108:111], v[144:147], 0
  v_mfma_f32_16x16x32_bf16 v[208:211], v[112:115], v[144:147], 0
  v_mfma_f32_16x16x32_bf16 v[212:215], v[116:119], v[144:147], 0
  v_mfma_f32_16x16x32_bf16 v[216:219], v[120:123], v[144:147], 0
  v_mfma_f32_16x16x32_bf16 v[220:223], v[124:127], v[144:147], 0
  v_mfma_f32_16x16x32_bf16 v[224:227], v[128:131], v[144:147], v[8:11]
  v_max3_f32 v62, v160, v161, v162
  v_max3_f32 v63, v163, v164, v165
  v_max3_f32 v62, v62, v166, v167
  v_max3_f32 v63, v63, v168, v169
  v_max3_f32 v62, v62, v170, v171
  v_max3_f32 v63, v63, v172, v173
  v_max3_f32 v62, v62, v174, v175
  v_max3_f32 v63, v63, v176, v177
  v_max3_f32 v62, v62, v178, v179
  v_max3_f32 v63, v63, v180, v181
  v_max3_f32 v62, v62, v182, v183
  v_max3_f32 v63, v63, v184, v185
  v_max3_f32 v62, v62, v186, v187
  v_max3_f32 v63, v63, v188, v189
  v_max3_f32 v62, v62, v190, v191
  v_max3_f32 v63, v63, v192, v193
  v_max3_f32 v62, v62, v194, v195
  v_max3_f32 v63, v63, v196, v197
  v_max3_f32 v62, v62, v198, v199
  v_max3_f32 v63, v63, v200, v201
  v_max3_f32 v62, v62, v202, v203
  v_max3_f32 v63, v63, v204, v205
  v_max3_f32 v62, v62, v206, v207
  v_max3_f32 v63, v63, v208, v209
  v_max3_f32 v62, v62, v210, v211
  v_max3_f32 v63, v63, v212, v213
  v_max3_f32 v62, v62, v214, v215
  v_max3_f32 v63, v63, v216, v217
  v_max3_f32 v62, v62, v218, v219
  v_max3_f32 v63, v63, v220, v221
  v_max3_f32 v62, v62, v222, v223
  v_max3_f32 v63, v63, v224, v225
  v_max3_f32 v62, v62, v226, v227
  v_max_f32 v62, v62, v63
  v_mov_b32 v63, v62
  s_nop 1
  v_permlane16_swap_b32 v62, v63
  v_max_f32 v62, v62, v63
  v_mov_b32 v63, v62
  s_nop 1
  v_permlane32_swap_b32 v62, v63
  v_max_f32 v62, v62, v63
  v_mul_f32 v62, v16, v62
  v_sub_f32 v62, 0, v62
  v_mov_b32 v63, v62
  v_pk_fma_f32 v[160:161], v[160:161], v[16:17], v[62:63]
  v_pk_fma_f32 v[162:163], v[162:163], v[16:17], v[62:63]
  v_pk_fma_f32 v[164:165], v[164:165], v[16:17], v[62:63]
  v_pk_fma_f32 v[166:167], v[166:167], v[16:17], v[62:63]
  v_pk_fma_f32 v[168:169], v[168:169], v[16:17], v[62:63]
  v_pk_fma_f32 v[170:171], v[170:171], v[16:17], v[62:63]
  v_pk_fma_f32 v[172:173], v[172:173], v[16:17], v[62:63]
  v_pk_fma_f32 v[174:175], v[174:175], v[16:17], v[62:63]
  v_pk_fma_f32 v[176:177], v[176:177], v[16:17], v[62:63]
  v_pk_fma_f32 v[178:179], v[178:179], v[16:17], v[62:63]
  v_pk_fma_f32 v[180:181], v[180:181], v[16:17], v[62:63]
  v_pk_fma_f32 v[182:183], v[182:183], v[16:17], v[62:63]
  v_pk_fma_f32 v[184:185], v[184:185], v[16:17], v[62:63]
  v_pk_fma_f32 v[186:187], v[186:187], v[16:17], v[62:63]
  v_pk_fma_f32 v[188:189], v[188:189], v[16:17], v[62:63]
  v_pk_fma_f32 v[190:191], v[190:191], v[16:17], v[62:63]
  v_pk_fma_f32 v[192:193], v[192:193], v[16:17], v[62:63]
  v_pk_fma_f32 v[194:195], v[194:195], v[16:17], v[62:63]
  v_pk_fma_f32 v[196:197], v[196:197], v[16:17], v[62:63]
  v_pk_fma_f32 v[198:199], v[198:199], v[16:17], v[62:63]
  v_pk_fma_f32 v[200:201], v[200:201], v[16:17], v[62:63]
  v_pk_fma_f32 v[202:203], v[202:203], v[16:17], v[62:63]
  v_pk_fma_f32 v[204:205], v[204:205], v[16:17], v[62:63]
  v_pk_fma_f32 v[206:207], v[206:207], v[16:17], v[62:63]
  v_pk_fma_f32 v[208:209], v[208:209], v[16:17], v[62:63]
  v_pk_fma_f32 v[210:211], v[210:211], v[16:17], v[62:63]
  v_pk_fma_f32 v[212:213], v[212:213], v[16:17], v[62:63]
  v_pk_fma_f32 v[214:215], v[214:215], v[16:17], v[62:63]
  v_pk_fma_f32 v[216:217], v[216:217], v[16:17], v[62:63]
  v_pk_fma_f32 v[218:219], v[218:219], v[16:17], v[62:63]
  v_pk_fma_f32 v[220:221], v[220:221], v[16:17], v[62:63]
  v_pk_fma_f32 v[222:223], v[222:223], v[16:17], v[62:63]
  v_pk_fma_f32 v[224:225], v[224:225], v[16:17], v[62:63]
  v_pk_fma_f32 v[226:227], v[226:227], v[16:17], v[62:63]
  v_exp_f32 v160, v160
  v_exp_f32 v161, v161
  v_exp_f32 v162, v162
  v_exp_f32 v163, v163
  v_exp_f32 v164, v164
  v_exp_f32 v165, v165
  v_exp_f32 v166, v166
  v_exp_f32 v167, v167
  v_exp_f32 v168, v168
  v_exp_f32 v169, v169
  v_exp_f32 v170, v170
  v_exp_f32 v171, v171
  v_exp_f32 v172, v172
  v_exp_f32 v173, v173
  v_exp_f32 v174, v174
  v_exp_f32 v175, v175
  v_exp_f32 v176, v176
  v_exp_f32 v177, v177
  v_exp_f32 v178, v178
  v_exp_f32 v179, v179
  v_exp_f32 v180, v180
  v_exp_f32 v181, v181
  v_exp_f32 v182, v182
  v_exp_f32 v183, v183
  v_exp_f32 v184, v184
  v_exp_f32 v185, v185
  v_exp_f32 v186, v186
  v_exp_f32 v187, v187
  v_exp_f32 v188, v188
  v_exp_f32 v189, v189
  v_exp_f32 v190, v190
  v_exp_f32 v191, v191
  v_exp_f32 v192, v192
  v_exp_f32 v193, v193
  v_exp_f32 v194, v194
  v_exp_f32 v195, v195
  v_exp_f32 v196, v196
  v_exp_f32 v197, v197
  v_exp_f32 v198, v198
  v_exp_f32 v199, v199
  v_exp_f32 v200, v200
  v_exp_f32 v201, v201
  v_exp_f32 v202, v202
  v_exp_f32 v203, v203
  v_exp_f32 v204, v204
  v_exp_f32 v205, v205
  v_exp_f32 v206, v206
  v_exp_f32 v207, v207
  v_exp_f32 v208, v208
  v_exp_f32 v209, v209
  v_exp_f32 v210, v210
  v_exp_f32 v211, v211
  v_exp_f32 v212, v212
  v_exp_f32 v213, v213
  v_exp_f32 v214, v214
  v_exp_f32 v215, v215
  v_exp_f32 v216, v216
  v_exp_f32 v217, v217
  v_exp_f32 v218, v218
  v_exp_f32 v219, v219
  v_exp_f32 v220, v220
  v_exp_f32 v221, v221
  v_exp_f32 v222, v222
  v_exp_f32 v223, v223
  v_exp_f32 v224, v224
  v_exp_f32 v225, v225
  v_exp_f32 v226, v226
  v_exp_f32 v227, v227
  v_mov_b32 v58, 0
  v_mov_b32 v59, 0
  v_cvt_pk_bf16_f32 v24, v160, v161
  v_cvt_pk_bf16_f32 v25, v162, v163
  v_cvt_pk_bf16_f32 v26, v164, v165
  v_cvt_pk_bf16_f32 v27, v166, v167
  v_cvt_pk_bf16_f32 v28, v168, v169
  v_cvt_pk_bf16_f32 v29, v170, v171
  v_cvt_pk_bf16_f32 v30, v172, v173
  v_cvt_pk_bf16_f32 v31, v174, v175
  v_cvt_pk_bf16_f32 v32, v176, v177
  v_cvt_pk_bf16_f32 v33, v178, v179
  v_cvt_pk_bf16_f32 v34, v180, v181
  v_cvt_pk_bf16_f32 v35, v182, v183
  v_cvt_pk_bf16_f32 v36, v184, v185
  v_cvt_pk_bf16_f32 v37, v186, v187
  v_cvt_pk_bf16_f32 v38, v188, v189
  v_cvt_pk_bf16_f32 v39, v190, v191
  v_cvt_pk_bf16_f32 v40, v192, v193
  v_cvt_pk_bf16_f32 v41, v194, v195
  v_cvt_pk_bf16_f32 v42, v196, v197
  v_cvt_pk_bf16_f32 v43, v198, v199
  v_cvt_pk_bf16_f32 v44, v200, v201
  v_cvt_pk_bf16_f32 v45, v202, v203
  v_cvt_pk_bf16_f32 v46, v204, v205
  v_cvt_pk_bf16_f32 v47, v206, v207
  v_cvt_pk_bf16_f32 v48, v208, v209
  v_cvt_pk_bf16_f32 v49, v210, v211
  v_cvt_pk_bf16_f32 v50, v212, v213
  v_cvt_pk_bf16_f32 v51, v214, v215
  v_cvt_pk_bf16_f32 v52, v216, v217
  v_cvt_pk_bf16_f32 v53, v218, v219
  v_cvt_pk_bf16_f32 v54, v220, v221
  v_cvt_pk_bf16_f32 v55, v222, v223
  v_cvt_pk_bf16_f32 v56, v224, v225
  v_cvt_pk_bf16_f32 v57, v226, v227
  s_waitcnt vmcnt(0)
  v_mfma_f32_16x16x32_bf16 v[228:231], a[0:3], v[24:27], 0
  v_mfma_f32_16x16x32_bf16 v[232:235], a[4:7], v[24:27], 0
  v_mfma_f32_16x16x32_bf16 v[228:231], a[8:11], v[28:31], v[228:231]
  v_mfma_f32_16x16x32_bf16 v[232:235], a[12:15], v[28:31], v[232:235]
  v_mfma_f32_16x16x32_bf16 v[228:231], a[16:19], v[32:35], v[228:231]
  v_mfma_f32_16x16x32_bf16 v[232:235], a[20:23], v[32:35], v[232:235]
  v_mfma_f32_16x16x32_bf16 v[228:231], a[24:27], v[36:39], v[228:231]
  v_mfma_f32_16x16x32_bf16 v[232:235], a[28:31], v[36:39], v[232:235]
  v_mfma_f32_16x16x32_bf16 v[228:231], a[32:35], v[40:43], v[228:231]
  v_mfma_f32_16x16x32_bf16 v[232:235], a[36:39], v[40:43], v[232:235]
  v_mfma_f32_16x16x32_bf16 v[228:231], a[40:43], v[44:47], v[228:231]
  v_mfma_f32_16x16x32_bf16 v[232:235], a[44:47], v[44:47], v[232:235]
  v_mfma_f32_16x16x32_bf16 v[228:231], a[48:51], v[48:51], v[228:231]
  v_mfma_f32_16x16x32_bf16 v[232:235], a[52:55], v[48:51], v[232:235]
  v_mfma_f32_16x16x32_bf16 v[228:231], a[56:59], v[52:55], v[228:231]
  v_mfma_f32_16x16x32_bf16 v[232:235], a[60:63], v[52:55], v[232:235]
  v_mfma_f32_16x16x32_bf16 v[228:231], a[64:67], v[56:59], v[228:231]
  v_mfma_f32_16x16x32_bf16 v[232:235], a[68:71], v[56:59], v[232:235]
  s_nop 7
  v_mov_b32 v62, v232
  v_mov_b32 v63, v232
  s_nop 1
  v_permlane16_swap_b32 v62, v63
  v_mov_b32 v62, v63
  s_nop 1
  v_permlane32_swap_b32 v62, v63
  v_rcp_f32 v62, v62
  s_nop 0
  v_mul_f32 v228, v62, v228
  v_mul_f32 v229, v62, v229
  v_mul_f32 v230, v62, v230
  v_mul_f32 v231, v62, v231
  v_mul_f32 v232, v62, v232
  v_mul_f32 v233, v62, v233
  v_mul_f32 v234, v62, v234
  v_mul_f32 v235, v62, v235
  v_cvt_pk_bf16_f32 v236, v228, v229
  v_cvt_pk_bf16_f32 v237, v230, v231
  v_cvt_pk_bf16_f32 v238, v232, v233
  v_cvt_pk_bf16_f32 v239, v234, v235
  buffer_store_dwordx2 v[236:237], v5, s[32:35], s93 offen sc1
  s_mov_b64 exec, 0xffff
  buffer_store_dwordx2 v[238:239], v5, s[32:35], s93 offen offset:32 sc1
  s_mov_b64 exec, -1
  s_add_u32 s93, s93, 20480
  v_mfma_f32_16x16x32_bf16 v[160:163], v[68:71], v[148:151], v[12:15]
  v_mfma_f32_16x16x32_bf16 v[164:167], v[72:75], v[148:151], 0
  v_mfma_f32_16x16x32_bf16 v[168:171], v[76:79], v[148:151], 0
  v_mfma_f32_16x16x32_bf16 v[172:175], v[80:83], v[148:151], 0
  v_mfma_f32_16x16x32_bf16 v[176:179], v[84:87], v[148:151], 0
  v_mfma_f32_16x16x32_bf16 v[180:183], v[88:91], v[148:151], 0
  v_mfma_f32_16x16x32_bf16 v[184:187], v[92:95], v[148:151], 0
  v_mfma_f32_16x16x32_bf16 v[188:191], v[96:99], v[148:151], 0
  v_mfma_f32_16x16x32_bf16 v[192:195], v[100:103], v[148:151], 0
  v_mfma_f32_16x16x32_bf16 v[196:199], v[104:107], v[148:151], 0
  v_mfma_f32_16x16x32_bf16 v[200:203], v[108:111], v[148:151], 0
  v_mfma_f32_16x16x32_bf16 v[204:207], v[112:115], v[148:151], 0
  v_mfma_f32_16x16x32_bf16 v[208:211], v[116:119], v[148:151], 0
  v_mfma_f32_16x16x32_bf16 v[212:215], v[120:123], v[148:151], 0
  v_mfma_f32_16x16x32_bf16 v[216:219], v[124:127], v[148:151], 0
  v_mfma_f32_16x16x32_bf16 v[220:223], v[128:131], v[148:151], 0
  v_mfma_f32_16x16x32_bf16 v[224:227], v[132:135], v[148:151], v[8:11]
  v_max3_f32 v62, v160, v161, v162
  v_max3_f32 v63, v163, v164, v165
  v_max3_f32 v62, v62, v166, v167
  v_max3_f32 v63, v63, v168, v169
  v_max3_f32 v62, v62, v170, v171
  v_max3_f32 v63, v63, v172, v173
  v_max3_f32 v62, v62, v174, v175
  v_max3_f32 v63, v63, v176, v177
  v_max3_f32 v62, v62, v178, v179
  v_max3_f32 v63, v63, v180, v181
  v_max3_f32 v62, v62, v182, v183
  v_max3_f32 v63, v63, v184, v185
  v_max3_f32 v62, v62, v186, v187
  v_max3_f32 v63, v63, v188, v189
  v_max3_f32 v62, v62, v190, v191
  v_max3_f32 v63, v63, v192, v193
  v_max3_f32 v62, v62, v194, v195
  v_max3_f32 v63, v63, v196, v197
  v_max3_f32 v62, v62, v198, v199
  v_max3_f32 v63, v63, v200, v201
  v_max3_f32 v62, v62, v202, v203
  v_max3_f32 v63, v63, v204, v205
  v_max3_f32 v62, v62, v206, v207
  v_max3_f32 v63, v63, v208, v209
  v_max3_f32 v62, v62, v210, v211
  v_max3_f32 v63, v63, v212, v213
  v_max3_f32 v62, v62, v214, v215
  v_max3_f32 v63, v63, v216, v217
  v_max3_f32 v62, v62, v218, v219
  v_max3_f32 v63, v63, v220, v221
  v_max3_f32 v62, v62, v222, v223
  v_max3_f32 v63, v63, v224, v225
  v_max3_f32 v62, v62, v226, v227
  v_max_f32 v62, v62, v63
  v_mov_b32 v63, v62
  s_nop 1
  v_permlane16_swap_b32 v62, v63
  v_max_f32 v62, v62, v63
  v_mov_b32 v63, v62
  s_nop 1
  v_permlane32_swap_b32 v62, v63
  v_max_f32 v62, v62, v63
  v_mul_f32 v62, v16, v62
  v_sub_f32 v62, 0, v62
  v_mov_b32 v63, v62
  v_pk_fma_f32 v[160:161], v[160:161], v[16:17], v[62:63]
  v_pk_fma_f32 v[162:163], v[162:163], v[16:17], v[62:63]
  v_pk_fma_f32 v[164:165], v[164:165], v[16:17], v[62:63]
  v_pk_fma_f32 v[166:167], v[166:167], v[16:17], v[62:63]
  v_pk_fma_f32 v[168:169], v[168:169], v[16:17], v[62:63]
  v_pk_fma_f32 v[170:171], v[170:171], v[16:17], v[62:63]
  v_pk_fma_f32 v[172:173], v[172:173], v[16:17], v[62:63]
  v_pk_fma_f32 v[174:175], v[174:175], v[16:17], v[62:63]
  v_pk_fma_f32 v[176:177], v[176:177], v[16:17], v[62:63]
  v_pk_fma_f32 v[178:179], v[178:179], v[16:17], v[62:63]
  v_pk_fma_f32 v[180:181], v[180:181], v[16:17], v[62:63]
  v_pk_fma_f32 v[182:183], v[182:183], v[16:17], v[62:63]
  v_pk_fma_f32 v[184:185], v[184:185], v[16:17], v[62:63]
  v_pk_fma_f32 v[186:187], v[186:187], v[16:17], v[62:63]
  v_pk_fma_f32 v[188:189], v[188:189], v[16:17], v[62:63]
  v_pk_fma_f32 v[190:191], v[190:191], v[16:17], v[62:63]
  v_pk_fma_f32 v[192:193], v[192:193], v[16:17], v[62:63]
  v_pk_fma_f32 v[194:195], v[194:195], v[16:17], v[62:63]
  v_pk_fma_f32 v[196:197], v[196:197], v[16:17], v[62:63]
  v_pk_fma_f32 v[198:199], v[198:199], v[16:17], v[62:63]
  v_pk_fma_f32 v[200:201], v[200:201], v[16:17], v[62:63]
  v_pk_fma_f32 v[202:203], v[202:203], v[16:17], v[62:63]
  v_pk_fma_f32 v[204:205], v[204:205], v[16:17], v[62:63]
  v_pk_fma_f32 v[206:207], v[206:207], v[16:17], v[62:63]
  v_pk_fma_f32 v[208:209], v[208:209], v[16:17], v[62:63]
  v_pk_fma_f32 v[210:211], v[210:211], v[16:17], v[62:63]
  v_pk_fma_f32 v[212:213], v[212:213], v[16:17], v[62:63]
  v_pk_fma_f32 v[214:215], v[214:215], v[16:17], v[62:63]
  v_pk_fma_f32 v[216:217], v[216:217], v[16:17], v[62:63]
  v_pk_fma_f32 v[218:219], v[218:219], v[16:17], v[62:63]
  v_pk_fma_f32 v[220:221], v[220:221], v[16:17], v[62:63]
  v_pk_fma_f32 v[222:223], v[222:223], v[16:17], v[62:63]
  v_pk_fma_f32 v[224:225], v[224:225], v[16:17], v[62:63]
  v_pk_fma_f32 v[226:227], v[226:227], v[16:17], v[62:63]
  v_exp_f32 v160, v160
  v_exp_f32 v161, v161
  v_exp_f32 v162, v162
  v_exp_f32 v163, v163
  v_exp_f32 v164, v164
  v_exp_f32 v165, v165
  v_exp_f32 v166, v166
  v_exp_f32 v167, v167
  v_exp_f32 v168, v168
  v_exp_f32 v169, v169
  v_exp_f32 v170, v170
  v_exp_f32 v171, v171
  v_exp_f32 v172, v172
  v_exp_f32 v173, v173
  v_exp_f32 v174, v174
  v_exp_f32 v175, v175
  v_exp_f32 v176, v176
  v_exp_f32 v177, v177
  v_exp_f32 v178, v178
  v_exp_f32 v179, v179
  v_exp_f32 v180, v180
  v_exp_f32 v181, v181
  v_exp_f32 v182, v182
  v_exp_f32 v183, v183
  v_exp_f32 v184, v184
  v_exp_f32 v185, v185
  v_exp_f32 v186, v186
  v_exp_f32 v187, v187
  v_exp_f32 v188, v188
  v_exp_f32 v189, v189
  v_exp_f32 v190, v190
  v_exp_f32 v191, v191
  v_exp_f32 v192, v192
  v_exp_f32 v193, v193
  v_exp_f32 v194, v194
  v_exp_f32 v195, v195
  v_exp_f32 v196, v196
  v_exp_f32 v197, v197
  v_exp_f32 v198, v198
  v_exp_f32 v199, v199
  v_exp_f32 v200, v200
  v_exp_f32 v201, v201
  v_exp_f32 v202, v202
  v_exp_f32 v203, v203
  v_exp_f32 v204, v204
  v_exp_f32 v205, v205
  v_exp_f32 v206, v206
  v_exp_f32 v207, v207
  v_exp_f32 v208, v208
  v_exp_f32 v209, v209
  v_exp_f32 v210, v210
  v_exp_f32 v211, v211
  v_exp_f32 v212, v212
  v_exp_f32 v213, v213
  v_exp_f32 v214, v214
  v_exp_f32 v215, v215
  v_exp_f32 v216, v216
  v_exp_f32 v217, v217
  v_exp_f32 v218, v218
  v_exp_f32 v219, v219
  v_exp_f32 v220, v220
  v_exp_f32 v221, v221
  v_exp_f32 v222, v222
  v_exp_f32 v223, v223
  v_exp_f32 v224, v224
  v_exp_f32 v225, v225
  v_exp_f32 v226, v226
  v_exp_f32 v227, v227
  v_mov_b32 v24, 0
  v_mov_b32 v25, 0
  v_cvt_pk_bf16_f32 v26, v160, v161
  v_cvt_pk_bf16_f32 v27, v162, v163
  v_cvt_pk_bf16_f32 v28, v164, v165
  v_cvt_pk_bf16_f32 v29, v166, v167
  v_cvt_pk_bf16_f32 v30, v168, v169
  v_cvt_pk_bf16_f32 v31, v170, v171
  v_cvt_pk_bf16_f32 v32, v172, v173
  v_cvt_pk_bf16_f32 v33, v174, v175
  v_cvt_pk_bf16_f32 v34, v176, v177
  v_cvt_pk_bf16_f32 v35, v178, v179
  v_cvt_pk_bf16_f32 v36, v180, v181
  v_cvt_pk_bf16_f32 v37, v182, v183
  v_cvt_pk_bf16_f32 v38, v184, v185
  v_cvt_pk_bf16_f32 v39, v186, v187
  v_cvt_pk_bf16_f32 v40, v188, v189
  v_cvt_pk_bf16_f32 v41, v190, v191
  v_cvt_pk_bf16_f32 v42, v192, v193
  v_cvt_pk_bf16_f32 v43, v194, v195
  v_cvt_pk_bf16_f32 v44, v196, v197
  v_cvt_pk_bf16_f32 v45, v198, v199
  v_cvt_pk_bf16_f32 v46, v200, v201
  v_cvt_pk_bf16_f32 v47, v202, v203
  v_cvt_pk_bf16_f32 v48, v204, v205
  v_cvt_pk_bf16_f32 v49, v206, v207
  v_cvt_pk_bf16_f32 v50, v208, v209
  v_cvt_pk_bf16_f32 v51, v210, v211
  v_cvt_pk_bf16_f32 v52, v212, v213
  v_cvt_pk_bf16_f32 v53, v214, v215
  v_cvt_pk_bf16_f32 v54, v216, v217
  v_cvt_pk_bf16_f32 v55, v218, v219
  v_cvt_pk_bf16_f32 v56, v220, v221
  v_cvt_pk_bf16_f32 v57, v222, v223
  v_cvt_pk_bf16_f32 v58, v224, v225
  v_cvt_pk_bf16_f32 v59, v226, v227
  v_mfma_f32_16x16x32_bf16 v[228:231], a[0:3], v[24:27], 0
  v_mfma_f32_16x16x32_bf16 v[232:235], a[4:7], v[24:27], 0
  v_mfma_f32_16x16x32_bf16 v[228:231], a[8:11], v[28:31], v[228:231]
  v_mfma_f32_16x16x32_bf16 v[232:235], a[12:15], v[28:31], v[232:235]
  v_mfma_f32_16x16x32_bf16 v[228:231], a[16:19], v[32:35], v[228:231]
  v_mfma_f32_16x16x32_bf16 v[232:235], a[20:23], v[32:35], v[232:235]
  v_mfma_f32_16x16x32_bf16 v[228:231], a[24:27], v[36:39], v[228:231]
  v_mfma_f32_16x16x32_bf16 v[232:235], a[28:31], v[36:39], v[232:235]
  v_mfma_f32_16x16x32_bf16 v[228:231], a[32:35], v[40:43], v[228:231]
  v_mfma_f32_16x16x32_bf16 v[232:235], a[36:39], v[40:43], v[232:235]
  v_mfma_f32_16x16x32_bf16 v[228:231], a[40:43], v[44:47], v[228:231]
  v_mfma_f32_16x16x32_bf16 v[232:235], a[44:47], v[44:47], v[232:235]
  v_mfma_f32_16x16x32_bf16 v[228:231], a[48:51], v[48:51], v[228:231]
  v_mfma_f32_16x16x32_bf16 v[232:235], a[52:55], v[48:51], v[232:235]
  v_mfma_f32_16x16x32_bf16 v[228:231], a[56:59], v[52:55], v[228:231]
  v_mfma_f32_16x16x32_bf16 v[232:235], a[60:63], v[52:55], v[232:235]
  v_mfma_f32_16x16x32_bf16 v[228:231], a[64:67], v[56:59], v[228:231]
  v_mfma_f32_16x16x32_bf16 v[232:235], a[68:71], v[56:59], v[232:235]
  s_nop 7
  v_mov_b32 v62, v232
  v_mov_b32 v63, v232
  s_nop 1
  v_permlane16_swap_b32 v62, v63
  v_mov_b32 v62, v63
  s_nop 1
  v_permlane32_swap_b32 v62, v63
  v_rcp_f32 v62, v62
  s_nop 0
  v_mul_f32 v228, v62, v228
  v_mul_f32 v229, v62, v229
  v_mul_f32 v230, v62, v230
  v_mul_f32 v231, v62, v231
  v_mul_f32 v232, v62, v232
  v_mul_f32 v233, v62, v233
  v_mul_f32 v234, v62, v234
  v_mul_f32 v235, v62, v235
  v_cvt_pk_bf16_f32 v240, v228, v229
  v_cvt_pk_bf16_f32 v241, v230, v231
  v_cvt_pk_bf16_f32 v242, v232, v233
  v_cvt_pk_bf16_f32 v243, v234, v235
  buffer_store_dwordx2 v[240:241], v5, s[32:35], s93 offen sc1
  s_mov_b64 exec, 0xffff
  buffer_store_dwordx2 v[242:243], v5, s[32:35], s93 offen offset:32 sc1
  s_mov_b64 exec, -1
  s_add_u32 s93, s93, 20480
  v_mfma_f32_16x16x32_bf16 v[160:163], v[72:75], v[152:155], v[12:15]
  v_mfma_f32_16x16x32_bf16 v[164:167], v[76:79], v[152:155], 0
  v_mfma_f32_16x16x32_bf16 v[168:171], v[80:83], v[152:155], 0
  v_mfma_f32_16x16x32_bf16 v[172:175], v[84:87], v[152:155], 0
  v_mfma_f32_16x16x32_bf16 v[176:179], v[88:91], v[152:155], 0
  v_mfma_f32_16x16x32_bf16 v[180:183], v[92:95], v[152:155], 0
  v_mfma_f32_16x16x32_bf16 v[184:187], v[96:99], v[152:155], 0
  v_mfma_f32_16x16x32_bf16 v[188:191], v[100:103], v[152:155], 0
  v_mfma_f32_16x16x32_bf16 v[192:195], v[104:107], v[152:155], 0
  v_mfma_f32_16x16x32_bf16 v[196:199], v[108:111], v[152:155], 0
  v_mfma_f32_16x16x32_bf16 v[200:203], v[112:115], v[152:155], 0
  v_mfma_f32_16x16x32_bf16 v[204:207], v[116:119], v[152:155], 0
  v_mfma_f32_16x16x32_bf16 v[208:211], v[120:123], v[152:155], 0
  v_mfma_f32_16x16x32_bf16 v[212:215], v[124:127], v[152:155], 0
  v_mfma_f32_16x16x32_bf16 v[216:219], v[128:131], v[152:155], 0
  v_mfma_f32_16x16x32_bf16 v[220:223], v[132:135], v[152:155], 0
  v_mfma_f32_16x16x32_bf16 v[224:227], v[136:139], v[152:155], v[8:11]
  v_max3_f32 v62, v160, v161, v162
  v_max3_f32 v63, v163, v164, v165
  v_max3_f32 v62, v62, v166, v167
  v_max3_f32 v63, v63, v168, v169
  v_max3_f32 v62, v62, v170, v171
  v_max3_f32 v63, v63, v172, v173
  v_max3_f32 v62, v62, v174, v175
  v_max3_f32 v63, v63, v176, v177
  v_max3_f32 v62, v62, v178, v179
  v_max3_f32 v63, v63, v180, v181
  v_max3_f32 v62, v62, v182, v183
  v_max3_f32 v63, v63, v184, v185
  v_max3_f32 v62, v62, v186, v187
  v_max3_f32 v63, v63, v188, v189
  v_max3_f32 v62, v62, v190, v191
  v_max3_f32 v63, v63, v192, v193
  v_max3_f32 v62, v62, v194, v195
  v_max3_f32 v63, v63, v196, v197
  v_max3_f32 v62, v62, v198, v199
  v_max3_f32 v63, v63, v200, v201
  v_max3_f32 v62, v62, v202, v203
  v_max3_f32 v63, v63, v204, v205
  v_max3_f32 v62, v62, v206, v207
  v_max3_f32 v63, v63, v208, v209
  v_max3_f32 v62, v62, v210, v211
  v_max3_f32 v63, v63, v212, v213
  v_max3_f32 v62, v62, v214, v215
  v_max3_f32 v63, v63, v216, v217
  v_max3_f32 v62, v62, v218, v219
  v_max3_f32 v63, v63, v220, v221
  v_max3_f32 v62, v62, v222, v223
  v_max3_f32 v63, v63, v224, v225
  v_max3_f32 v62, v62, v226, v227
  v_max_f32 v62, v62, v63
  v_mov_b32 v63, v62
  s_nop 1
  v_permlane16_swap_b32 v62, v63
  v_max_f32 v62, v62, v63
  v_mov_b32 v63, v62
  s_nop 1
  v_permlane32_swap_b32 v62, v63
  v_max_f32 v62, v62, v63
  v_mul_f32 v62, v16, v62
  v_sub_f32 v62, 0, v62
  v_mov_b32 v63, v62
  v_pk_fma_f32 v[160:161], v[160:161], v[16:17], v[62:63]
  v_pk_fma_f32 v[162:163], v[162:163], v[16:17], v[62:63]
  v_pk_fma_f32 v[164:165], v[164:165], v[16:17], v[62:63]
  v_pk_fma_f32 v[166:167], v[166:167], v[16:17], v[62:63]
  v_pk_fma_f32 v[168:169], v[168:169], v[16:17], v[62:63]
  v_pk_fma_f32 v[170:171], v[170:171], v[16:17], v[62:63]
  v_pk_fma_f32 v[172:173], v[172:173], v[16:17], v[62:63]
  v_pk_fma_f32 v[174:175], v[174:175], v[16:17], v[62:63]
  v_pk_fma_f32 v[176:177], v[176:177], v[16:17], v[62:63]
  v_pk_fma_f32 v[178:179], v[178:179], v[16:17], v[62:63]
  v_pk_fma_f32 v[180:181], v[180:181], v[16:17], v[62:63]
  v_pk_fma_f32 v[182:183], v[182:183], v[16:17], v[62:63]
  v_pk_fma_f32 v[184:185], v[184:185], v[16:17], v[62:63]
  v_pk_fma_f32 v[186:187], v[186:187], v[16:17], v[62:63]
  v_pk_fma_f32 v[188:189], v[188:189], v[16:17], v[62:63]
  v_pk_fma_f32 v[190:191], v[190:191], v[16:17], v[62:63]
  v_pk_fma_f32 v[192:193], v[192:193], v[16:17], v[62:63]
  v_pk_fma_f32 v[194:195], v[194:195], v[16:17], v[62:63]
  v_pk_fma_f32 v[196:197], v[196:197], v[16:17], v[62:63]
  v_pk_fma_f32 v[198:199], v[198:199], v[16:17], v[62:63]
  v_pk_fma_f32 v[200:201], v[200:201], v[16:17], v[62:63]
  v_pk_fma_f32 v[202:203], v[202:203], v[16:17], v[62:63]
  v_pk_fma_f32 v[204:205], v[204:205], v[16:17], v[62:63]
  v_pk_fma_f32 v[206:207], v[206:207], v[16:17], v[62:63]
  v_pk_fma_f32 v[208:209], v[208:209], v[16:17], v[62:63]
  v_pk_fma_f32 v[210:211], v[210:211], v[16:17], v[62:63]
  v_pk_fma_f32 v[212:213], v[212:213], v[16:17], v[62:63]
  v_pk_fma_f32 v[214:215], v[214:215], v[16:17], v[62:63]
  v_pk_fma_f32 v[216:217], v[216:217], v[16:17], v[62:63]
  v_pk_fma_f32 v[218:219], v[218:219], v[16:17], v[62:63]
  v_pk_fma_f32 v[220:221], v[220:221], v[16:17], v[62:63]
  v_pk_fma_f32 v[222:223], v[222:223], v[16:17], v[62:63]
  v_pk_fma_f32 v[224:225], v[224:225], v[16:17], v[62:63]
  v_pk_fma_f32 v[226:227], v[226:227], v[16:17], v[62:63]
  v_exp_f32 v160, v160
  v_exp_f32 v161, v161
  v_exp_f32 v162, v162
  v_exp_f32 v163, v163
  v_exp_f32 v164, v164
  v_exp_f32 v165, v165
  v_exp_f32 v166, v166
  v_exp_f32 v167, v167
  v_exp_f32 v168, v168
  v_exp_f32 v169, v169
  v_exp_f32 v170, v170
  v_exp_f32 v171, v171
  v_exp_f32 v172, v172
  v_exp_f32 v173, v173
  v_exp_f32 v174, v174
  v_exp_f32 v175, v175
  v_exp_f32 v176, v176
  v_exp_f32 v177, v177
  v_exp_f32 v178, v178
  v_exp_f32 v179, v179
  v_exp_f32 v180, v180
  v_exp_f32 v181, v181
  v_exp_f32 v182, v182
  v_exp_f32 v183, v183
  v_exp_f32 v184, v184
  v_exp_f32 v185, v185
  v_exp_f32 v186, v186
  v_exp_f32 v187, v187
  v_exp_f32 v188, v188
  v_exp_f32 v189, v189
  v_exp_f32 v190, v190
  v_exp_f32 v191, v191
  v_exp_f32 v192, v192
  v_exp_f32 v193, v193
  v_exp_f32 v194, v194
  v_exp_f32 v195, v195
  v_exp_f32 v196, v196
  v_exp_f32 v197, v197
  v_exp_f32 v198, v198
  v_exp_f32 v199, v199
  v_exp_f32 v200, v200
  v_exp_f32 v201, v201
  v_exp_f32 v202, v202
  v_exp_f32 v203, v203
  v_exp_f32 v204, v204
  v_exp_f32 v205, v205
  v_exp_f32 v206, v206
  v_exp_f32 v207, v207
  v_exp_f32 v208, v208
  v_exp_f32 v209, v209
  v_exp_f32 v210, v210
  v_exp_f32 v211, v211
  v_exp_f32 v212, v212
  v_exp_f32 v213, v213
  v_exp_f32 v214, v214
  v_exp_f32 v215, v215
  v_exp_f32 v216, v216
  v_exp_f32 v217, v217
  v_exp_f32 v218, v218
  v_exp_f32 v219, v219
  v_exp_f32 v220, v220
  v_exp_f32 v221, v221
  v_exp_f32 v222, v222
  v_exp_f32 v223, v223
  v_exp_f32 v224, v224
  v_exp_f32 v225, v225
  v_exp_f32 v226, v226
  v_exp_f32 v227, v227
  v_mov_b32 v58, 0
  v_mov_b32 v59, 0
  v_cvt_pk_bf16_f32 v24, v160, v161
  v_cvt_pk_bf16_f32 v25, v162, v163
  v_cvt_pk_bf16_f32 v26, v164, v165
  v_cvt_pk_bf16_f32 v27, v166, v167
  v_cvt_pk_bf16_f32 v28, v168, v169
  v_cvt_pk_bf16_f32 v29, v170, v171
  v_cvt_pk_bf16_f32 v30, v172, v173
  v_cvt_pk_bf16_f32 v31, v174, v175
  v_cvt_pk_bf16_f32 v32, v176, v177
  v_cvt_pk_bf16_f32 v33, v178, v179
  v_cvt_pk_bf16_f32 v34, v180, v181
  v_cvt_pk_bf16_f32 v35, v182, v183
  v_cvt_pk_bf16_f32 v36, v184, v185
  v_cvt_pk_bf16_f32 v37, v186, v187
  v_cvt_pk_bf16_f32 v38, v188, v189
  v_cvt_pk_bf16_f32 v39, v190, v191
  v_cvt_pk_bf16_f32 v40, v192, v193
  v_cvt_pk_bf16_f32 v41, v194, v195
  v_cvt_pk_bf16_f32 v42, v196, v197
  v_cvt_pk_bf16_f32 v43, v198, v199
  v_cvt_pk_bf16_f32 v44, v200, v201
  v_cvt_pk_bf16_f32 v45, v202, v203
  v_cvt_pk_bf16_f32 v46, v204, v205
  v_cvt_pk_bf16_f32 v47, v206, v207
  v_cvt_pk_bf16_f32 v48, v208, v209
  v_cvt_pk_bf16_f32 v49, v210, v211
  v_cvt_pk_bf16_f32 v50, v212, v213
  v_cvt_pk_bf16_f32 v51, v214, v215
  v_cvt_pk_bf16_f32 v52, v216, v217
  v_cvt_pk_bf16_f32 v53, v218, v219
  v_cvt_pk_bf16_f32 v54, v220, v221
  v_cvt_pk_bf16_f32 v55, v222, v223
  v_cvt_pk_bf16_f32 v56, v224, v225
  v_cvt_pk_bf16_f32 v57, v226, v227
  v_mfma_f32_16x16x32_bf16 v[228:231], a[8:11], v[24:27], 0
  v_mfma_f32_16x16x32_bf16 v[232:235], a[12:15], v[24:27], 0
  v_mfma_f32_16x16x32_bf16 v[228:231], a[16:19], v[28:31], v[228:231]
  v_mfma_f32_16x16x32_bf16 v[232:235], a[20:23], v[28:31], v[232:235]
  v_mfma_f32_16x16x32_bf16 v[228:231], a[24:27], v[32:35], v[228:231]
  v_mfma_f32_16x16x32_bf16 v[232:235], a[28:31], v[32:35], v[232:235]
  v_mfma_f32_16x16x32_bf16 v[228:231], a[32:35], v[36:39], v[228:231]
  v_mfma_f32_16x16x32_bf16 v[232:235], a[36:39], v[36:39], v[232:235]
  v_mfma_f32_16x16x32_bf16 v[228:231], a[40:43], v[40:43], v[228:231]
  v_mfma_f32_16x16x32_bf16 v[232:235], a[44:47], v[40:43], v[232:235]
  v_mfma_f32_16x16x32_bf16 v[228:231], a[48:51], v[44:47], v[228:231]
  v_mfma_f32_16x16x32_bf16 v[232:235], a[52:55], v[44:47], v[232:235]
  v_mfma_f32_16x16x32_bf16 v[228:231], a[56:59], v[48:51], v[228:231]
  v_mfma_f32_16x16x32_bf16 v[232:235], a[60:63], v[48:51], v[232:235]
  v_mfma_f32_16x16x32_bf16 v[228:231], a[64:67], v[52:55], v[228:231]
  v_mfma_f32_16x16x32_bf16 v[232:235], a[68:71], v[52:55], v[232:235]
  v_mfma_f32_16x16x32_bf16 v[228:231], a[72:75], v[56:59], v[228:231]
  v_mfma_f32_16x16x32_bf16 v[232:235], a[76:79], v[56:59], v[232:235]
  s_nop 7
  v_mov_b32 v62, v232
  v_mov_b32 v63, v232
  s_nop 1
  v_permlane16_swap_b32 v62, v63
  v_mov_b32 v62, v63
  s_nop 1
  v_permlane32_swap_b32 v62, v63
  v_rcp_f32 v62, v62
  s_nop 0
  v_mul_f32 v228, v62, v228
  v_mul_f32 v229, v62, v229
  v_mul_f32 v230, v62, v230
  v_mul_f32 v231, v62, v231
  v_mul_f32 v232, v62, v232
  v_mul_f32 v233, v62, v233
  v_mul_f32 v234, v62, v234
  v_mul_f32 v235, v62, v235
  v_cvt_pk_bf16_f32 v236, v228, v229
  v_cvt_pk_bf16_f32 v237, v230, v231
  v_cvt_pk_bf16_f32 v238, v232, v233
  v_cvt_pk_bf16_f32 v239, v234, v235
  buffer_store_dwordx2 v[236:237], v5, s[32:35], s93 offen sc1
  s_mov_b64 exec, 0xffff
  buffer_store_dwordx2 v[238:239], v5, s[32:35], s93 offen offset:32 sc1
  s_mov_b64 exec, -1
  s_add_u32 s93, s93, 20480
  v_mfma_f32_16x16x32_bf16 v[160:163], v[76:79], v[156:159], v[12:15]
  v_mfma_f32_16x16x32_bf16 v[164:167], v[80:83], v[156:159], 0
  v_mfma_f32_16x16x32_bf16 v[168:171], v[84:87], v[156:159], 0
  v_mfma_f32_16x16x32_bf16 v[172:175], v[88:91], v[156:159], 0
  v_mfma_f32_16x16x32_bf16 v[176:179], v[92:95], v[156:159], 0
  v_mfma_f32_16x16x32_bf16 v[180:183], v[96:99], v[156:159], 0
  v_mfma_f32_16x16x32_bf16 v[184:187], v[100:103], v[156:159], 0
  v_mfma_f32_16x16x32_bf16 v[188:191], v[104:107], v[156:159], 0
  v_mfma_f32_16x16x32_bf16 v[192:195], v[108:111], v[156:159], 0
  v_mfma_f32_16x16x32_bf16 v[196:199], v[112:115], v[156:159], 0
  v_mfma_f32_16x16x32_bf16 v[200:203], v[116:119], v[156:159], 0
  v_mfma_f32_16x16x32_bf16 v[204:207], v[120:123], v[156:159], 0
  v_mfma_f32_16x16x32_bf16 v[208:211], v[124:127], v[156:159], 0
  v_mfma_f32_16x16x32_bf16 v[212:215], v[128:131], v[156:159], 0
  v_mfma_f32_16x16x32_bf16 v[216:219], v[132:135], v[156:159], 0
  v_mfma_f32_16x16x32_bf16 v[220:223], v[136:139], v[156:159], 0
  v_mfma_f32_16x16x32_bf16 v[224:227], v[140:143], v[156:159], v[8:11]
  v_max3_f32 v62, v160, v161, v162
  v_max3_f32 v63, v163, v164, v165
  v_max3_f32 v62, v62, v166, v167
  v_max3_f32 v63, v63, v168, v169
  v_max3_f32 v62, v62, v170, v171
  v_max3_f32 v63, v63, v172, v173
  v_max3_f32 v62, v62, v174, v175
  v_max3_f32 v63, v63, v176, v177
  v_max3_f32 v62, v62, v178, v179
  v_max3_f32 v63, v63, v180, v181
  v_max3_f32 v62, v62, v182, v183
  v_max3_f32 v63, v63, v184, v185
  v_max3_f32 v62, v62, v186, v187
  v_max3_f32 v63, v63, v188, v189
  v_max3_f32 v62, v62, v190, v191
  v_max3_f32 v63, v63, v192, v193
  v_max3_f32 v62, v62, v194, v195
  v_max3_f32 v63, v63, v196, v197
  v_max3_f32 v62, v62, v198, v199
  v_max3_f32 v63, v63, v200, v201
  v_max3_f32 v62, v62, v202, v203
  v_max3_f32 v63, v63, v204, v205
  v_max3_f32 v62, v62, v206, v207
  v_max3_f32 v63, v63, v208, v209
  v_max3_f32 v62, v62, v210, v211
  v_max3_f32 v63, v63, v212, v213
  v_max3_f32 v62, v62, v214, v215
  v_max3_f32 v63, v63, v216, v217
  v_max3_f32 v62, v62, v218, v219
  v_max3_f32 v63, v63, v220, v221
  v_max3_f32 v62, v62, v222, v223
  v_max3_f32 v63, v63, v224, v225
  v_max3_f32 v62, v62, v226, v227
  v_max_f32 v62, v62, v63
  v_mov_b32 v63, v62
  s_nop 1
  v_permlane16_swap_b32 v62, v63
  v_max_f32 v62, v62, v63
  v_mov_b32 v63, v62
  s_nop 1
  v_permlane32_swap_b32 v62, v63
  v_max_f32 v62, v62, v63
  v_mul_f32 v62, v16, v62
  v_sub_f32 v62, 0, v62
  v_mov_b32 v63, v62
  v_pk_fma_f32 v[160:161], v[160:161], v[16:17], v[62:63]
  v_pk_fma_f32 v[162:163], v[162:163], v[16:17], v[62:63]
  v_pk_fma_f32 v[164:165], v[164:165], v[16:17], v[62:63]
  v_pk_fma_f32 v[166:167], v[166:167], v[16:17], v[62:63]
  v_pk_fma_f32 v[168:169], v[168:169], v[16:17], v[62:63]
  v_pk_fma_f32 v[170:171], v[170:171], v[16:17], v[62:63]
  v_pk_fma_f32 v[172:173], v[172:173], v[16:17], v[62:63]
  v_pk_fma_f32 v[174:175], v[174:175], v[16:17], v[62:63]
  v_pk_fma_f32 v[176:177], v[176:177], v[16:17], v[62:63]
  v_pk_fma_f32 v[178:179], v[178:179], v[16:17], v[62:63]
  v_pk_fma_f32 v[180:181], v[180:181], v[16:17], v[62:63]
  v_pk_fma_f32 v[182:183], v[182:183], v[16:17], v[62:63]
  v_pk_fma_f32 v[184:185], v[184:185], v[16:17], v[62:63]
  v_pk_fma_f32 v[186:187], v[186:187], v[16:17], v[62:63]
  v_pk_fma_f32 v[188:189], v[188:189], v[16:17], v[62:63]
  v_pk_fma_f32 v[190:191], v[190:191], v[16:17], v[62:63]
  v_pk_fma_f32 v[192:193], v[192:193], v[16:17], v[62:63]
  v_pk_fma_f32 v[194:195], v[194:195], v[16:17], v[62:63]
  v_pk_fma_f32 v[196:197], v[196:197], v[16:17], v[62:63]
  v_pk_fma_f32 v[198:199], v[198:199], v[16:17], v[62:63]
  v_pk_fma_f32 v[200:201], v[200:201], v[16:17], v[62:63]
  v_pk_fma_f32 v[202:203], v[202:203], v[16:17], v[62:63]
  v_pk_fma_f32 v[204:205], v[204:205], v[16:17], v[62:63]
  v_pk_fma_f32 v[206:207], v[206:207], v[16:17], v[62:63]
  v_pk_fma_f32 v[208:209], v[208:209], v[16:17], v[62:63]
  v_pk_fma_f32 v[210:211], v[210:211], v[16:17], v[62:63]
  v_pk_fma_f32 v[212:213], v[212:213], v[16:17], v[62:63]
  v_pk_fma_f32 v[214:215], v[214:215], v[16:17], v[62:63]
  v_pk_fma_f32 v[216:217], v[216:217], v[16:17], v[62:63]
  v_pk_fma_f32 v[218:219], v[218:219], v[16:17], v[62:63]
  v_pk_fma_f32 v[220:221], v[220:221], v[16:17], v[62:63]
  v_pk_fma_f32 v[222:223], v[222:223], v[16:17], v[62:63]
  v_pk_fma_f32 v[224:225], v[224:225], v[16:17], v[62:63]
  v_pk_fma_f32 v[226:227], v[226:227], v[16:17], v[62:63]
  v_exp_f32 v160, v160
  v_exp_f32 v161, v161
  v_exp_f32 v162, v162
  v_exp_f32 v163, v163
  v_exp_f32 v164, v164
  v_exp_f32 v165, v165
  v_exp_f32 v166, v166
  v_exp_f32 v167, v167
  v_exp_f32 v168, v168
  v_exp_f32 v169, v169
  v_exp_f32 v170, v170
  v_exp_f32 v171, v171
  v_exp_f32 v172, v172
  v_exp_f32 v173, v173
  v_exp_f32 v174, v174
  v_exp_f32 v175, v175
  v_exp_f32 v176, v176
  v_exp_f32 v177, v177
  v_exp_f32 v178, v178
  v_exp_f32 v179, v179
  v_exp_f32 v180, v180
  v_exp_f32 v181, v181
  v_exp_f32 v182, v182
  v_exp_f32 v183, v183
  v_exp_f32 v184, v184
  v_exp_f32 v185, v185
  v_exp_f32 v186, v186
  v_exp_f32 v187, v187
  v_exp_f32 v188, v188
  v_exp_f32 v189, v189
  v_exp_f32 v190, v190
  v_exp_f32 v191, v191
  v_exp_f32 v192, v192
  v_exp_f32 v193, v193
  v_exp_f32 v194, v194
  v_exp_f32 v195, v195
  v_exp_f32 v196, v196
  v_exp_f32 v197, v197
  v_exp_f32 v198, v198
  v_exp_f32 v199, v199
  v_exp_f32 v200, v200
  v_exp_f32 v201, v201
  v_exp_f32 v202, v202
  v_exp_f32 v203, v203
  v_exp_f32 v204, v204
  v_exp_f32 v205, v205
  v_exp_f32 v206, v206
  v_exp_f32 v207, v207
  v_exp_f32 v208, v208
  v_exp_f32 v209, v209
  v_exp_f32 v210, v210
  v_exp_f32 v211, v211
  v_exp_f32 v212, v212
  v_exp_f32 v213, v213
  v_exp_f32 v214, v214
  v_exp_f32 v215, v215
  v_exp_f32 v216, v216
  v_exp_f32 v217, v217
  v_exp_f32 v218, v218
  v_exp_f32 v219, v219
  v_exp_f32 v220, v220
  v_exp_f32 v221, v221
  v_exp_f32 v222, v222
  v_exp_f32 v223, v223
  v_exp_f32 v224, v224
  v_exp_f32 v225, v225
  v_exp_f32 v226, v226
  v_exp_f32 v227, v227
  v_mov_b32 v24, 0
  v_mov_b32 v25, 0
  v_cvt_pk_bf16_f32 v26, v160, v161
  v_cvt_pk_bf16_f32 v27, v162, v163
  v_cvt_pk_bf16_f32 v28, v164, v165
  v_cvt_pk_bf16_f32 v29, v166, v167
  v_cvt_pk_bf16_f32 v30, v168, v169
  v_cvt_pk_bf16_f32 v31, v170, v171
  v_cvt_pk_bf16_f32 v32, v172, v173
  v_cvt_pk_bf16_f32 v33, v174, v175
  v_cvt_pk_bf16_f32 v34, v176, v177
  v_cvt_pk_bf16_f32 v35, v178, v179
  v_cvt_pk_bf16_f32 v36, v180, v181
  v_cvt_pk_bf16_f32 v37, v182, v183
  v_cvt_pk_bf16_f32 v38, v184, v185
  v_cvt_pk_bf16_f32 v39, v186, v187
  v_cvt_pk_bf16_f32 v40, v188, v189
  v_cvt_pk_bf16_f32 v41, v190, v191
  v_cvt_pk_bf16_f32 v42, v192, v193
  v_cvt_pk_bf16_f32 v43, v194, v195
  v_cvt_pk_bf16_f32 v44, v196, v197
  v_cvt_pk_bf16_f32 v45, v198, v199
  v_cvt_pk_bf16_f32 v46, v200, v201
  v_cvt_pk_bf16_f32 v47, v202, v203
  v_cvt_pk_bf16_f32 v48, v204, v205
  v_cvt_pk_bf16_f32 v49, v206, v207
  v_cvt_pk_bf16_f32 v50, v208, v209
  v_cvt_pk_bf16_f32 v51, v210, v211
  v_cvt_pk_bf16_f32 v52, v212, v213
  v_cvt_pk_bf16_f32 v53, v214, v215
  v_cvt_pk_bf16_f32 v54, v216, v217
  v_cvt_pk_bf16_f32 v55, v218, v219
  v_cvt_pk_bf16_f32 v56, v220, v221
  v_cvt_pk_bf16_f32 v57, v222, v223
  v_cvt_pk_bf16_f32 v58, v224, v225
  v_cvt_pk_bf16_f32 v59, v226, v227
  v_mfma_f32_16x16x32_bf16 v[228:231], a[8:11], v[24:27], 0
  v_mfma_f32_16x16x32_bf16 v[232:235], a[12:15], v[24:27], 0
  v_mfma_f32_16x16x32_bf16 v[228:231], a[16:19], v[28:31], v[228:231]
  v_mfma_f32_16x16x32_bf16 v[232:235], a[20:23], v[28:31], v[232:235]
  v_mfma_f32_16x16x32_bf16 v[228:231], a[24:27], v[32:35], v[228:231]
  v_mfma_f32_16x16x32_bf16 v[232:235], a[28:31], v[32:35], v[232:235]
  v_mfma_f32_16x16x32_bf16 v[228:231], a[32:35], v[36:39], v[228:231]
  v_mfma_f32_16x16x32_bf16 v[232:235], a[36:39], v[36:39], v[232:235]
  v_mfma_f32_16x16x32_bf16 v[228:231], a[40:43], v[40:43], v[228:231]
  v_mfma_f32_16x16x32_bf16 v[232:235], a[44:47], v[40:43], v[232:235]
  v_mfma_f32_16x16x32_bf16 v[228:231], a[48:51], v[44:47], v[228:231]
  v_mfma_f32_16x16x32_bf16 v[232:235], a[52:55], v[44:47], v[232:235]
  v_mfma_f32_16x16x32_bf16 v[228:231], a[56:59], v[48:51], v[228:231]
  v_mfma_f32_16x16x32_bf16 v[232:235], a[60:63], v[48:51], v[232:235]
  v_mfma_f32_16x16x32_bf16 v[228:231], a[64:67], v[52:55], v[228:231]
  v_mfma_f32_16x16x32_bf16 v[232:235], a[68:71], v[52:55], v[232:235]
  v_mfma_f32_16x16x32_bf16 v[228:231], a[72:75], v[56:59], v[228:231]
  v_mfma_f32_16x16x32_bf16 v[232:235], a[76:79], v[56:59], v[232:235]
  s_nop 7
  v_mov_b32 v62, v232
  v_mov_b32 v63, v232
  s_nop 1
  v_permlane16_swap_b32 v62, v63
  v_mov_b32 v62, v63
  s_nop 1
  v_permlane32_swap_b32 v62, v63
  v_rcp_f32 v62, v62
  s_nop 0
  v_mul_f32 v228, v62, v228
  v_mul_f32 v229, v62, v229
  v_mul_f32 v230, v62, v230
  v_mul_f32 v231, v62, v231
  v_mul_f32 v232, v62, v232
  v_mul_f32 v233, v62, v233
  v_mul_f32 v234, v62, v234
  v_mul_f32 v235, v62, v235
  v_cvt_pk_bf16_f32 v240, v228, v229
  v_cvt_pk_bf16_f32 v241, v230, v231
  v_cvt_pk_bf16_f32 v242, v232, v233
  v_cvt_pk_bf16_f32 v243, v234, v235
  buffer_store_dwordx2 v[240:241], v5, s[32:35], s93 offen sc1
  s_mov_b64 exec, 0xffff
  buffer_store_dwordx2 v[242:243], v5, s[32:35], s93 offen offset:32 sc1
  s_mov_b64 exec, -1
  s_add_u32 s93, s93, 20480
  s_waitcnt vmcnt(0)
  s_barrier
  s_cmp_lg_u32 s56, 0
  s_cbranch_scc1 L_a2n
  s_lshr_b32 s92, s87, 1
  s_lshl_b32 s92, s92, 7
  s_add_u32 s92, s92, 88145920
  s_mov_b64 exec, 1
  v_mov_b32 v62, 0
  v_mov_b32 v63, 1
  buffer_atomic_add v63, v62, s[32:35], s92 offen sc1
  s_mov_b64 exec, -1
L_a2n:
  s_add_u32 s85, s85, 96
  s_cmp_lt_u32 s85, 256
  s_cbranch_scc1 L_a2item

  s_cmp_ge_u32 s57, 80
  s_cbranch_scc1 L_pwexit
  s_mul_i32 s86, s57, 52429
  s_lshr_b32 s86, s86, 18
  s_mul_i32 s87, s86, 5
  s_sub_u32 s87, s57, s87
  s_add_u32 s36, s28, 83886080
  s_addc_u32 s37, s29, 0
  s_mul_i32 s68, s86, 163840
  s_add_u32 s38, s68, 163840
  s_mov_b32 s40, s8
  s_mov_b32 s41, s9
  s_mov_b32 s42, 819200
  s_mov_b32 s44, s24
  s_mov_b32 s45, s25
  s_mov_b32 s46, 5242880
  s_movk_i32 s60, 1280
  s_lshl_b32 s61, s87, 8
  s_mov_b32 s62, 64
  s_mov_b32 s63, 8
  s_mov_b32 s64, 16
  s_mul_i32 s65, s86, 327680
  s_add_u32 s65, s65, s61
  s_lshl_b32 s70, s56, 6
  s_add_u32 s65, s65, s70
  s_mov_b32 s66, 81920
  s_mov_b32 s67, 40960
  s_mov_b32 s69, 1
  s_mov_b32 s59, 0
  s_mov_b32 s84, 1
  s_mov_b32 s83, 64
  v_mov_b32 v21, 0x7ff00000
  v_lshrrev_b32 v22, 4, v1
  v_and_b32 v23, 15, v1
  v_mul_u32_u24 v18, 2560, v23
  v_lshl_add_u32 v18, v22, 4, v18

  v_lshrrev_b32 v22, 4, v1
  v_and_b32 v23, 15, v1

  v_add_u32 v24, 0, v22
  v_xor_b32 v25, v24, v23
  v_mul_u32_u24 v24, 1280, v24
  v_lshl_add_u32 v2, v25, 4, v24
  v_add_u32 v24, 4, v22
  v_xor_b32 v25, v24, v23
  v_mul_u32_u24 v24, 1280, v24
  v_lshl_add_u32 v3, v25, 4, v24
  v_add_u32 v24, 8, v22
  v_xor_b32 v25, v24, v23
  v_mul_u32_u24 v24, 1280, v24
  v_lshl_add_u32 v4, v25, 4, v24
  v_add_u32 v24, 12, v22
  v_xor_b32 v25, v24, v23
  v_mul_u32_u24 v24, 1280, v24
  v_lshl_add_u32 v5, v25, 4, v24
  v_mul_lo_u32 v24, v22, s60
  v_add_u32 v25, 0, v22
  v_lshlrev_b32 v25, 1, v25
  v_xor_b32 v25, v25, v23
  v_lshl_add_u32 v6, v25, 4, v24
  v_add_u32 v25, 4, v22
  v_lshlrev_b32 v25, 1, v25
  v_xor_b32 v25, v25, v23
  v_lshl_add_u32 v7, v25, 4, v24
  v_lshrrev_b32 v24, 2, v23
  v_and_b32 v25, 3, v1
  v_lshl_add_u32 v26, v22, 3, v24
  v_lshlrev_b32 v26, 8, v26
  v_and_b32 v27, 1, v22
  v_lshl_add_u32 v27, v27, 2, v24
  v_lshlrev_b32 v27, 1, v27
  v_mul_lo_u32 v25, v25, s64
  s_mul_i32 s70, s56, s62
  v_add_u32 v25, s70, v25

  v_lshrrev_b32 v28, 4, v25
  v_xor_b32 v28, v28, v27
  v_lshl_add_u32 v28, v28, 4, v26
  v_and_b32 v29, 8, v25
  v_add_u32 v8, v28, v29
  v_add_u32 v25, s63, v25
  v_lshrrev_b32 v28, 4, v25
  v_xor_b32 v28, v28, v27
  v_lshl_add_u32 v28, v28, 4, v26
  v_and_b32 v29, 8, v25
  v_add_u32 v9, v28, v29
  v_add_u32 v24, 0, v22
  v_xor_b32 v24, v24, v23
  v_lshlrev_b32 v24, 4, v24
  v_lshl_add_u32 v30, v23, 8, v24
  v_add_u32 v34, 0x10000, v30
  v_add_u32 v38, 0x20000, v30
  v_add_u32 v24, 4, v22
  v_xor_b32 v24, v24, v23
  v_lshlrev_b32 v24, 4, v24
  v_lshl_add_u32 v31, v23, 8, v24
  v_add_u32 v35, 0x10000, v31
  v_add_u32 v39, 0x20000, v31
  v_add_u32 v24, 8, v22
  v_xor_b32 v24, v24, v23
  v_lshlrev_b32 v24, 4, v24
  v_lshl_add_u32 v32, v23, 8, v24
  v_add_u32 v36, 0x10000, v32
  v_add_u32 v40, 0x20000, v32
  v_add_u32 v24, 12, v22
  v_xor_b32 v24, v24, v23
  v_lshlrev_b32 v24, 4, v24
  v_lshl_add_u32 v33, v23, 8, v24
  v_add_u32 v37, 0x10000, v33
  v_add_u32 v41, 0x20000, v33
  v_cmp_eq_u32 vcc, 0, v22
  s_nop 1
  v_cndmask_b32 v19, 0, -1, vcc
  s_cmp_eq_u32 s59, 0
  s_cselect_b32 s70, -1, 0
  v_or_b32 v19, s70, v19
  v_cmp_eq_u32 vcc, 4, v23
  v_mov_b32 v24, 0x3f803f80
  s_nop 0
  v_cndmask_b32 v42, 0, v24, vcc
  v_cndmask_b32 v43, -1, 0, vcc
  v_or_b32 v43, s70, v43
  v_not_b32 v24, v43
  v_and_b32 v42, v24, v42
  s_lshl_b32 s74, s56, 13
  s_mul_i32 s70, s56, 32
  s_mul_i32 s76, s70, s60
  s_add_u32 s76, s76, s61
  s_lshl_b32 s77, s60, 2
  s_mul_i32 s78, s60, 96
  s_mul_i32 s70, s70, 1280
  s_add_u32 s72, s68, s70
  s_add_u32 s73, s72, 163840
  s_lshl_b32 s85, s83, 2
  s_add_u32 s85, s85, s56
  s_mul_i32 s70, s85, 7168
  s_add_u32 s70, s70, s68
  s_add_u32 s70, s70, 327680
  s_cmp_lt_u32 s85, 23
  s_cselect_b32 s85, s70, 0x7ff00000
  v_lshlrev_b32 v46, 4, v1
  s_add_u32 m0, s74, 65536
  s_nop 0
  buffer_load_dwordx4 v6, s[40:43], s76 offen  lds
  s_add_u32 s76, s76, s77
  s_add_u32 m0, s74, 66560
  s_nop 0
  buffer_load_dwordx4 v6, s[40:43], s76 offen  lds
  s_add_u32 s76, s76, s77
  s_add_u32 m0, s74, 67584
  s_nop 0
  buffer_load_dwordx4 v7, s[40:43], s76 offen  lds
  s_add_u32 s76, s76, s77
  s_add_u32 m0, s74, 68608
  s_nop 0
  buffer_load_dwordx4 v7, s[40:43], s76 offen  lds
  s_add_u32 s76, s76, s77
  s_add_u32 m0, s74, 69632
  s_nop 0
  buffer_load_dwordx4 v6, s[40:43], s76 offen  lds
  s_add_u32 s76, s76, s77
  s_add_u32 m0, s74, 70656
  s_nop 0
  buffer_load_dwordx4 v6, s[40:43], s76 offen  lds
  s_add_u32 s76, s76, s77
  s_add_u32 m0, s74, 71680
  s_nop 0
  buffer_load_dwordx4 v7, s[40:43], s76 offen  lds
  s_add_u32 s76, s76, s77
  s_add_u32 m0, s74, 72704
  s_nop 0
  buffer_load_dwordx4 v7, s[40:43], s76 offen  lds
  s_add_u32 s76, s76, s77
  s_add_u32 s76, s76, s78
  s_add_u32 m0, s74, 98304
  s_nop 0
  buffer_load_dwordx4 v6, s[40:43], s76 offen  lds
  s_add_u32 s76, s76, s77
  s_add_u32 m0, s74, 99328
  s_nop 0
  buffer_load_dwordx4 v6, s[40:43], s76 offen  lds
  s_add_u32 s76, s76, s77
  s_add_u32 m0, s74, 100352
  s_nop 0
  buffer_load_dwordx4 v7, s[40:43], s76 offen  lds
  s_add_u32 s76, s76, s77
  s_add_u32 m0, s74, 101376
  s_nop 0
  buffer_load_dwordx4 v7, s[40:43], s76 offen  lds
  s_add_u32 s76, s76, s77
  s_add_u32 m0, s74, 102400
  s_nop 0
  buffer_load_dwordx4 v6, s[40:43], s76 offen  lds
  s_add_u32 s76, s76, s77
  s_add_u32 m0, s74, 103424
  s_nop 0
  buffer_load_dwordx4 v6, s[40:43], s76 offen  lds
  s_add_u32 s76, s76, s77
  s_add_u32 m0, s74, 104448
  s_nop 0
  buffer_load_dwordx4 v7, s[40:43], s76 offen  lds
  s_add_u32 s76, s76, s77
  s_add_u32 m0, s74, 105472
  s_nop 0
  buffer_load_dwordx4 v7, s[40:43], s76 offen  lds
  s_add_u32 s76, s76, s77
  s_add_u32 s76, s76, s78
  s_lshl_b32 s90, s86, 7
  s_add_u32 s90, s90, 88145920
  v_mov_b32 v62, 0
  s_mov_b64 exec, 1
  s_mov_b32 s70, 0
SP_9:
  buffer_load_dword v63, v62, s[32:35], s90 offen sc1
  s_waitcnt vmcnt(0)
  v_cmp_gt_u32 vcc, 16, v63
  s_cbranch_vccz SD_10
  s_sleep 2
  s_add_u32 s70, s70, 1
  s_cmp_lt_u32 s70, 700934
  s_cbranch_scc1 SP_9
  s_endpgm
SD_10:
  s_mov_b64 exec, -1
  s_add_u32 s75, s72, 0
  s_add_u32 m0, s74, 0
  s_nop 0
  buffer_load_dwordx4 v2, s[36:39], s75 offen lds
  s_add_u32 s75, s72, 0
  s_add_u32 m0, s74, 1024
  s_nop 0
  buffer_load_dwordx4 v3, s[36:39], s75 offen lds
  s_add_u32 s75, s72, 0
  s_add_u32 m0, s74, 2048
  s_nop 0
  buffer_load_dwordx4 v4, s[36:39], s75 offen lds
  s_add_u32 s75, s72, 0
  s_add_u32 m0, s74, 3072
  s_nop 0
  buffer_load_dwordx4 v5, s[36:39], s75 offen lds
  s_add_u32 s75, s72, 20480
  s_add_u32 m0, s74, 4096
  s_nop 0
  buffer_load_dwordx4 v2, s[36:39], s75 offen lds
  s_add_u32 s75, s72, 20480
  s_add_u32 m0, s74, 5120
  s_nop 0
  buffer_load_dwordx4 v3, s[36:39], s75 offen lds
  s_add_u32 s75, s72, 20480
  s_add_u32 m0, s74, 6144
  s_nop 0
  buffer_load_dwordx4 v4, s[36:39], s75 offen lds
  s_add_u32 s75, s72, 20480
  s_add_u32 m0, s74, 7168
  s_nop 0
  buffer_load_dwordx4 v5, s[36:39], s75 offen lds
  s_waitcnt vmcnt(0)
  s_branch L_pwT
L_team1:
  v_lshrrev_b32 v22, 4, v1
  v_and_b32 v23, 15, v1
  v_bfe_u32 v5, v1, 3, 1
  v_lshlrev_b32 v5, 16, v5
  v_lshl_add_u32 v5, v22, 6, v5
  v_bfe_u32 v24, v1, 2, 1
  v_lshl_add_u32 v5, v24, 5, v5
  v_and_b32 v24, 1, v1
  v_lshl_add_u32 v5, v24, 4, v5
  s_lshr_b32 s60, s31, 3
  s_lshl_b32 s60, s60, 14
  s_and_b32 s61, s31, 7
  s_lshl_b32 s61, s61, 10
  s_add_u32 s60, s60, s61
  s_lshl_b32 s61, s56, 8
  s_add_u32 s60, s60, s61
  v_add_u32 v5, s60, v5
  v_lshlrev_b32 v13, 7, v1
  v_mov_b32 v12, 0
  s_lshl_b32 s72, s31, 7
  s_add_u32 s73, s72, 88113152
  s_lshl_b32 s61, s56, 2
  s_add_u32 s73, s73, s61
  s_cmp_lt_u32 s31, 4
  s_cselect_b32 s72, 0, 0x7ff00000
  s_cmp_eq_u32 s56, 0
  s_cselect_b32 s72, s72, 0x7ff00000
  s_add_u32 s72, s72, 163840

  v_and_b32 v24, 1, v22
  v_or_b32 v24, 0, v24
  v_lshlrev_b32 v24, 1, v24
  v_xor_b32 v24, v24, v23
  v_lshlrev_b32 v24, 4, v24
  v_lshl_add_u32 v6, v22, 13, v24
  v_and_b32 v24, 1, v22
  v_or_b32 v24, 2, v24
  v_lshlrev_b32 v24, 1, v24
  v_xor_b32 v24, v24, v23
  v_lshlrev_b32 v24, 4, v24
  v_lshl_add_u32 v7, v22, 13, v24
  v_and_b32 v24, 1, v22
  v_or_b32 v24, 4, v24
  v_lshlrev_b32 v24, 1, v24
  v_xor_b32 v24, v24, v23
  v_lshlrev_b32 v24, 4, v24
  v_lshl_add_u32 v8, v22, 13, v24
  v_and_b32 v24, 1, v22
  v_or_b32 v24, 6, v24
  v_lshlrev_b32 v24, 1, v24
  v_xor_b32 v24, v24, v23
  v_lshlrev_b32 v24, 4, v24
  v_lshl_add_u32 v9, v22, 13, v24
  v_lshrrev_b32 v24, 2, v23
  v_lshrrev_b32 v25, 1, v22
  v_lshlrev_b32 v25, 4, v25
  v_and_b32 v26, 1, v22
  v_lshl_add_u32 v25, v26, 2, v25
  v_and_b32 v27, 1, v24
  v_add_u32 v25, v25, v27
  v_lshrrev_b32 v28, 1, v24
  v_lshl_add_u32 v25, v28, 3, v25
  v_lshlrev_b32 v25, 8, v25
  v_lshl_add_u32 v27, v26, 1, v27
  v_lshl_add_u32 v27, v28, 2, v27
  v_lshlrev_b32 v27, 1, v27
  v_and_b32 v26, 3, v1
  v_lshlrev_b32 v26, 3, v26
  s_lshl_b32 s61, s56, 6
  v_add_u32 v26, s61, v26
  v_lshrrev_b32 v28, 4, v26
  v_xor_b32 v28, v28, v27
  v_lshl_add_u32 v28, v28, 4, v25
  v_and_b32 v29, 8, v26
  v_add_u32 v2, v28, v29
  v_add_u32 v26, 32, v26
  v_lshrrev_b32 v28, 4, v26
  v_xor_b32 v28, v28, v27
  v_lshl_add_u32 v28, v28, 4, v25
  v_and_b32 v29, 8, v26
  v_add_u32 v3, v28, v29
  s_lshl_b32 s74, s56, 13
  s_lshl_b32 s75, s56, 18
  s_lshl_b32 s61, s31, 8
  s_add_u32 s75, s75, s61
  s_mov_b32 s40, s14
  s_mov_b32 s41, s15
  s_add_u32 s76, s75, 0
  s_add_u32 m0, s74, 0
  s_nop 0
  buffer_load_dwordx4 v6, s[40:43], s76 offen  lds
  s_add_u32 s76, s75, 32768
  s_add_u32 m0, s74, 1024
  s_nop 0
  buffer_load_dwordx4 v7, s[40:43], s76 offen  lds
  s_add_u32 s76, s75, 65536
  s_add_u32 m0, s74, 2048
  s_nop 0
  buffer_load_dwordx4 v8, s[40:43], s76 offen  lds
  s_add_u32 s76, s75, 98304
  s_add_u32 m0, s74, 3072
  s_nop 0
  buffer_load_dwordx4 v9, s[40:43], s76 offen  lds
  s_add_u32 s76, s75, 131072
  s_add_u32 m0, s74, 4096
  s_nop 0
  buffer_load_dwordx4 v6, s[40:43], s76 offen  lds
  s_add_u32 s76, s75, 163840
  s_add_u32 m0, s74, 5120
  s_nop 0
  buffer_load_dwordx4 v7, s[40:43], s76 offen  lds
  s_add_u32 s76, s75, 196608
  s_add_u32 m0, s74, 6144
  s_nop 0
  buffer_load_dwordx4 v8, s[40:43], s76 offen  lds
  s_add_u32 s76, s75, 229376
  s_add_u32 m0, s74, 7168
  s_nop 0
  buffer_load_dwordx4 v9, s[40:43], s76 offen  lds
  s_add_u32 s76, s75, 1048576
  s_add_u32 m0, s74, 32768
  s_nop 0
  buffer_load_dwordx4 v6, s[40:43], s76 offen  lds
  s_add_u32 s76, s75, 1081344
  s_add_u32 m0, s74, 33792
  s_nop 0
  buffer_load_dwordx4 v7, s[40:43], s76 offen  lds
  s_add_u32 s76, s75, 1114112
  s_add_u32 m0, s74, 34816
  s_nop 0
  buffer_load_dwordx4 v8, s[40:43], s76 offen  lds
  s_add_u32 s76, s75, 1146880
  s_add_u32 m0, s74, 35840
  s_nop 0
  buffer_load_dwordx4 v9, s[40:43], s76 offen  lds
  s_add_u32 s76, s75, 1179648
  s_add_u32 m0, s74, 36864
  s_nop 0
  buffer_load_dwordx4 v6, s[40:43], s76 offen  lds
  s_add_u32 s76, s75, 1212416
  s_add_u32 m0, s74, 37888
  s_nop 0
  buffer_load_dwordx4 v7, s[40:43], s76 offen  lds
  s_add_u32 s76, s75, 1245184
  s_add_u32 m0, s74, 38912
  s_nop 0
  buffer_load_dwordx4 v8, s[40:43], s76 offen  lds
  s_add_u32 s76, s75, 1277952
  s_add_u32 m0, s74, 39936
  s_nop 0
  buffer_load_dwordx4 v9, s[40:43], s76 offen  lds
  s_add_u32 s76, s75, 2097152
  s_add_u32 m0, s74, 65536
  s_nop 0
  buffer_load_dwordx4 v6, s[40:43], s76 offen  lds
  s_add_u32 s76, s75, 2129920
  s_add_u32 m0, s74, 66560
  s_nop 0
  buffer_load_dwordx4 v7, s[40:43], s76 offen  lds
  s_add_u32 s76, s75, 2162688
  s_add_u32 m0, s74, 67584
  s_nop 0
  buffer_load_dwordx4 v8, s[40:43], s76 offen  lds
  s_add_u32 s76, s75, 2195456
  s_add_u32 m0, s74, 68608
  s_nop 0
  buffer_load_dwordx4 v9, s[40:43], s76 offen  lds
  s_add_u32 s76, s75, 2228224
  s_add_u32 m0, s74, 69632
  s_nop 0
  buffer_load_dwordx4 v6, s[40:43], s76 offen  lds
  s_add_u32 s76, s75, 2260992
  s_add_u32 m0, s74, 70656
  s_nop 0
  buffer_load_dwordx4 v7, s[40:43], s76 offen  lds
  s_add_u32 s76, s75, 2293760
  s_add_u32 m0, s74, 71680
  s_nop 0
  buffer_load_dwordx4 v8, s[40:43], s76 offen  lds
  s_add_u32 s76, s75, 2326528
  s_add_u32 m0, s74, 72704
  s_nop 0
  buffer_load_dwordx4 v9, s[40:43], s76 offen  lds
  s_add_u32 s76, s75, 3145728
  s_add_u32 m0, s74, 98304
  s_nop 0
  buffer_load_dwordx4 v6, s[40:43], s76 offen  lds
  s_add_u32 s76, s75, 3178496
  s_add_u32 m0, s74, 99328
  s_nop 0
  buffer_load_dwordx4 v7, s[40:43], s76 offen  lds
  s_add_u32 s76, s75, 3211264
  s_add_u32 m0, s74, 100352
  s_nop 0
  buffer_load_dwordx4 v8, s[40:43], s76 offen  lds
  s_add_u32 s76, s75, 3244032
  s_add_u32 m0, s74, 101376
  s_nop 0
  buffer_load_dwordx4 v9, s[40:43], s76 offen  lds
  s_add_u32 s76, s75, 3276800
  s_add_u32 m0, s74, 102400
  s_nop 0
  buffer_load_dwordx4 v6, s[40:43], s76 offen  lds
  s_add_u32 s76, s75, 3309568
  s_add_u32 m0, s74, 103424
  s_nop 0
  buffer_load_dwordx4 v7, s[40:43], s76 offen  lds
  s_add_u32 s76, s75, 3342336
  s_add_u32 m0, s74, 104448
  s_nop 0
  buffer_load_dwordx4 v8, s[40:43], s76 offen  lds
  s_add_u32 s76, s75, 3375104
  s_add_u32 m0, s74, 105472
  s_nop 0
  buffer_load_dwordx4 v9, s[40:43], s76 offen  lds
  s_waitcnt vmcnt(24)
  s_barrier
  s_add_u32 s76, s75, 4194304
  s_add_u32 m0, s74, 131072
  s_nop 0
  buffer_load_dwordx4 v6, s[40:43], s76 offen  lds
  s_add_u32 s76, s75, 4227072
  s_add_u32 m0, s74, 132096
  s_nop 0
  buffer_load_dwordx4 v7, s[40:43], s76 offen  lds
  s_add_u32 s76, s75, 4259840
  s_add_u32 m0, s74, 133120
  s_nop 0
  buffer_load_dwordx4 v8, s[40:43], s76 offen  lds
  s_add_u32 s76, s75, 4292608
  s_add_u32 m0, s74, 134144
  s_nop 0
  buffer_load_dwordx4 v9, s[40:43], s76 offen  lds
  s_add_u32 s76, s75, 4325376
  s_add_u32 m0, s74, 135168
  s_nop 0
  buffer_load_dwordx4 v6, s[40:43], s76 offen  lds
  s_add_u32 s76, s75, 4358144
  s_add_u32 m0, s74, 136192
  s_nop 0
  buffer_load_dwordx4 v7, s[40:43], s76 offen  lds
  s_add_u32 s76, s75, 4390912
  s_add_u32 m0, s74, 137216
  s_nop 0
  buffer_load_dwordx4 v8, s[40:43], s76 offen  lds
  s_add_u32 s76, s75, 4423680
  s_add_u32 m0, s74, 138240
  s_nop 0
  buffer_load_dwordx4 v9, s[40:43], s76 offen  lds
  v_add_u32 v10, 0, v2
  v_add_u32 v11, 0, v3
  ds_read_b64_tr_b16 v[32:33], v10 offset:0
  ds_read_b64_tr_b16 v[34:35], v10 offset:512
  ds_read_b64_tr_b16 v[36:37], v10 offset:8192
  ds_read_b64_tr_b16 v[38:39], v10 offset:8704
  ds_read_b64_tr_b16 v[40:41], v11 offset:0
  ds_read_b64_tr_b16 v[42:43], v11 offset:512
  ds_read_b64_tr_b16 v[44:45], v11 offset:8192
  ds_read_b64_tr_b16 v[46:47], v11 offset:8704
  ds_read_b64_tr_b16 a[0:1], v10 offset:16384
  ds_read_b64_tr_b16 a[2:3], v10 offset:16896
  ds_read_b64_tr_b16 a[4:5], v10 offset:24576
  ds_read_b64_tr_b16 a[6:7], v10 offset:25088
  ds_read_b64_tr_b16 a[8:9], v11 offset:16384
  ds_read_b64_tr_b16 a[10:11], v11 offset:16896
  ds_read_b64_tr_b16 a[12:13], v11 offset:24576
  ds_read_b64_tr_b16 a[14:15], v11 offset:25088
  s_waitcnt lgkmcnt(0)
  s_waitcnt vmcnt(24)
  s_barrier
  s_mov_b32 s40, s16
  s_mov_b32 s41, s17
  s_add_u32 s76, s75, 0
  s_add_u32 m0, s74, 0
  s_nop 0
  buffer_load_dwordx4 v6, s[40:43], s76 offen  lds
  s_add_u32 s76, s75, 32768
  s_add_u32 m0, s74, 1024
  s_nop 0
  buffer_load_dwordx4 v7, s[40:43], s76 offen  lds
  s_add_u32 s76, s75, 65536
  s_add_u32 m0, s74, 2048
  s_nop 0
  buffer_load_dwordx4 v8, s[40:43], s76 offen  lds
  s_add_u32 s76, s75, 98304
  s_add_u32 m0, s74, 3072
  s_nop 0
  buffer_load_dwordx4 v9, s[40:43], s76 offen  lds
  s_add_u32 s76, s75, 131072
  s_add_u32 m0, s74, 4096
  s_nop 0
  buffer_load_dwordx4 v6, s[40:43], s76 offen  lds
  s_add_u32 s76, s75, 163840
  s_add_u32 m0, s74, 5120
  s_nop 0
  buffer_load_dwordx4 v7, s[40:43], s76 offen  lds
  s_add_u32 s76, s75, 196608
  s_add_u32 m0, s74, 6144
  s_nop 0
  buffer_load_dwordx4 v8, s[40:43], s76 offen  lds
  s_add_u32 s76, s75, 229376
  s_add_u32 m0, s74, 7168
  s_nop 0
  buffer_load_dwordx4 v9, s[40:43], s76 offen  lds
  v_add_u32 v10, 32768, v2
  v_add_u32 v11, 32768, v3
  ds_read_b64_tr_b16 a[16:17], v10 offset:0
  ds_read_b64_tr_b16 a[18:19], v10 offset:512
  ds_read_b64_tr_b16 a[20:21], v10 offset:8192
  ds_read_b64_tr_b16 a[22:23], v10 offset:8704
  ds_read_b64_tr_b16 a[24:25], v11 offset:0
  ds_read_b64_tr_b16 a[26:27], v11 offset:512
  ds_read_b64_tr_b16 a[28:29], v11 offset:8192
  ds_read_b64_tr_b16 a[30:31], v11 offset:8704
  ds_read_b64_tr_b16 v[64:65], v10 offset:16384
  ds_read_b64_tr_b16 v[66:67], v10 offset:16896
  ds_read_b64_tr_b16 v[68:69], v10 offset:24576
  ds_read_b64_tr_b16 v[70:71], v10 offset:25088
  ds_read_b64_tr_b16 v[72:73], v11 offset:16384
  ds_read_b64_tr_b16 v[74:75], v11 offset:16896
  ds_read_b64_tr_b16 v[76:77], v11 offset:24576
  ds_read_b64_tr_b16 v[78:79], v11 offset:25088
  s_waitcnt lgkmcnt(0)
  s_waitcnt vmcnt(24)
  s_barrier
  s_add_u32 s76, s75, 1048576
  s_add_u32 m0, s74, 32768
  s_nop 0
  buffer_load_dwordx4 v6, s[40:43], s76 offen  lds
  s_add_u32 s76, s75, 1081344
  s_add_u32 m0, s74, 33792
  s_nop 0
  buffer_load_dwordx4 v7, s[40:43], s76 offen  lds
  s_add_u32 s76, s75, 1114112
  s_add_u32 m0, s74, 34816
  s_nop 0
  buffer_load_dwordx4 v8, s[40:43], s76 offen  lds
  s_add_u32 s76, s75, 1146880
  s_add_u32 m0, s74, 35840
  s_nop 0
  buffer_load_dwordx4 v9, s[40:43], s76 offen  lds
  s_add_u32 s76, s75, 1179648
  s_add_u32 m0, s74, 36864
  s_nop 0
  buffer_load_dwordx4 v6, s[40:43], s76 offen  lds
  s_add_u32 s76, s75, 1212416
  s_add_u32 m0, s74, 37888
  s_nop 0
  buffer_load_dwordx4 v7, s[40:43], s76 offen  lds
  s_add_u32 s76, s75, 1245184
  s_add_u32 m0, s74, 38912
  s_nop 0
  buffer_load_dwordx4 v8, s[40:43], s76 offen  lds
  s_add_u32 s76, s75, 1277952
  s_add_u32 m0, s74, 39936
  s_nop 0
  buffer_load_dwordx4 v9, s[40:43], s76 offen  lds
  v_add_u32 v10, 65536, v2
  v_add_u32 v11, 65536, v3
  ds_read_b64_tr_b16 a[32:33], v10 offset:0
  ds_read_b64_tr_b16 a[34:35], v10 offset:512
  ds_read_b64_tr_b16 a[36:37], v10 offset:8192
  ds_read_b64_tr_b16 a[38:39], v10 offset:8704
  ds_read_b64_tr_b16 a[40:41], v11 offset:0
  ds_read_b64_tr_b16 a[42:43], v11 offset:512
  ds_read_b64_tr_b16 a[44:45], v11 offset:8192
  ds_read_b64_tr_b16 a[46:47], v11 offset:8704
  ds_read_b64_tr_b16 a[48:49], v10 offset:16384
  ds_read_b64_tr_b16 a[50:51], v10 offset:16896
  ds_read_b64_tr_b16 a[52:53], v10 offset:24576
  ds_read_b64_tr_b16 a[54:55], v10 offset:25088
  ds_read_b64_tr_b16 a[56:57], v11 offset:16384
  ds_read_b64_tr_b16 a[58:59], v11 offset:16896
  ds_read_b64_tr_b16 a[60:61], v11 offset:24576
  ds_read_b64_tr_b16 a[62:63], v11 offset:25088
  s_waitcnt lgkmcnt(0)
  s_waitcnt vmcnt(24)
  s_barrier
  s_add_u32 s76, s75, 2097152
  s_add_u32 m0, s74, 65536
  s_nop 0
  buffer_load_dwordx4 v6, s[40:43], s76 offen  lds
  s_add_u32 s76, s75, 2129920
  s_add_u32 m0, s74, 66560
  s_nop 0
  buffer_load_dwordx4 v7, s[40:43], s76 offen  lds
  s_add_u32 s76, s75, 2162688
  s_add_u32 m0, s74, 67584
  s_nop 0
  buffer_load_dwordx4 v8, s[40:43], s76 offen  lds
  s_add_u32 s76, s75, 2195456
  s_add_u32 m0, s74, 68608
  s_nop 0
  buffer_load_dwordx4 v9, s[40:43], s76 offen  lds
  s_add_u32 s76, s75, 2228224
  s_add_u32 m0, s74, 69632
  s_nop 0
  buffer_load_dwordx4 v6, s[40:43], s76 offen  lds
  s_add_u32 s76, s75, 2260992
  s_add_u32 m0, s74, 70656
  s_nop 0
  buffer_load_dwordx4 v7, s[40:43], s76 offen  lds
  s_add_u32 s76, s75, 2293760
  s_add_u32 m0, s74, 71680
  s_nop 0
  buffer_load_dwordx4 v8, s[40:43], s76 offen  lds
  s_add_u32 s76, s75, 2326528
  s_add_u32 m0, s74, 72704
  s_nop 0
  buffer_load_dwordx4 v9, s[40:43], s76 offen  lds
  v_add_u32 v10, 98304, v2
  v_add_u32 v11, 98304, v3
  ds_read_b64_tr_b16 v[96:97], v10 offset:0
  ds_read_b64_tr_b16 v[98:99], v10 offset:512
  ds_read_b64_tr_b16 v[100:101], v10 offset:8192
  ds_read_b64_tr_b16 v[102:103], v10 offset:8704
  ds_read_b64_tr_b16 v[104:105], v11 offset:0
  ds_read_b64_tr_b16 v[106:107], v11 offset:512
  ds_read_b64_tr_b16 v[108:109], v11 offset:8192
  ds_read_b64_tr_b16 v[110:111], v11 offset:8704
  ds_read_b64_tr_b16 a[64:65], v10 offset:16384
  ds_read_b64_tr_b16 a[66:67], v10 offset:16896
  ds_read_b64_tr_b16 a[68:69], v10 offset:24576
  ds_read_b64_tr_b16 a[70:71], v10 offset:25088
  ds_read_b64_tr_b16 a[72:73], v11 offset:16384
  ds_read_b64_tr_b16 a[74:75], v11 offset:16896
  ds_read_b64_tr_b16 a[76:77], v11 offset:24576
  ds_read_b64_tr_b16 a[78:79], v11 offset:25088
  s_waitcnt lgkmcnt(0)
  s_waitcnt vmcnt(24)
  s_barrier
  s_add_u32 s76, s75, 3145728
  s_add_u32 m0, s74, 98304
  s_nop 0
  buffer_load_dwordx4 v6, s[40:43], s76 offen  lds
  s_add_u32 s76, s75, 3178496
  s_add_u32 m0, s74, 99328
  s_nop 0
  buffer_load_dwordx4 v7, s[40:43], s76 offen  lds
  s_add_u32 s76, s75, 3211264
  s_add_u32 m0, s74, 100352
  s_nop 0
  buffer_load_dwordx4 v8, s[40:43], s76 offen  lds
  s_add_u32 s76, s75, 3244032
  s_add_u32 m0, s74, 101376
  s_nop 0
  buffer_load_dwordx4 v9, s[40:43], s76 offen  lds
  s_add_u32 s76, s75, 3276800
  s_add_u32 m0, s74, 102400
  s_nop 0
  buffer_load_dwordx4 v6, s[40:43], s76 offen  lds
  s_add_u32 s76, s75, 3309568
  s_add_u32 m0, s74, 103424
  s_nop 0
  buffer_load_dwordx4 v7, s[40:43], s76 offen  lds
  s_add_u32 s76, s75, 3342336
  s_add_u32 m0, s74, 104448
  s_nop 0
  buffer_load_dwordx4 v8, s[40:43], s76 offen  lds
  s_add_u32 s76, s75, 3375104
  s_add_u32 m0, s74, 105472
  s_nop 0
  buffer_load_dwordx4 v9, s[40:43], s76 offen  lds
  v_add_u32 v10, 131072, v2
  v_add_u32 v11, 131072, v3
  ds_read_b64_tr_b16 a[80:81], v10 offset:0
  ds_read_b64_tr_b16 a[82:83], v10 offset:512
  ds_read_b64_tr_b16 a[84:85], v10 offset:8192
  ds_read_b64_tr_b16 a[86:87], v10 offset:8704
  ds_read_b64_tr_b16 a[88:89], v11 offset:0
  ds_read_b64_tr_b16 a[90:91], v11 offset:512
  ds_read_b64_tr_b16 a[92:93], v11 offset:8192
  ds_read_b64_tr_b16 a[94:95], v11 offset:8704
  ds_read_b64_tr_b16 a[96:97], v10 offset:16384
  ds_read_b64_tr_b16 a[98:99], v10 offset:16896
  ds_read_b64_tr_b16 a[100:101], v10 offset:24576
  ds_read_b64_tr_b16 a[102:103], v10 offset:25088
  ds_read_b64_tr_b16 a[104:105], v11 offset:16384
  ds_read_b64_tr_b16 a[106:107], v11 offset:16896
  ds_read_b64_tr_b16 a[108:109], v11 offset:24576
  ds_read_b64_tr_b16 a[110:111], v11 offset:25088
  s_waitcnt lgkmcnt(0)
  s_waitcnt vmcnt(24)
  s_barrier
  s_add_u32 s76, s75, 4194304
  s_add_u32 m0, s74, 131072
  s_nop 0
  buffer_load_dwordx4 v6, s[40:43], s76 offen  lds
  s_add_u32 s76, s75, 4227072
  s_add_u32 m0, s74, 132096
  s_nop 0
  buffer_load_dwordx4 v7, s[40:43], s76 offen  lds
  s_add_u32 s76, s75, 4259840
  s_add_u32 m0, s74, 133120
  s_nop 0
  buffer_load_dwordx4 v8, s[40:43], s76 offen  lds
  s_add_u32 s76, s75, 4292608
  s_add_u32 m0, s74, 134144
  s_nop 0
  buffer_load_dwordx4 v9, s[40:43], s76 offen  lds
  s_add_u32 s76, s75, 4325376
  s_add_u32 m0, s74, 135168
  s_nop 0
  buffer_load_dwordx4 v6, s[40:43], s76 offen  lds
  s_add_u32 s76, s75, 4358144
  s_add_u32 m0, s74, 136192
  s_nop 0
  buffer_load_dwordx4 v7, s[40:43], s76 offen  lds
  s_add_u32 s76, s75, 4390912
  s_add_u32 m0, s74, 137216
  s_nop 0
  buffer_load_dwordx4 v8, s[40:43], s76 offen  lds
  s_add_u32 s76, s75, 4423680
  s_add_u32 m0, s74, 138240
  s_nop 0
  buffer_load_dwordx4 v9, s[40:43], s76 offen  lds
  v_add_u32 v10, 0, v2
  v_add_u32 v11, 0, v3
  ds_read_b64_tr_b16 a[112:113], v10 offset:0
  ds_read_b64_tr_b16 a[114:115], v10 offset:512
  ds_read_b64_tr_b16 a[116:117], v10 offset:8192
  ds_read_b64_tr_b16 a[118:119], v10 offset:8704
  ds_read_b64_tr_b16 a[120:121], v11 offset:0
  ds_read_b64_tr_b16 a[122:123], v11 offset:512
  ds_read_b64_tr_b16 a[124:125], v11 offset:8192
  ds_read_b64_tr_b16 a[126:127], v11 offset:8704
  ds_read_b64_tr_b16 v[48:49], v10 offset:16384
  ds_read_b64_tr_b16 v[50:51], v10 offset:16896
  ds_read_b64_tr_b16 v[52:53], v10 offset:24576
  ds_read_b64_tr_b16 v[54:55], v10 offset:25088
  ds_read_b64_tr_b16 v[56:57], v11 offset:16384
  ds_read_b64_tr_b16 v[58:59], v11 offset:16896
  ds_read_b64_tr_b16 v[60:61], v11 offset:24576
  ds_read_b64_tr_b16 v[62:63], v11 offset:25088
  s_waitcnt lgkmcnt(0)
  s_waitcnt vmcnt(24)
  s_barrier
  s_mov_b32 s40, s18
  s_mov_b32 s41, s19
  s_add_u32 s76, s75, 0
  s_add_u32 m0, s74, 0
  s_nop 0
  buffer_load_dwordx4 v6, s[40:43], s76 offen  lds
  s_add_u32 s76, s75, 32768
  s_add_u32 m0, s74, 1024
  s_nop 0
  buffer_load_dwordx4 v7, s[40:43], s76 offen  lds
  s_add_u32 s76, s75, 65536
  s_add_u32 m0, s74, 2048
  s_nop 0
  buffer_load_dwordx4 v8, s[40:43], s76 offen  lds
  s_add_u32 s76, s75, 98304
  s_add_u32 m0, s74, 3072
  s_nop 0
  buffer_load_dwordx4 v9, s[40:43], s76 offen  lds
  s_add_u32 s76, s75, 131072
  s_add_u32 m0, s74, 4096
  s_nop 0
  buffer_load_dwordx4 v6, s[40:43], s76 offen  lds
  s_add_u32 s76, s75, 163840
  s_add_u32 m0, s74, 5120
  s_nop 0
  buffer_load_dwordx4 v7, s[40:43], s76 offen  lds
  s_add_u32 s76, s75, 196608
  s_add_u32 m0, s74, 6144
  s_nop 0
  buffer_load_dwordx4 v8, s[40:43], s76 offen  lds
  s_add_u32 s76, s75, 229376
  s_add_u32 m0, s74, 7168
  s_nop 0
  buffer_load_dwordx4 v9, s[40:43], s76 offen  lds
  v_add_u32 v10, 32768, v2
  v_add_u32 v11, 32768, v3
  ds_read_b64_tr_b16 a[128:129], v10 offset:0
  ds_read_b64_tr_b16 a[130:131], v10 offset:512
  ds_read_b64_tr_b16 a[132:133], v10 offset:8192
  ds_read_b64_tr_b16 a[134:135], v10 offset:8704
  ds_read_b64_tr_b16 a[136:137], v11 offset:0
  ds_read_b64_tr_b16 a[138:139], v11 offset:512
  ds_read_b64_tr_b16 a[140:141], v11 offset:8192
  ds_read_b64_tr_b16 a[142:143], v11 offset:8704
  ds_read_b64_tr_b16 a[144:145], v10 offset:16384
  ds_read_b64_tr_b16 a[146:147], v10 offset:16896
  ds_read_b64_tr_b16 a[148:149], v10 offset:24576
  ds_read_b64_tr_b16 a[150:151], v10 offset:25088
  ds_read_b64_tr_b16 a[152:153], v11 offset:16384
  ds_read_b64_tr_b16 a[154:155], v11 offset:16896
  ds_read_b64_tr_b16 a[156:157], v11 offset:24576
  ds_read_b64_tr_b16 a[158:159], v11 offset:25088
  s_waitcnt lgkmcnt(0)
  s_waitcnt vmcnt(24)
  s_barrier
  s_add_u32 s76, s75, 1048576
  s_add_u32 m0, s74, 32768
  s_nop 0
  buffer_load_dwordx4 v6, s[40:43], s76 offen  lds
  s_add_u32 s76, s75, 1081344
  s_add_u32 m0, s74, 33792
  s_nop 0
  buffer_load_dwordx4 v7, s[40:43], s76 offen  lds
  s_add_u32 s76, s75, 1114112
  s_add_u32 m0, s74, 34816
  s_nop 0
  buffer_load_dwordx4 v8, s[40:43], s76 offen  lds
  s_add_u32 s76, s75, 1146880
  s_add_u32 m0, s74, 35840
  s_nop 0
  buffer_load_dwordx4 v9, s[40:43], s76 offen  lds
  s_add_u32 s76, s75, 1179648
  s_add_u32 m0, s74, 36864
  s_nop 0
  buffer_load_dwordx4 v6, s[40:43], s76 offen  lds
  s_add_u32 s76, s75, 1212416
  s_add_u32 m0, s74, 37888
  s_nop 0
  buffer_load_dwordx4 v7, s[40:43], s76 offen  lds
  s_add_u32 s76, s75, 1245184
  s_add_u32 m0, s74, 38912
  s_nop 0
  buffer_load_dwordx4 v8, s[40:43], s76 offen  lds
  s_add_u32 s76, s75, 1277952
  s_add_u32 m0, s74, 39936
  s_nop 0
  buffer_load_dwordx4 v9, s[40:43], s76 offen  lds
  v_add_u32 v10, 65536, v2
  v_add_u32 v11, 65536, v3
  ds_read_b64_tr_b16 v[80:81], v10 offset:0
  ds_read_b64_tr_b16 v[82:83], v10 offset:512
  ds_read_b64_tr_b16 v[84:85], v10 offset:8192
  ds_read_b64_tr_b16 v[86:87], v10 offset:8704
  ds_read_b64_tr_b16 v[88:89], v11 offset:0
  ds_read_b64_tr_b16 v[90:91], v11 offset:512
  ds_read_b64_tr_b16 v[92:93], v11 offset:8192
  ds_read_b64_tr_b16 v[94:95], v11 offset:8704
  ds_read_b64_tr_b16 a[160:161], v10 offset:16384
  ds_read_b64_tr_b16 a[162:163], v10 offset:16896
  ds_read_b64_tr_b16 a[164:165], v10 offset:24576
  ds_read_b64_tr_b16 a[166:167], v10 offset:25088
  ds_read_b64_tr_b16 a[168:169], v11 offset:16384
  ds_read_b64_tr_b16 a[170:171], v11 offset:16896
  ds_read_b64_tr_b16 a[172:173], v11 offset:24576
  ds_read_b64_tr_b16 a[174:175], v11 offset:25088
  s_waitcnt lgkmcnt(0)
  s_waitcnt vmcnt(24)
  s_barrier
  s_add_u32 s76, s75, 2097152
  s_add_u32 m0, s74, 65536
  s_nop 0
  buffer_load_dwordx4 v6, s[40:43], s76 offen  lds
  s_add_u32 s76, s75, 2129920
  s_add_u32 m0, s74, 66560
  s_nop 0
  buffer_load_dwordx4 v7, s[40:43], s76 offen  lds
  s_add_u32 s76, s75, 2162688
  s_add_u32 m0, s74, 67584
  s_nop 0
  buffer_load_dwordx4 v8, s[40:43], s76 offen  lds
  s_add_u32 s76, s75, 2195456
  s_add_u32 m0, s74, 68608
  s_nop 0
  buffer_load_dwordx4 v9, s[40:43], s76 offen  lds
  s_add_u32 s76, s75, 2228224
  s_add_u32 m0, s74, 69632
  s_nop 0
  buffer_load_dwordx4 v6, s[40:43], s76 offen  lds
  s_add_u32 s76, s75, 2260992
  s_add_u32 m0, s74, 70656
  s_nop 0
  buffer_load_dwordx4 v7, s[40:43], s76 offen  lds
  s_add_u32 s76, s75, 2293760
  s_add_u32 m0, s74, 71680
  s_nop 0
  buffer_load_dwordx4 v8, s[40:43], s76 offen  lds
  s_add_u32 s76, s75, 2326528
  s_add_u32 m0, s74, 72704
  s_nop 0
  buffer_load_dwordx4 v9, s[40:43], s76 offen  lds
  v_add_u32 v10, 98304, v2
  v_add_u32 v11, 98304, v3
  ds_read_b64_tr_b16 a[176:177], v10 offset:0
  ds_read_b64_tr_b16 a[178:179], v10 offset:512
  ds_read_b64_tr_b16 a[180:181], v10 offset:8192
  ds_read_b64_tr_b16 a[182:183], v10 offset:8704
  ds_read_b64_tr_b16 a[184:185], v11 offset:0
  ds_read_b64_tr_b16 a[186:187], v11 offset:512
  ds_read_b64_tr_b16 a[188:189], v11 offset:8192
  ds_read_b64_tr_b16 a[190:191], v11 offset:8704
  ds_read_b64_tr_b16 a[192:193], v10 offset:16384
  ds_read_b64_tr_b16 a[194:195], v10 offset:16896
  ds_read_b64_tr_b16 a[196:197], v10 offset:24576
  ds_read_b64_tr_b16 a[198:199], v10 offset:25088
  ds_read_b64_tr_b16 a[200:201], v11 offset:16384
  ds_read_b64_tr_b16 a[202:203], v11 offset:16896
  ds_read_b64_tr_b16 a[204:205], v11 offset:24576
  ds_read_b64_tr_b16 a[206:207], v11 offset:25088
  s_waitcnt lgkmcnt(0)
  s_waitcnt vmcnt(24)
  s_barrier
  s_add_u32 s76, s75, 3145728
  s_add_u32 m0, s74, 98304
  s_nop 0
  buffer_load_dwordx4 v6, s[40:43], s76 offen  lds
  s_add_u32 s76, s75, 3178496
  s_add_u32 m0, s74, 99328
  s_nop 0
  buffer_load_dwordx4 v7, s[40:43], s76 offen  lds
  s_add_u32 s76, s75, 3211264
  s_add_u32 m0, s74, 100352
  s_nop 0
  buffer_load_dwordx4 v8, s[40:43], s76 offen  lds
  s_add_u32 s76, s75, 3244032
  s_add_u32 m0, s74, 101376
  s_nop 0
  buffer_load_dwordx4 v9, s[40:43], s76 offen  lds
  s_add_u32 s76, s75, 3276800
  s_add_u32 m0, s74, 102400
  s_nop 0
  buffer_load_dwordx4 v6, s[40:43], s76 offen  lds
  s_add_u32 s76, s75, 3309568
  s_add_u32 m0, s74, 103424
  s_nop 0
  buffer_load_dwordx4 v7, s[40:43], s76 offen  lds
  s_add_u32 s76, s75, 3342336
  s_add_u32 m0, s74, 104448
  s_nop 0
  buffer_load_dwordx4 v8, s[40:43], s76 offen  lds
  s_add_u32 s76, s75, 3375104
  s_add_u32 m0, s74, 105472
  s_nop 0
  buffer_load_dwordx4 v9, s[40:43], s76 offen  lds
  v_add_u32 v10, 131072, v2
  v_add_u32 v11, 131072, v3
  ds_read_b64_tr_b16 a[208:209], v10 offset:0
  ds_read_b64_tr_b16 a[210:211], v10 offset:512
  ds_read_b64_tr_b16 a[212:213], v10 offset:8192
  ds_read_b64_tr_b16 a[214:215], v10 offset:8704
  ds_read_b64_tr_b16 a[216:217], v11 offset:0
  ds_read_b64_tr_b16 a[218:219], v11 offset:512
  ds_read_b64_tr_b16 a[220:221], v11 offset:8192
  ds_read_b64_tr_b16 a[222:223], v11 offset:8704
  ds_read_b64_tr_b16 a[224:225], v10 offset:16384
  ds_read_b64_tr_b16 a[226:227], v10 offset:16896
  ds_read_b64_tr_b16 a[228:229], v10 offset:24576
  ds_read_b64_tr_b16 a[230:231], v10 offset:25088
  ds_read_b64_tr_b16 a[232:233], v11 offset:16384
  ds_read_b64_tr_b16 a[234:235], v11 offset:16896
  ds_read_b64_tr_b16 a[236:237], v11 offset:24576
  ds_read_b64_tr_b16 a[238:239], v11 offset:25088
  s_waitcnt lgkmcnt(0)
  s_waitcnt vmcnt(24)
  s_barrier
  s_add_u32 s76, s75, 4194304
  s_add_u32 m0, s74, 131072
  s_nop 0
  buffer_load_dwordx4 v6, s[40:43], s76 offen  lds
  s_add_u32 s76, s75, 4227072
  s_add_u32 m0, s74, 132096
  s_nop 0
  buffer_load_dwordx4 v7, s[40:43], s76 offen  lds
  s_add_u32 s76, s75, 4259840
  s_add_u32 m0, s74, 133120
  s_nop 0
  buffer_load_dwordx4 v8, s[40:43], s76 offen  lds
  s_add_u32 s76, s75, 4292608
  s_add_u32 m0, s74, 134144
  s_nop 0
  buffer_load_dwordx4 v9, s[40:43], s76 offen  lds
  s_add_u32 s76, s75, 4325376
  s_add_u32 m0, s74, 135168
  s_nop 0
  buffer_load_dwordx4 v6, s[40:43], s76 offen  lds
  s_add_u32 s76, s75, 4358144
  s_add_u32 m0, s74, 136192
  s_nop 0
  buffer_load_dwordx4 v7, s[40:43], s76 offen  lds
  s_add_u32 s76, s75, 4390912
  s_add_u32 m0, s74, 137216
  s_nop 0
  buffer_load_dwordx4 v8, s[40:43], s76 offen  lds
  s_add_u32 s76, s75, 4423680
  s_add_u32 m0, s74, 138240
  s_nop 0
  buffer_load_dwordx4 v9, s[40:43], s76 offen  lds
  v_add_u32 v10, 0, v2
  v_add_u32 v11, 0, v3
  ds_read_b64_tr_b16 v[112:113], v10 offset:0
  ds_read_b64_tr_b16 v[114:115], v10 offset:512
  ds_read_b64_tr_b16 v[116:117], v10 offset:8192
  ds_read_b64_tr_b16 v[118:119], v10 offset:8704
  ds_read_b64_tr_b16 v[120:121], v11 offset:0
  ds_read_b64_tr_b16 v[122:123], v11 offset:512
  ds_read_b64_tr_b16 v[124:125], v11 offset:8192
  ds_read_b64_tr_b16 v[126:127], v11 offset:8704
  ds_read_b64_tr_b16 v[128:129], v10 offset:16384
  ds_read_b64_tr_b16 v[130:131], v10 offset:16896
  ds_read_b64_tr_b16 v[132:133], v10 offset:24576
  ds_read_b64_tr_b16 v[134:135], v10 offset:25088
  ds_read_b64_tr_b16 v[136:137], v11 offset:16384
  ds_read_b64_tr_b16 v[138:139], v11 offset:16896
  ds_read_b64_tr_b16 v[140:141], v11 offset:24576
  ds_read_b64_tr_b16 v[142:143], v11 offset:25088
  s_waitcnt lgkmcnt(0)
  s_waitcnt vmcnt(24)
  s_barrier
  v_add_u32 v10, 32768, v2
  v_add_u32 v11, 32768, v3
  ds_read_b64_tr_b16 a[240:241], v10 offset:0
  ds_read_b64_tr_b16 a[242:243], v10 offset:512
  ds_read_b64_tr_b16 a[244:245], v10 offset:8192
  ds_read_b64_tr_b16 a[246:247], v10 offset:8704
  ds_read_b64_tr_b16 a[248:249], v11 offset:0
  ds_read_b64_tr_b16 a[250:251], v11 offset:512
  ds_read_b64_tr_b16 a[252:253], v11 offset:8192
  ds_read_b64_tr_b16 a[254:255], v11 offset:8704
  ds_read_b64_tr_b16 v[160:161], v10 offset:16384
  ds_read_b64_tr_b16 v[162:163], v10 offset:16896
  ds_read_b64_tr_b16 v[164:165], v10 offset:24576
  ds_read_b64_tr_b16 v[166:167], v10 offset:25088
  ds_read_b64_tr_b16 v[168:169], v11 offset:16384
  ds_read_b64_tr_b16 v[170:171], v11 offset:16896
  ds_read_b64_tr_b16 v[172:173], v11 offset:24576
  ds_read_b64_tr_b16 v[174:175], v11 offset:25088
  s_waitcnt lgkmcnt(0)
  s_waitcnt vmcnt(16)
  s_barrier
  v_add_u32 v10, 65536, v2
  v_add_u32 v11, 65536, v3
  ds_read_b64_tr_b16 v[176:177], v10 offset:0
  ds_read_b64_tr_b16 v[178:179], v10 offset:512
  ds_read_b64_tr_b16 v[180:181], v10 offset:8192
  ds_read_b64_tr_b16 v[182:183], v10 offset:8704
  ds_read_b64_tr_b16 v[184:185], v11 offset:0
  ds_read_b64_tr_b16 v[186:187], v11 offset:512
  ds_read_b64_tr_b16 v[188:189], v11 offset:8192
  ds_read_b64_tr_b16 v[190:191], v11 offset:8704
  ds_read_b64_tr_b16 v[192:193], v10 offset:16384
  ds_read_b64_tr_b16 v[194:195], v10 offset:16896
  ds_read_b64_tr_b16 v[196:197], v10 offset:24576
  ds_read_b64_tr_b16 v[198:199], v10 offset:25088
  ds_read_b64_tr_b16 v[200:201], v11 offset:16384
  ds_read_b64_tr_b16 v[202:203], v11 offset:16896
  ds_read_b64_tr_b16 v[204:205], v11 offset:24576
  ds_read_b64_tr_b16 v[206:207], v11 offset:25088
  s_waitcnt lgkmcnt(0)
  s_waitcnt vmcnt(8)
  s_barrier
  v_add_u32 v10, 98304, v2
  v_add_u32 v11, 98304, v3
  ds_read_b64_tr_b16 v[208:209], v10 offset:0
  ds_read_b64_tr_b16 v[210:211], v10 offset:512
  ds_read_b64_tr_b16 v[212:213], v10 offset:8192
  ds_read_b64_tr_b16 v[214:215], v10 offset:8704
  ds_read_b64_tr_b16 v[216:217], v11 offset:0
  ds_read_b64_tr_b16 v[218:219], v11 offset:512
  ds_read_b64_tr_b16 v[220:221], v11 offset:8192
  ds_read_b64_tr_b16 v[222:223], v11 offset:8704
  ds_read_b64_tr_b16 v[144:145], v10 offset:16384
  ds_read_b64_tr_b16 v[146:147], v10 offset:16896
  ds_read_b64_tr_b16 v[148:149], v10 offset:24576
  ds_read_b64_tr_b16 v[150:151], v10 offset:25088
  ds_read_b64_tr_b16 v[152:153], v11 offset:16384
  ds_read_b64_tr_b16 v[154:155], v11 offset:16896
  ds_read_b64_tr_b16 v[156:157], v11 offset:24576
  ds_read_b64_tr_b16 v[158:159], v11 offset:25088
  s_waitcnt lgkmcnt(0)
  s_waitcnt vmcnt(0)
  s_barrier
  v_add_u32 v10, 131072, v2
  v_add_u32 v11, 131072, v3
  ds_read_b64_tr_b16 v[224:225], v10 offset:0
  ds_read_b64_tr_b16 v[226:227], v10 offset:512
  ds_read_b64_tr_b16 v[228:229], v10 offset:8192
  ds_read_b64_tr_b16 v[230:231], v10 offset:8704
  ds_read_b64_tr_b16 v[232:233], v11 offset:0
  ds_read_b64_tr_b16 v[234:235], v11 offset:512
  ds_read_b64_tr_b16 v[236:237], v11 offset:8192
  ds_read_b64_tr_b16 v[238:239], v11 offset:8704
  ds_read_b64_tr_b16 v[240:241], v10 offset:16384
  ds_read_b64_tr_b16 v[242:243], v10 offset:16896
  ds_read_b64_tr_b16 v[244:245], v10 offset:24576
  ds_read_b64_tr_b16 v[246:247], v10 offset:25088
  ds_read_b64_tr_b16 v[248:249], v11 offset:16384
  ds_read_b64_tr_b16 v[250:251], v11 offset:16896
  ds_read_b64_tr_b16 v[252:253], v11 offset:24576
  ds_read_b64_tr_b16 v[254:255], v11 offset:25088
  s_waitcnt lgkmcnt(0)
  s_barrier
  v_lshlrev_b32 v11, 4, v1
  s_lshl_b32 s61, s56, 15
  v_add_u32 v7, s61, v11
  ds_write_b128 v7, v[32:35] offset:0
  ds_write_b128 v7, v[36:39] offset:1024
  ds_write_b128 v7, v[40:43] offset:2048
  ds_write_b128 v7, v[44:47] offset:3072
  ds_write_b128 v7, v[48:51] offset:4096
  ds_write_b128 v7, v[52:55] offset:5120
  ds_write_b128 v7, v[56:59] offset:6144
  ds_write_b128 v7, v[60:63] offset:7168
  ds_write_b128 v7, v[64:67] offset:8192
  ds_write_b128 v7, v[68:71] offset:9216
  ds_write_b128 v7, v[72:75] offset:10240
  ds_write_b128 v7, v[76:79] offset:11264
  ds_write_b128 v7, v[80:83] offset:12288
  ds_write_b128 v7, v[84:87] offset:13312
  ds_write_b128 v7, v[88:91] offset:14336
  ds_write_b128 v7, v[92:95] offset:15360
  ds_write_b128 v7, v[96:99] offset:16384
  ds_write_b128 v7, v[100:103] offset:17408
  ds_write_b128 v7, v[104:107] offset:18432
  ds_write_b128 v7, v[108:111] offset:19456
  ds_write_b128 v7, v[112:115] offset:20480
  ds_write_b128 v7, v[116:119] offset:21504
  ds_write_b128 v7, v[120:123] offset:22528
  ds_write_b128 v7, v[124:127] offset:23552
  ds_write_b128 v7, v[128:131] offset:24576
  ds_write_b128 v7, v[132:135] offset:25600
  ds_write_b128 v7, v[136:139] offset:26624
  ds_write_b128 v7, v[140:143] offset:27648
  ds_write_b128 v7, v[144:147] offset:28672
  ds_write_b128 v7, v[148:151] offset:29696
  ds_write_b128 v7, v[152:155] offset:30720
  ds_write_b128 v7, v[156:159] offset:31744
  v_lshlrev_b32 v2, 8, v22
  v_bfe_u32 v24, v1, 3, 1
  v_lshl_add_u32 v2, v24, 7, v2
  v_bfe_u32 v24, v1, 1, 2
  v_lshl_add_u32 v2, v24, 4, v2
  v_and_b32 v24, 1, v1
  v_lshl_add_u32 v2, v24, 6, v2
  v_and_b32 v25, 3, v1
  v_add_u32 v3, 4096, v2
  v_add_u32 v4, 16384, v2
  v_cmp_eq_u32 vcc, 0, v24
  v_mov_b32 v26, 0xeeee
  v_mov_b32 v27, 0x4444
  v_cndmask_b32 v6, v26, v27, vcc
  v_lshrrev_b32 v24, 2, v23
  v_xor_b32 v26, v22, v24
  v_lshlrev_b32 v26, 3, v26
  v_lshl_add_u32 v26, v23, 5, v26
  s_lshl_b32 s61, s56, 10
  s_add_u32 s61, s61, 155648
  v_add_u32 v8, s61, v26
  v_lshl_add_u32 v26, v22, 2, v24
  v_lshlrev_b32 v26, 5, v26
  v_add_u32 v26, 155648, v26
  v_xor_b32 v27, v25, v22
  v_lshl_add_u32 v9, v27, 3, v26
  v_add_u32 v12, 131072, v11
  v_min_u32 v14, 2, v1
  v_lshlrev_b32 v14, 12, v14
  s_and_b32 s61, s31, 3
  s_lshr_b32 s63, s31, 2
  v_min_u32 v0, 47, v1
  v_lshlrev_b32 v0, 9, v0
  v_lshrrev_b32 v13, 13, v0
  v_lshl_add_u32 v0, v13, 13, v0
  s_lshl_b32 s71, s61, 7
  v_add_u32 v0, s71, v0
  v_mov_b32 v13, s56
  v_lshlrev_b32 v13, 7, v13
  s_lshl_b32 s71, s61, 9
  v_add_u32 v13, s71, v13

  s_lshl_b32 s77, s31, 7
  s_add_u32 s77, s77, 88080384
  s_mul_i32 s78, s31, 24576
  s_add_u32 s78, s78, 4194304
  s_lshl_b32 s61, s56, 11
  s_add_u32 s78, s78, s61
  s_add_u32 s79, s61, 131072
  s_lshl_b32 s81, s31, 13
  s_lshl_b32 s61, s56, 10
  s_add_u32 s81, s81, s61
  s_add_u32 s81, s81, 54525952
  s_mov_b32 s82, 0x3e0293ee
  s_mov_b32 s84, 0xcccccccc
  s_mov_b32 s85, 0xcccccccc
  s_mov_b32 s89, 0
  s_mov_b32 s92, 0
  s_mov_b32 s90, s82
  s_mov_b32 s91, s82
  s_mov_b32 s74, 0x3f803f80
  s_mov_b32 s75, 0x3f003f00

  v_mov_b32 v28, 0xf149f2ca
  v_lshl_add_u32 v27, v22, 2, 0
  v_cmp_le_u32 vcc, v27, v23
  s_nop 1
  v_cndmask_b32 v32, v28, 0, vcc
  v_lshl_add_u32 v27, v22, 2, 1
  v_cmp_le_u32 vcc, v27, v23
  s_nop 1
  v_cndmask_b32 v33, v28, 0, vcc
  v_lshl_add_u32 v27, v22, 2, 2
  v_cmp_le_u32 vcc, v27, v23
  s_nop 1
  v_cndmask_b32 v34, v28, 0, vcc
  v_lshl_add_u32 v27, v22, 2, 3
  v_cmp_le_u32 vcc, v27, v23
  s_nop 1
  v_cndmask_b32 v35, v28, 0, vcc
  ds_write_b128 v12, v[32:35] offset:28672
  v_mov_b32 v21, 0
  s_movk_i32 s71, 16
  s_mov_b64 exec, 1
  s_mov_b32 s70, 0
SP_11:
  buffer_load_dword v20, v21, s[52:55], 0 offen sc1
  s_waitcnt vmcnt(0)
  v_cmp_gt_u32 vcc, s71, v20
  s_cbranch_vccz SD_12
  s_sleep 4
  s_add_u32 s70, s70, 1
  s_cmp_lt_u32 s70, 539568
  s_cbranch_scc1 SP_11
  s_endpgm
SD_12:
  s_mov_b64 exec, -1
  s_mov_b32 s62, 0
  s_mov_b32 s60, 0
  s_lshl_b32 s87, s56, 11
  s_add_u32 s87, s87, 8192
  s_mov_b32 s70, 0
KV_13:
  buffer_load_dword v21, v14, s[32:35], s77 offen sc1
  s_waitcnt vmcnt(0)
  v_cmp_gt_u32 vcc, 1, v21
  s_nop 0
  s_and_b32 s71, vcc_lo, 3
  s_cbranch_scc0 KD_14
  s_sleep 1
  s_add_u32 s70, s70, 1
  s_cmp_lt_u32 s70, 524288
  s_cbranch_scc1 KV_13
  s_endpgm
KD_14:
  s_waitcnt lgkmcnt(0)
  s_barrier
  v_mov_b32 v10, 0
  s_mov_b32 m0, s79
  s_add_u32 s67, s78, 8192
  buffer_load_dwordx4 v11, s[32:35], s67 offen sc1 lds
  buffer_load_dwordx4 v11, s[32:35], s67 offen offset:1024 sc1 lds
  s_add_u32 m0, s79, 8192
  s_add_u32 s67, s78, 16384
  buffer_load_dwordx4 v11, s[32:35], s67 offen sc1 lds
  buffer_load_dwordx4 v11, s[32:35], s67 offen offset:1024 sc1 lds
  ds_read_b128 v[80:83], v7 offset:0
  ds_read_b128 v[84:87], v7 offset:1024
  ds_read_b128 v[88:91], v7 offset:2048
  ds_read_b128 v[92:95], v7 offset:3072
  ds_read_b128 v[96:99], v7 offset:4096
  ds_read_b128 v[100:103], v7 offset:5120
  ds_read_b128 v[104:107], v7 offset:6144
  ds_read_b128 v[108:111], v7 offset:7168
  v_mov_b32 v56, 0
  v_mov_b32 v57, 0
  v_mov_b32 v58, 0
  v_mov_b32 v59, 0
  v_mov_b32 v60, 0
  v_mov_b32 v61, 0
  v_mov_b32 v62, 0
  v_mov_b32 v63, 0
  v_mov_b32 v64, 0
  v_mov_b32 v65, 0
  v_mov_b32 v66, 0
  v_mov_b32 v67, 0
  v_mov_b32 v68, 0
  v_mov_b32 v69, 0
  v_mov_b32 v70, 0
  v_mov_b32 v71, 0
  v_mov_b32 v72, 0
  v_mov_b32 v73, 0
  v_mov_b32 v74, 0
  v_mov_b32 v75, 0
  v_mov_b32 v76, 0
  v_mov_b32 v77, 0
  v_mov_b32 v78, 0
  v_mov_b32 v79, 0
  s_mov_b32 s76, 0x7ff00000
  s_mov_b32 s93, 0
  s_mov_b32 s86, 212992
L_t1loop:
  s_and_b32 s63, s60, 7
  s_lshl_b32 s63, s63, 18
  s_add_u32 s64, s63, s62
  s_add_u32 s65, s64, 131072
  s_add_u32 s66, s60, 1
  s_add_u32 s83, s64, s72

  s_add_u32 s71, s86, 0
  buffer_load_dword v44, v13, s[48:51], s71 offen offset:0 sc1
  s_nop 15
  s_nop 8
  s_add_u32 s71, s86, 0
  buffer_load_dword v45, v13, s[48:51], s71 offen offset:2048 sc1
  s_nop 15
  s_nop 8
  s_add_u32 s71, s86, 4096
  buffer_load_dword v46, v13, s[48:51], s71 offen offset:0 sc1
  s_nop 15
  s_nop 8
  s_add_u32 s71, s86, 4096
  buffer_load_dword v47, v13, s[48:51], s71 offen offset:2048 sc1
  s_waitcnt vmcnt(3)
  v_cmp_gt_u32 vcc, s66, v44
  s_cbranch_vccz PD_16
  s_add_u32 s71, s86, 16384
  buffer_load_dword v48, v13, s[48:51], s71 offen offset:0 sc1
  s_waitcnt vmcnt(3)
  v_cmp_gt_u32 vcc, s66, v45
  s_cbranch_vccz PD_16
  s_add_u32 s71, s86, 16384
  buffer_load_dword v49, v13, s[48:51], s71 offen offset:2048 sc1
  s_waitcnt vmcnt(3)
  v_cmp_gt_u32 vcc, s66, v46
  s_cbranch_vccz PD_16
  s_add_u32 s71, s86, 20480
  buffer_load_dword v50, v13, s[48:51], s71 offen offset:0 sc1
  s_waitcnt vmcnt(3)
  v_cmp_gt_u32 vcc, s66, v47
  s_cbranch_vccz PD_16
  s_add_u32 s71, s86, 20480
  buffer_load_dword v51, v13, s[48:51], s71 offen offset:2048 sc1
  s_waitcnt vmcnt(3)
  v_cmp_gt_u32 vcc, s66, v48
  s_cbranch_vccz PD_16
  s_add_u32 s71, s86, 32768
  buffer_load_dword v52, v13, s[48:51], s71 offen offset:0 sc1
  s_waitcnt vmcnt(3)
  v_cmp_gt_u32 vcc, s66, v49
  s_cbranch_vccz PD_16
  s_add_u32 s71, s86, 32768
  buffer_load_dword v53, v13, s[48:51], s71 offen offset:2048 sc1
  s_waitcnt vmcnt(3)
  v_cmp_gt_u32 vcc, s66, v50
  s_cbranch_vccz PD_16
  s_add_u32 s71, s86, 36864
  buffer_load_dword v54, v13, s[48:51], s71 offen offset:0 sc1
  s_waitcnt vmcnt(3)
  v_cmp_gt_u32 vcc, s66, v51
  s_cbranch_vccz PD_16
  s_add_u32 s71, s86, 36864
  buffer_load_dword v55, v13, s[48:51], s71 offen offset:2048 sc1
  s_waitcnt vmcnt(3)
  v_cmp_gt_u32 vcc, s66, v52
  s_cbranch_vccz PD_16
  s_waitcnt vmcnt(2)
  v_cmp_gt_u32 vcc, s66, v53
  s_cbranch_vccz PD_16
  s_waitcnt vmcnt(1)
  v_cmp_gt_u32 vcc, s66, v54
  s_cbranch_vccz PD_16
  s_waitcnt vmcnt(0)
  v_cmp_gt_u32 vcc, s66, v55
  s_cbranch_vccz PD_16
  s_mov_b32 s70, 0
PF_15:
  s_add_u32 s71, s86, 36864
  buffer_load_dword v55, v13, s[48:51], s71 offen offset:2048 sc1
  s_waitcnt vmcnt(0)
  v_cmp_gt_u32 vcc, s66, v55
  s_cbranch_vccz PD_16
  s_add_u32 s70, s70, 1
  s_cmp_lt_u32 s70, 524288
  s_cbranch_scc1 PF_15
  s_endpgm
PD_16:
  s_barrier
L_t1again:
  buffer_load_dwordx4 v[16:19], v2, s[48:51], s65 offen offset:0 sc1
  ds_read_b128 v[112:115], v12 offset:0
  v_mov_b32 v15, s66
  v_add_u32 v144, s87, v12
  s_nop 8
  buffer_load_dwordx4 v[20:23], v2, s[48:51], s65 offen offset:1024 sc1
  ds_read_b128 v[116:119], v12 offset:1024
  ds_read_b128 v[148:151], v144 offset:1024
  ds_read_b128 v[144:147], v144
  s_nop 8
  buffer_load_dwordx4 v[24:27], v2, s[48:51], s65 offen offset:2048 sc1
  ds_read_b128 v[120:123], v12 offset:2048
  s_nop 10
  buffer_load_dwordx4 v[28:31], v2, s[48:51], s65 offen offset:3072 sc1
  ds_read_b128 v[124:127], v12 offset:3072
  s_nop 10
  buffer_load_dwordx4 v[32:35], v3, s[48:51], s65 offen offset:0 sc1
  ds_read_b128 v[128:131], v12 offset:4096
  s_nop 10
  buffer_load_dwordx4 v[36:39], v3, s[48:51], s65 offen offset:1024 sc1
  ds_read_b128 v[132:135], v12 offset:5120
  s_nop 10
  buffer_load_dwordx4 v[40:43], v3, s[48:51], s65 offen offset:2048 sc1
  ds_read_b128 v[136:139], v12 offset:6144
  ds_read_b128 v[140:143], v12 offset:7168
  s_waitcnt vmcnt(6)
  buffer_load_dwordx4 v[44:47], v3, s[48:51], s65 offen offset:3072 sc1
  s_waitcnt lgkmcnt(14)
  v_smfmac_f32_16x16x64_bf16 v[56:59], v[16:19], v[80:87], v6
  ds_read_b128 v[80:83], v7 offset:8192
  v_smfmac_f32_16x16x64_bf16 v[60:63], v[16:19], v[88:95], v6
  ds_read_b128 v[84:87], v7 offset:9216
  v_smfmac_f32_16x16x64_bf16 v[64:67], v[16:19], a[112:119], v6
  ds_read_b128 v[88:91], v7 offset:10240
  v_smfmac_f32_16x16x64_bf16 v[68:71], v[16:19], a[120:127], v6
  s_waitcnt vmcnt(6)
  buffer_load_dwordx4 v[48:51], v4, s[48:51], s65 offen offset:0 sc1
  s_waitcnt lgkmcnt(13)
  v_smfmac_f32_16x16x64_bf16 v[64:67], v[20:23], v[96:103], v6
  ds_read_b128 v[92:95], v7 offset:11264
  v_smfmac_f32_16x16x64_bf16 v[68:71], v[20:23], v[104:111], v6
  ds_read_b128 v[96:99], v7 offset:12288
  v_smfmac_f32_16x16x64_bf16 v[56:59], v[20:23], a[0:7], v6
  ds_read_b128 v[100:103], v7 offset:13312
  v_smfmac_f32_16x16x64_bf16 v[60:63], v[20:23], a[8:15], v6
  s_waitcnt vmcnt(6)
  buffer_load_dwordx4 v[52:55], v4, s[48:51], s65 offen offset:1024 sc1
  v_smfmac_f32_16x16x64_bf16 v[56:59], v[24:27], a[16:23], v6
  ds_read_b128 v[104:107], v7 offset:14336
  v_smfmac_f32_16x16x64_bf16 v[60:63], v[24:27], a[24:31], v6
  ds_read_b128 v[108:111], v7 offset:15360
  v_smfmac_f32_16x16x64_bf16 v[64:67], v[24:27], a[128:135], v6
  v_smfmac_f32_16x16x64_bf16 v[68:71], v[24:27], a[136:143], v6
  s_waitcnt vmcnt(6)
  s_waitcnt lgkmcnt(4)
  v_smfmac_f32_16x16x64_bf16 v[56:59], v[28:31], v[80:87], v6
  ds_read_b128 v[80:83], v7 offset:16384
  v_smfmac_f32_16x16x64_bf16 v[60:63], v[28:31], v[88:95], v6
  ds_read_b128 v[84:87], v7 offset:17408
  v_smfmac_f32_16x16x64_bf16 v[64:67], v[28:31], a[144:151], v6
  ds_read_b128 v[88:91], v7 offset:18432
  v_smfmac_f32_16x16x64_bf16 v[68:71], v[28:31], a[152:159], v6
  ds_read_b128 v[92:95], v7 offset:19456
  s_waitcnt vmcnt(5)
  s_waitcnt lgkmcnt(4)
  v_smfmac_f32_16x16x64_bf16 v[64:67], v[32:35], v[96:103], v6
  ds_read_b128 v[96:99], v7 offset:20480
  v_smfmac_f32_16x16x64_bf16 v[68:71], v[32:35], v[104:111], v6
  ds_read_b128 v[100:103], v7 offset:21504
  v_smfmac_f32_16x16x64_bf16 v[56:59], v[32:35], a[32:39], v6
  ds_read_b128 v[104:107], v7 offset:22528
  v_smfmac_f32_16x16x64_bf16 v[60:63], v[32:35], a[40:47], v6
  ds_read_b128 v[108:111], v7 offset:23552
  s_waitcnt vmcnt(4)
  v_smfmac_f32_16x16x64_bf16 v[56:59], v[36:39], a[48:55], v6
  v_smfmac_f32_16x16x64_bf16 v[60:63], v[36:39], a[56:63], v6
  v_smfmac_f32_16x16x64_bf16 v[64:67], v[36:39], a[160:167], v6
  v_smfmac_f32_16x16x64_bf16 v[68:71], v[36:39], a[168:175], v6
  s_waitcnt vmcnt(3)
  s_waitcnt lgkmcnt(4)
  v_smfmac_f32_16x16x64_bf16 v[56:59], v[40:43], v[80:87], v6
  ds_read_b128 v[80:83], v7 offset:24576
  v_smfmac_f32_16x16x64_bf16 v[60:63], v[40:43], v[88:95], v6
  ds_read_b128 v[84:87], v7 offset:25600
  v_smfmac_f32_16x16x64_bf16 v[64:67], v[40:43], a[176:183], v6
  ds_read_b128 v[88:91], v7 offset:26624
  v_smfmac_f32_16x16x64_bf16 v[68:71], v[40:43], a[184:191], v6
  ds_read_b128 v[92:95], v7 offset:27648
  s_waitcnt vmcnt(2)
  v_smfmac_f32_16x16x64_bf16 v[56:59], v[44:47], a[64:71], v6
  v_smfmac_f32_16x16x64_bf16 v[60:63], v[44:47], a[72:79], v6
  v_smfmac_f32_16x16x64_bf16 v[64:67], v[44:47], a[192:199], v6
  v_smfmac_f32_16x16x64_bf16 v[68:71], v[44:47], a[200:207], v6
  s_waitcnt vmcnt(1)
  v_smfmac_f32_16x16x64_bf16 v[56:59], v[48:51], a[80:87], v6
  v_smfmac_f32_16x16x64_bf16 v[60:63], v[48:51], a[88:95], v6
  v_smfmac_f32_16x16x64_bf16 v[64:67], v[48:51], a[208:215], v6
  v_smfmac_f32_16x16x64_bf16 v[68:71], v[48:51], a[216:223], v6
  s_waitcnt vmcnt(0)
  s_cmp_ge_u32 s60, 61
  s_cbranch_scc1 L_t1ef
L_t1ef1:
  v_smfmac_f32_16x16x64_bf16 v[56:59], v[52:55], a[96:103], v6
  v_smfmac_f32_16x16x64_bf16 v[60:63], v[52:55], a[104:111], v6
  v_smfmac_f32_16x16x64_bf16 v[64:67], v[52:55], a[224:231], v6
  v_smfmac_f32_16x16x64_bf16 v[68:71], v[52:55], a[232:239], v6
L_t1ok:
  s_waitcnt lgkmcnt(4)
  v_smfmac_f32_16x16x64_bf16 v[72:75], v[16:19], v[96:103], v6
  v_smfmac_f32_16x16x64_bf16 v[76:79], v[16:19], v[104:111], v6
  s_waitcnt lgkmcnt(0)
  v_smfmac_f32_16x16x64_bf16 v[72:75], v[20:23], v[80:87], v6
  v_add_f32 v56, v56, v57
  v_add_f32 v58, v58, v59
  v_add_f32 v60, v60, v61
  v_add_f32 v62, v62, v63
  v_cmp_u_f32 vcc, v56, v58
  v_add_f32 v64, v64, v65
  v_add_f32 v66, v66, v67
  v_cvt_pk_bf16_f32 v65, v56, v58
  v_cvt_pk_bf16_f32 v64, v64, v66
  v_add_f32 v68, v68, v69
  v_add_f32 v70, v70, v71
  ds_write_b64 v8, v[64:65]
  v_cvt_pk_bf16_f32 v69, v60, v62
  v_cvt_pk_bf16_f32 v68, v68, v70
  s_cbranch_vccnz L_t1retry
L_t1go:
  ds_write_b64 v8, v[68:69] offset:512
  s_cmp_eq_u32 s60, 63
  s_cbranch_scc1 L_t1last
  v_smfmac_f32_16x16x64_bf16 v[76:79], v[20:23], v[88:95], v6
  v_smfmac_f32_16x16x64_bf16 v[72:75], v[24:27], a[240:247], v6
  v_smfmac_f32_16x16x64_bf16 v[76:79], v[24:27], a[248:255], v6
  v_smfmac_f32_16x16x64_bf16 v[72:75], v[28:31], v[160:167], v6
  s_waitcnt lgkmcnt(0)
  s_barrier
  ds_read_b64_tr_b16 v[80:81], v9 offset:0
  ds_read_b64_tr_b16 v[82:83], v9 offset:512
  ds_read_b64_tr_b16 v[84:85], v9 offset:1024
  ds_read_b64_tr_b16 v[86:87], v9 offset:1536
  ds_read_b64_tr_b16 v[88:89], v9 offset:2048
  ds_read_b64_tr_b16 v[90:91], v9 offset:2560
  ds_read_b64_tr_b16 v[92:93], v9 offset:3072
  ds_read_b64_tr_b16 v[94:95], v9 offset:3584
  v_smfmac_f32_16x16x64_bf16 v[76:79], v[28:31], v[168:175], v6
  v_smfmac_f32_16x16x64_bf16 v[72:75], v[32:35], v[176:183], v6
  s_waitcnt lgkmcnt(6)
  v_mfma_f32_16x16x32_bf16 v[56:59], v[112:115], v[80:83], 0
  v_mov_b32 v16, s74
  v_mfma_f32_16x16x32_bf16 v[60:63], v[128:131], v[80:83], 0
  v_mov_b32 v17, s74
  v_mfma_f32_16x16x32_bf16 v[64:67], v[80:83], v[80:83], 0
  v_mov_b32 v18, s74
  s_waitcnt lgkmcnt(4)
  v_mfma_f32_16x16x32_bf16 v[56:59], v[116:119], v[84:87], v[56:59]
  v_mov_b32 v19, s74
  v_mfma_f32_16x16x32_bf16 v[60:63], v[132:135], v[84:87], v[60:63]
  v_mov_b32 v20, s75
  v_mfma_f32_16x16x32_bf16 v[64:67], v[84:87], v[84:87], v[64:67]
  v_mov_b32 v21, s75
  s_waitcnt lgkmcnt(2)
  v_mfma_f32_16x16x32_bf16 v[56:59], v[120:123], v[88:91], v[56:59]
  v_mov_b32 v30, 0
  v_mfma_f32_16x16x32_bf16 v[60:63], v[136:139], v[88:91], v[60:63]
  v_mov_b32 v31, 0
  v_mfma_f32_16x16x32_bf16 v[64:67], v[88:91], v[88:91], v[64:67]
  ds_read_b128 v[96:99], v7 offset:28672
  s_waitcnt lgkmcnt(1)
  v_mfma_f32_16x16x32_bf16 v[56:59], v[124:127], v[92:95], v[56:59]
  ds_read_b128 v[100:103], v7 offset:29696
  v_mfma_f32_16x16x32_bf16 v[60:63], v[140:143], v[92:95], v[60:63]
  ds_read_b128 v[104:107], v7 offset:30720
  v_mfma_f32_16x16x32_bf16 v[64:67], v[92:95], v[92:95], v[64:67]
  ds_read_b128 v[108:111], v7 offset:31744
  buffer_store_dword v15, v0, s[48:51], s83 offen sc1
  v_smfmac_f32_16x16x64_bf16 v[76:79], v[32:35], v[184:191], v6
  v_smfmac_f32_16x16x64_bf16 v[72:75], v[36:39], v[192:199], v6
  v_smfmac_f32_16x16x64_bf16 v[76:79], v[36:39], v[200:207], v6
  v_max3_f32 v32, v56, v57, v58
  v_max3_f32 v33, v59, v60, v61
  v_max3_f32 v32, v32, v62, v63
  v_max3_f32 v33, v33, v64, v65
  v_max_f32 v32, v32, v33
  v_mov_b32 v33, v32
  v_smfmac_f32_16x16x64_bf16 v[72:75], v[40:43], v[208:215], v6
  s_nop 0
  v_permlane16_swap_b32 v32, v33
  v_max_f32 v32, v32, v33
  v_mov_b32 v33, v32
  v_smfmac_f32_16x16x64_bf16 v[76:79], v[40:43], v[216:223], v6
  s_nop 0
  v_permlane32_swap_b32 v32, v33
  v_max_f32 v32, v32, v33
  v_mul_f32 v32, s82, v32
  v_pk_fma_f32 v[56:57], v[56:57], s[90:91], v[32:33] op_sel_hi:[1,1,0] neg_lo:[0,0,1] neg_hi:[0,0,1]
  v_pk_fma_f32 v[58:59], v[58:59], s[90:91], v[32:33] op_sel_hi:[1,1,0] neg_lo:[0,0,1] neg_hi:[0,0,1]
  v_pk_fma_f32 v[60:61], v[60:61], s[90:91], v[32:33] op_sel_hi:[1,1,0] neg_lo:[0,0,1] neg_hi:[0,0,1]
  v_pk_fma_f32 v[62:63], v[62:63], s[90:91], v[32:33] op_sel_hi:[1,1,0] neg_lo:[0,0,1] neg_hi:[0,0,1]
  v_pk_fma_f32 v[64:65], v[64:65], s[90:91], v[32:33] op_sel_hi:[1,1,0] neg_lo:[0,0,1] neg_hi:[0,0,1]
  v_exp_f32 v56, v56
  s_waitcnt lgkmcnt(0)
  v_smfmac_f32_16x16x64_bf16 v[72:75], v[44:47], v[96:103], v6
  v_exp_f32 v57, v57
  v_smfmac_f32_16x16x64_bf16 v[76:79], v[44:47], v[104:111], v6
  v_exp_f32 v58, v58
  v_smfmac_f32_16x16x64_bf16 v[72:75], v[48:51], v[224:231], v6
  v_exp_f32 v59, v59
  v_smfmac_f32_16x16x64_bf16 v[76:79], v[48:51], v[232:239], v6
  v_exp_f32 v60, v60
  v_smfmac_f32_16x16x64_bf16 v[72:75], v[52:55], v[240:247], v6
  v_exp_f32 v61, v61
  v_smfmac_f32_16x16x64_bf16 v[76:79], v[52:55], v[248:255], v6
  v_exp_f32 v62, v62
  v_exp_f32 v63, v63
  v_exp_f32 v64, v64
  v_exp_f32 v65, v65
  v_cvt_pk_bf16_f32 v68, v56, v57
  v_cvt_pk_bf16_f32 v69, v58, v59
  v_cvt_pk_bf16_f32 v70, v60, v61
  v_cvt_pk_bf16_f32 v71, v62, v63
  v_cvt_pk_bf16_f32 v28, v64, v64
  v_cvt_pk_bf16_f32 v29, v65, v65
  v_mfma_f32_16x16x32_bf16 v[56:59], v[16:19], v[68:71], 0
  v_cvt_pk_bf16_f32 v24, v72, v73
  v_cvt_pk_bf16_f32 v25, v74, v75
  v_mfma_f32_16x16x32_bf16 v[56:59], v[20:23], v[28:31], v[56:59]
  v_cvt_pk_bf16_f32 v26, v76, v77
  v_cvt_pk_bf16_f32 v27, v78, v79
  v_mfma_f32_16x16x32_bf16 v[32:35], v[144:147], v[68:71], 0
  s_nop 0
  v_mfma_f32_16x16x32_bf16 v[32:35], v[24:27], v[28:31], v[32:35]
  v_mfma_f32_16x16x32_bf16 v[36:39], v[148:151], v[68:71], 0
  v_mfma_f32_16x16x32_bf16 v[36:39], v[26:29], v[28:31], v[36:39]
  s_mov_b64 exec, s[84:85]
  v_rcp_f32 v56, v56
  s_nop 3
  v_pk_mul_f32 v[32:33], v[32:33], v[56:57] op_sel_hi:[1,0]
  v_cvt_pk_bf16_f32 v60, v32, v33
  v_pk_mul_f32 v[34:35], v[34:35], v[56:57] op_sel_hi:[1,0]
  v_cvt_pk_bf16_f32 v61, v34, v35
  v_pk_mul_f32 v[36:37], v[36:37], v[56:57] op_sel_hi:[1,0]
  v_cvt_pk_bf16_f32 v62, v36, v37
  v_pk_mul_f32 v[38:39], v[38:39], v[56:57] op_sel_hi:[1,0]
  v_cvt_pk_bf16_f32 v63, v38, v39
  buffer_store_dwordx4 v[60:63], v5, s[48:51], s64 offen sc1
  s_mov_b64 exec, -1
  s_mov_b32 s89, 0
L_t1idle:
  s_add_u32 s61, s76, 4096
  s_cmp_eq_u32 s60, 0
  s_cbranch_scc1 L_t1q0
L_t1q1:
  ds_read_b128 v[32:35], v12 offset:16384
  ds_read_b128 v[36:39], v12 offset:17408
  ds_read_b128 v[40:43], v12 offset:18432
  ds_read_b128 v[44:47], v12 offset:19456
  ds_read_b128 v[48:51], v12 offset:20480
  ds_read_b128 v[52:55], v12 offset:21504
  ds_read_b128 v[96:99], v12 offset:22528
  ds_read_b128 v[100:103], v12 offset:23552
  ds_read_b128 v[104:107], v12 offset:28672
  v_mov_b32 v76, -1
  v_mov_b32 v77, -1
  v_mov_b32 v78, -1
  v_mov_b32 v79, -1
  v_mov_b32 v15, s92
  s_mov_b32 s92, s60
  s_xor_b32 s64, s64, 1048576
  s_xor_b32 s83, s83, 1048576
  s_mov_b64 exec, s[84:85]
  buffer_store_dwordx4 v[76:79], v5, s[48:51], s64 offen sc1
  s_mov_b64 exec, -1
  s_waitcnt lgkmcnt(0)
  s_barrier
  v_mfma_f32_16x16x32_bf16 v[56:59], v[80:83], v[32:35], 0
  buffer_load_dword v1, v14, s[32:35], s77 offen sc1
  v_mfma_f32_16x16x32_bf16 v[60:63], v[112:115], v[32:35], v[104:107]
  v_mfma_f32_16x16x32_bf16 v[64:67], v[80:83], v[48:51], 0
  v_mfma_f32_16x16x32_bf16 v[68:71], v[112:115], v[48:51], 0
  v_mfma_f32_16x16x32_bf16 v[72:75], v[128:131], v[48:51], v[104:107]
  s_mov_b32 m0, s79
  s_add_u32 s67, s78, 8192
  buffer_load_dwordx4 v11, s[32:35], s67 offen sc1 lds
  v_mfma_f32_16x16x32_bf16 v[56:59], v[84:87], v[36:39], v[56:59]
  v_mfma_f32_16x16x32_bf16 v[60:63], v[116:119], v[36:39], v[60:63]
  v_mfma_f32_16x16x32_bf16 v[64:67], v[84:87], v[52:55], v[64:67]
  v_mfma_f32_16x16x32_bf16 v[68:71], v[116:119], v[52:55], v[68:71]
  buffer_load_dwordx4 v11, s[32:35], s67 offen offset:1024 sc1 lds
  v_mfma_f32_16x16x32_bf16 v[72:75], v[132:135], v[52:55], v[72:75]
  v_mfma_f32_16x16x32_bf16 v[56:59], v[88:91], v[40:43], v[56:59]
  v_mfma_f32_16x16x32_bf16 v[60:63], v[120:123], v[40:43], v[60:63]
  v_mfma_f32_16x16x32_bf16 v[64:67], v[88:91], v[96:99], v[64:67]
  s_add_u32 m0, s79, 8192
  s_add_u32 s67, s78, 16384
  buffer_load_dwordx4 v11, s[32:35], s67 offen sc1 lds
  v_mfma_f32_16x16x32_bf16 v[68:71], v[120:123], v[96:99], v[68:71]
  v_mfma_f32_16x16x32_bf16 v[72:75], v[136:139], v[96:99], v[72:75]
  v_mfma_f32_16x16x32_bf16 v[56:59], v[92:95], v[44:47], v[56:59]
  v_mfma_f32_16x16x32_bf16 v[60:63], v[124:127], v[44:47], v[60:63]
  buffer_load_dwordx4 v11, s[32:35], s67 offen offset:1024 sc1 lds
  v_mfma_f32_16x16x32_bf16 v[64:67], v[92:95], v[100:103], v[64:67]
  v_mfma_f32_16x16x32_bf16 v[68:71], v[124:127], v[100:103], v[68:71]
  v_mfma_f32_16x16x32_bf16 v[72:75], v[140:143], v[100:103], v[72:75]
  s_cmp_lg_u32 s66, 1
  s_cbranch_scc1 L_t1nsw
  v_mov_b32 v31, 128
  s_mov_b32 s71, 524288
  s_mov_b64 exec, 1
  s_mov_b32 s70, 0
SP_18:
  buffer_load_dword v30, v31, s[52:55], 0 offen sc1
  s_waitcnt vmcnt(0)
  v_cmp_gt_u32 vcc, s71, v30
  s_cbranch_vccz SD_19
  s_sleep 2
  s_add_u32 s70, s70, 1
  s_cmp_lt_u32 s70, 700934
  s_cbranch_scc1 SP_18
  s_endpgm
SD_19:
  s_mov_b64 exec, -1
  v_readfirstlane_b32 s62, v30
  s_nop 0
  s_and_b32 s62, s62, 0xffff
  s_cmp_gt_u32 s62, 2
  s_cselect_b32 s62, 8192, 0
L_t1nsw:
  s_and_b32 s86, s66, 7
  s_lshl_b32 s86, s86, 18
  s_add_u32 s86, s86, s62
  s_add_u32 s86, s86, 212992
  v_max3_f32 v76, v56, v57, v60
  v_max3_f32 v78, v64, v65, v68
  v_max3_f32 v76, v76, v61, v62
  v_max3_f32 v78, v78, v69, v70
  v_max_f32 v76, v76, v63
  v_max3_f32 v78, v78, v71, v72
  s_add_u32 m0, s79, 16384
  s_nop 0
  buffer_load_dwordx4 v11, s[32:35], s78 offen sc1 lds
  v_mov_b32 v77, v76
  v_max3_f32 v78, v78, v73, v74
  v_mov_b32 v34, 0
  v_max_f32 v78, v78, v75
  v_permlane16_swap_b32 v76, v77
  v_mov_b32 v79, v78
  v_max_f32 v76, v76, v77
  v_mov_b32 v38, 0
  v_mov_b32 v77, v76
  v_permlane16_swap_b32 v78, v79
  v_mov_b32 v35, 0
  v_max_f32 v78, v78, v79
  buffer_load_dwordx4 v11, s[32:35], s78 offen offset:1024 sc1 lds
  s_add_u32 s78, s78, 786432
  v_permlane32_swap_b32 v76, v77
  v_mov_b32 v79, v78
  v_max_f32 v76, v76, v77
  v_mov_b32 v39, 0
  v_mul_f32 v76, s82, v76
  v_permlane32_swap_b32 v78, v79
  v_fma_f32 v56, v56, s82, -v76
  v_max_f32 v78, v78, v79
  v_fma_f32 v57, v57, s82, -v76
  v_mul_f32 v78, s82, v78
  v_fma_f32 v60, v60, s82, -v76
  v_fma_f32 v64, v64, s82, -v78
  buffer_store_dwordx4 v[152:155], v11, s[32:35], s76 offen sc1
  v_fma_f32 v61, v61, s82, -v76
  v_fma_f32 v65, v65, s82, -v78
  v_fma_f32 v62, v62, s82, -v76
  v_fma_f32 v68, v68, s82, -v78
  v_fma_f32 v63, v63, s82, -v76
  v_fma_f32 v69, v69, s82, -v78
  v_exp_f32 v56, v56
  v_fma_f32 v70, v70, s82, -v78
  v_exp_f32 v57, v57
  v_fma_f32 v71, v71, s82, -v78
  v_exp_f32 v60, v60
  v_fma_f32 v72, v72, s82, -v78
  buffer_store_dwordx4 v[156:159], v11, s[32:35], s61 offen sc1
  v_exp_f32 v61, v61
  v_fma_f32 v73, v73, s82, -v78
  v_exp_f32 v62, v62
  v_fma_f32 v74, v74, s82, -v78
  v_exp_f32 v63, v63
  v_fma_f32 v75, v75, s82, -v78
  v_cvt_pk_bf16_f32 v32, v56, v56
  v_exp_f32 v64, v64
  v_cvt_pk_bf16_f32 v33, v57, v57
  v_exp_f32 v65, v65
  v_cvt_pk_bf16_f32 v112, v60, v61
  v_exp_f32 v68, v68
  buffer_store_dword v15, v10, s[32:35], s73 offen sc1
  v_cvt_pk_bf16_f32 v113, v62, v63
  v_exp_f32 v69, v69
  v_mov_b32 v114, 0
  v_exp_f32 v70, v70
  v_mov_b32 v115, 0
  v_exp_f32 v71, v71
  s_nop 0
  v_mfma_f32_16x16x32_bf16 v[104:107], v[16:19], v[112:115], 0
  v_exp_f32 v72, v72
  v_mov_b32 v56, 0
  v_exp_f32 v73, v73
  v_mov_b32 v57, 0
  v_exp_f32 v74, v74
  buffer_store_dword v10, v0, s[48:51], s83 offen sc1
  v_mfma_f32_16x16x32_bf16 v[104:107], v[20:23], v[32:35], v[104:107]
  v_exp_f32 v75, v75
  v_mov_b32 v58, 0
  v_cvt_pk_bf16_f32 v36, v64, v64
  v_mov_b32 v59, 0
  v_cvt_pk_bf16_f32 v37, v65, v65
  v_mfma_f32_16x16x32_bf16 v[120:123], v[144:147], v[112:115], 0
  v_cvt_pk_bf16_f32 v116, v68, v69
  v_mov_b32 v60, 0
  v_cvt_pk_bf16_f32 v117, v70, v71
  v_mov_b32 v61, 0
  v_cvt_pk_bf16_f32 v118, v72, v73
  v_mfma_f32_16x16x32_bf16 v[124:127], v[148:151], v[112:115], 0
  v_cvt_pk_bf16_f32 v119, v74, v75
  v_mov_b32 v62, 0
  s_nop 0
  v_mfma_f32_16x16x32_bf16 v[108:111], v[16:19], v[116:119], 0
  v_mov_b32 v63, 0
  v_mov_b32 v64, 0
  v_mfma_f32_16x16x32_bf16 v[120:123], v[24:27], v[32:35], v[120:123]
  v_mov_b32 v65, 0
  v_mfma_f32_16x16x32_bf16 v[124:127], v[26:29], v[32:35], v[124:127]
  v_mfma_f32_16x16x32_bf16 v[108:111], v[20:23], v[36:39], v[108:111]
  v_rcp_f32 v104, v104
  v_mov_b32 v66, 0
  s_nop 2
  v_mul_f32 v120, v104, v120
  v_mov_b32 v67, 0
  v_mul_f32 v121, v104, v121
  v_mfma_f32_16x16x32_bf16 v[96:99], v[144:147], v[116:119], 0
  v_mul_f32 v122, v104, v122
  v_mov_b32 v68, 0
  v_mul_f32 v123, v104, v123
  v_mov_b32 v69, 0
  v_mul_f32 v124, v104, v124
  v_mfma_f32_16x16x32_bf16 v[100:103], v[148:151], v[116:119], 0
  v_mul_f32 v125, v104, v125
  v_mov_b32 v70, 0
  v_mul_f32 v126, v104, v126
  v_mov_b32 v71, 0
  v_mul_f32 v127, v104, v127
  v_mfma_f32_16x16x32_bf16 v[96:99], v[24:27], v[36:39], v[96:99]
  v_mov_b32 v72, 0
  v_mov_b32 v73, 0
  v_mfma_f32_16x16x32_bf16 v[100:103], v[26:29], v[36:39], v[100:103]
  v_mov_b32 v74, 0
  v_mov_b32 v75, 0
  v_mov_b32 v76, 0
  v_mov_b32 v77, 0
  v_mov_b32 v78, 0
  v_mov_b32 v79, 0
  v_rcp_f32 v108, v108
  s_nop 0
  v_mul_f32 v96, v108, v96
  v_mul_f32 v97, v108, v97
  v_mul_f32 v98, v108, v98
  v_mul_f32 v99, v108, v99
  v_mul_f32 v100, v108, v100
  v_mul_f32 v101, v108, v101
  v_mul_f32 v102, v108, v102
  v_mul_f32 v103, v108, v103
  v_cvt_pk_bf16_f32 v152, v120, v121
  v_cvt_pk_bf16_f32 v153, v122, v123
  v_cvt_pk_bf16_f32 v154, v124, v125
  v_cvt_pk_bf16_f32 v155, v126, v127
  v_cvt_pk_bf16_f32 v156, v96, v97
  v_cvt_pk_bf16_f32 v157, v98, v99
  v_cvt_pk_bf16_f32 v158, v100, v101
  v_cvt_pk_bf16_f32 v159, v102, v103
  ds_read_b128 v[80:83], v7 offset:0
  ds_read_b128 v[84:87], v7 offset:1024
  ds_read_b128 v[88:91], v7 offset:2048
  ds_read_b128 v[92:95], v7 offset:3072
  ds_read_b128 v[96:99], v7 offset:4096
  ds_read_b128 v[100:103], v7 offset:5120
  ds_read_b128 v[104:107], v7 offset:6144
  ds_read_b128 v[108:111], v7 offset:7168
  s_add_u32 s71, s60, 6
  s_lshr_b32 s71, s71, 2
  s_min_u32 s71, s71, 16
  s_waitcnt vmcnt(10)
  v_cmp_gt_u32 vcc, s71, v1
  s_cbranch_vccz L_t1pf
  s_mov_b64 exec, 7
  s_mov_b32 s70, 0
SP_20:
  buffer_load_dword v1, v14, s[32:35], s77 offen sc1
  s_waitcnt vmcnt(0)
  v_cmp_gt_u32 vcc, s71, v1
  s_cbranch_vccz SD_21
  s_sleep 1
  s_add_u32 s70, s70, 1
  s_cmp_lt_u32 s70, 824175
  s_cbranch_scc1 SP_20
  s_endpgm
SD_21:
  s_mov_b64 exec, -1
L_t1pf:
  s_mov_b32 s76, s81
  s_cmp_lt_u32 s60, 63
  s_cbranch_scc1 L_t1keep
  s_add_u32 s61, s76, 4096
  buffer_store_dwordx4 v[152:155], v11, s[32:35], s76 offen sc1
  buffer_store_dwordx4 v[156:159], v11, s[32:35], s61 offen sc1
  s_mov_b32 s76, 0x7ff00000
  s_mov_b32 s92, s66
  v_mov_b32 v15, s66
  s_waitcnt vmcnt(0)
  buffer_store_dword v15, v10, s[32:35], s73 offen sc1
L_t1keep:
  s_add_u32 s81, s81, 262144

  s_add_u32 s60, s60, 1
  s_cmp_lt_u32 s60, 64
  s_cbranch_scc1 L_t1loop

  s_endpgm
L_t1ef:
  v_mov_b32 v1, s92
  buffer_store_dword v1, v10, s[32:35], s73 offen sc1
  s_branch L_t1ef1
L_t1q0:
  s_cmp_eq_u32 s93, 1
  s_cbranch_scc1 L_t1q2
  s_mov_b64 exec, 7
  s_mov_b32 s70, 0
SP_22:
  buffer_load_dword v1, v14, s[32:35], s77 offen sc1
  s_waitcnt vmcnt(0)
  v_cmp_gt_u32 vcc, 1, v1
  s_cbranch_vccz SD_23
  s_sleep 1
  s_add_u32 s70, s70, 1
  s_cmp_lt_u32 s70, 824175
  s_cbranch_scc1 SP_22
  s_endpgm
SD_23:
  s_mov_b64 exec, -1
  s_add_u32 m0, s79, 16384
  s_nop 0
  buffer_load_dwordx4 v11, s[32:35], s78 offen sc1 lds
  buffer_load_dwordx4 v11, s[32:35], s78 offen offset:1024 sc1 lds
  s_add_u32 s78, s78, 786432
L_t1q2:
  s_waitcnt vmcnt(0)
  s_barrier
  s_branch L_t1q1
L_t1last:
  v_smfmac_f32_16x16x64_bf16 v[76:79], v[20:23], v[88:95], v6
  s_waitcnt lgkmcnt(0)
  s_barrier
  ds_read_b64_tr_b16 v[80:81], v9 offset:0
  ds_read_b64_tr_b16 v[82:83], v9 offset:512
  ds_read_b64_tr_b16 v[84:85], v9 offset:1024
  ds_read_b64_tr_b16 v[86:87], v9 offset:1536
  ds_read_b64_tr_b16 v[88:89], v9 offset:2048
  ds_read_b64_tr_b16 v[90:91], v9 offset:2560
  ds_read_b64_tr_b16 v[92:93], v9 offset:3072
  ds_read_b64_tr_b16 v[94:95], v9 offset:3584
  ds_read_b128 v[96:99], v7 offset:28672
  ds_read_b128 v[100:103], v7 offset:29696
  ds_read_b128 v[104:107], v7 offset:30720
  ds_read_b128 v[108:111], v7 offset:31744
  v_mov_b32 v16, s74
  v_mov_b32 v17, s74
  v_mov_b32 v18, s74
  v_mov_b32 v19, s74
  v_mov_b32 v20, s75
  v_mov_b32 v21, s75
  s_waitcnt lgkmcnt(0)
  v_smfmac_f32_16x16x64_bf16 v[72:75], v[24:27], a[240:247], v6
  v_smfmac_f32_16x16x64_bf16 v[76:79], v[24:27], a[248:255], v6
  v_smfmac_f32_16x16x64_bf16 v[72:75], v[28:31], v[160:167], v6
  v_smfmac_f32_16x16x64_bf16 v[76:79], v[28:31], v[168:175], v6
  v_smfmac_f32_16x16x64_bf16 v[72:75], v[32:35], v[176:183], v6
  v_smfmac_f32_16x16x64_bf16 v[76:79], v[32:35], v[184:191], v6
  v_smfmac_f32_16x16x64_bf16 v[72:75], v[36:39], v[192:199], v6
  v_smfmac_f32_16x16x64_bf16 v[76:79], v[36:39], v[200:207], v6
  v_smfmac_f32_16x16x64_bf16 v[72:75], v[40:43], v[208:215], v6
  v_smfmac_f32_16x16x64_bf16 v[76:79], v[40:43], v[216:223], v6
  v_smfmac_f32_16x16x64_bf16 v[72:75], v[44:47], v[96:103], v6
  v_smfmac_f32_16x16x64_bf16 v[76:79], v[44:47], v[104:111], v6
  v_smfmac_f32_16x16x64_bf16 v[72:75], v[48:51], v[224:231], v6
  v_smfmac_f32_16x16x64_bf16 v[76:79], v[48:51], v[232:239], v6
  v_smfmac_f32_16x16x64_bf16 v[72:75], v[52:55], v[240:247], v6
  v_smfmac_f32_16x16x64_bf16 v[76:79], v[52:55], v[248:255], v6
  s_nop 6
  v_cvt_pk_bf16_f32 v24, v72, v73
  v_cvt_pk_bf16_f32 v25, v74, v75
  v_cvt_pk_bf16_f32 v26, v76, v77
  v_cvt_pk_bf16_f32 v27, v78, v79
  v_mov_b32 v28, 0
  v_mov_b32 v29, 0
  s_branch L_t1idle
L_t1retry:
  s_cmp_eq_u32 s89, 2
  s_cbranch_scc1 L_t1go
  s_add_u32 s89, s89, 1
  s_cmp_eq_u32 s89, 2
  s_cbranch_scc1 L_t1slow
  s_nop 7
  ds_read_b128 v[80:83], v7 offset:0
  ds_read_b128 v[84:87], v7 offset:1024
  ds_read_b128 v[88:91], v7 offset:2048
  ds_read_b128 v[92:95], v7 offset:3072
  ds_read_b128 v[96:99], v7 offset:4096
  ds_read_b128 v[100:103], v7 offset:5120
  ds_read_b128 v[104:107], v7 offset:6144
  ds_read_b128 v[108:111], v7 offset:7168
  v_mov_b32 v56, 0
  v_mov_b32 v57, 0
  v_mov_b32 v58, 0
  v_mov_b32 v59, 0
  v_mov_b32 v60, 0
  v_mov_b32 v61, 0
  v_mov_b32 v62, 0
  v_mov_b32 v63, 0
  v_mov_b32 v64, 0
  v_mov_b32 v65, 0
  v_mov_b32 v66, 0
  v_mov_b32 v67, 0
  v_mov_b32 v68, 0
  v_mov_b32 v69, 0
  v_mov_b32 v70, 0
  v_mov_b32 v71, 0
  v_mov_b32 v72, 0
  v_mov_b32 v73, 0
  v_mov_b32 v74, 0
  v_mov_b32 v75, 0
  v_mov_b32 v76, 0
  v_mov_b32 v77, 0
  v_mov_b32 v78, 0
  v_mov_b32 v79, 0
  s_branch L_t1again
L_t1slow:
  s_mov_b32 s70, 0
L_t1r1:
  buffer_load_dwordx4 v[16:19], v2, s[48:51], s65 offen offset:0 sc1
  buffer_load_dwordx4 v[20:23], v2, s[48:51], s65 offen offset:1024 sc1
  buffer_load_dwordx4 v[24:27], v2, s[48:51], s65 offen offset:2048 sc1
  buffer_load_dwordx4 v[28:31], v2, s[48:51], s65 offen offset:3072 sc1
  buffer_load_dwordx4 v[32:35], v3, s[48:51], s65 offen offset:0 sc1
  buffer_load_dwordx4 v[36:39], v3, s[48:51], s65 offen offset:1024 sc1
  buffer_load_dwordx4 v[40:43], v3, s[48:51], s65 offen offset:2048 sc1
  buffer_load_dwordx4 v[44:47], v3, s[48:51], s65 offen offset:3072 sc1
  buffer_load_dwordx4 v[48:51], v4, s[48:51], s65 offen offset:0 sc1
  buffer_load_dwordx4 v[52:55], v4, s[48:51], s65 offen offset:1024 sc1
  v_mov_b32 v56, 0
  s_waitcnt vmcnt(0)
  v_max3_u32 v56, v56, v16, v17
  v_max3_u32 v56, v56, v18, v19
  v_max3_u32 v56, v56, v20, v21
  v_max3_u32 v56, v56, v22, v23
  v_max3_u32 v56, v56, v24, v25
  v_max3_u32 v56, v56, v26, v27
  v_max3_u32 v56, v56, v28, v29
  v_max3_u32 v56, v56, v30, v31
  v_max3_u32 v56, v56, v32, v33
  v_max3_u32 v56, v56, v34, v35
  v_max3_u32 v56, v56, v36, v37
  v_max3_u32 v56, v56, v38, v39
  v_max3_u32 v56, v56, v40, v41
  v_max3_u32 v56, v56, v42, v43
  v_max3_u32 v56, v56, v44, v45
  v_max3_u32 v56, v56, v46, v47
  v_max3_u32 v56, v56, v48, v49
  v_max3_u32 v56, v56, v50, v51
  v_max3_u32 v56, v56, v52, v53
  v_max3_u32 v56, v56, v54, v55
  v_cmp_eq_u32 vcc, -1, v56
  s_cbranch_vccz L_t1r2
  s_add_u32 s70, s70, 1
  s_cmp_lt_u32 s70, 524288
  s_cbranch_scc1 L_t1r1
  s_endpgm
L_t1r2:
  ds_read_b128 v[80:83], v7 offset:0
  ds_read_b128 v[84:87], v7 offset:1024
  ds_read_b128 v[88:91], v7 offset:2048
  ds_read_b128 v[92:95], v7 offset:3072
  ds_read_b128 v[96:99], v7 offset:4096
  ds_read_b128 v[100:103], v7 offset:5120
  ds_read_b128 v[104:107], v7 offset:6144
  ds_read_b128 v[108:111], v7 offset:7168
  v_mov_b32 v56, 0
  v_mov_b32 v57, 0
  v_mov_b32 v58, 0
  v_mov_b32 v59, 0
  v_mov_b32 v60, 0
  v_mov_b32 v61, 0
  v_mov_b32 v62, 0
  v_mov_b32 v63, 0
  v_mov_b32 v64, 0
  v_mov_b32 v65, 0
  v_mov_b32 v66, 0
  v_mov_b32 v67, 0
  v_mov_b32 v68, 0
  v_mov_b32 v69, 0
  v_mov_b32 v70, 0
  v_mov_b32 v71, 0
  v_mov_b32 v72, 0
  v_mov_b32 v73, 0
  v_mov_b32 v74, 0
  v_mov_b32 v75, 0
  v_mov_b32 v76, 0
  v_mov_b32 v77, 0
  v_mov_b32 v78, 0
  v_mov_b32 v79, 0
  s_waitcnt lgkmcnt(4)
  v_smfmac_f32_16x16x64_bf16 v[56:59], v[16:19], v[80:87], v6
  ds_read_b128 v[80:83], v7 offset:8192
  v_smfmac_f32_16x16x64_bf16 v[60:63], v[16:19], v[88:95], v6
  ds_read_b128 v[84:87], v7 offset:9216
  v_smfmac_f32_16x16x64_bf16 v[64:67], v[16:19], a[112:119], v6
  ds_read_b128 v[88:91], v7 offset:10240
  v_smfmac_f32_16x16x64_bf16 v[68:71], v[16:19], a[120:127], v6
  ds_read_b128 v[92:95], v7 offset:11264
  s_waitcnt lgkmcnt(4)
  v_smfmac_f32_16x16x64_bf16 v[64:67], v[20:23], v[96:103], v6
  ds_read_b128 v[96:99], v7 offset:12288
  v_smfmac_f32_16x16x64_bf16 v[68:71], v[20:23], v[104:111], v6
  ds_read_b128 v[100:103], v7 offset:13312
  v_smfmac_f32_16x16x64_bf16 v[56:59], v[20:23], a[0:7], v6
  ds_read_b128 v[104:107], v7 offset:14336
  v_smfmac_f32_16x16x64_bf16 v[60:63], v[20:23], a[8:15], v6
  ds_read_b128 v[108:111], v7 offset:15360
  v_smfmac_f32_16x16x64_bf16 v[56:59], v[24:27], a[16:23], v6
  v_smfmac_f32_16x16x64_bf16 v[60:63], v[24:27], a[24:31], v6
  v_smfmac_f32_16x16x64_bf16 v[64:67], v[24:27], a[128:135], v6
  v_smfmac_f32_16x16x64_bf16 v[68:71], v[24:27], a[136:143], v6
  s_waitcnt lgkmcnt(4)
  v_smfmac_f32_16x16x64_bf16 v[56:59], v[28:31], v[80:87], v6
  ds_read_b128 v[80:83], v7 offset:16384
  v_smfmac_f32_16x16x64_bf16 v[60:63], v[28:31], v[88:95], v6
  ds_read_b128 v[84:87], v7 offset:17408
  v_smfmac_f32_16x16x64_bf16 v[64:67], v[28:31], a[144:151], v6
  ds_read_b128 v[88:91], v7 offset:18432
  v_smfmac_f32_16x16x64_bf16 v[68:71], v[28:31], a[152:159], v6
  ds_read_b128 v[92:95], v7 offset:19456
  s_waitcnt lgkmcnt(4)
  v_smfmac_f32_16x16x64_bf16 v[64:67], v[32:35], v[96:103], v6
  ds_read_b128 v[96:99], v7 offset:20480
  v_smfmac_f32_16x16x64_bf16 v[68:71], v[32:35], v[104:111], v6
  ds_read_b128 v[100:103], v7 offset:21504
  v_smfmac_f32_16x16x64_bf16 v[56:59], v[32:35], a[32:39], v6
  ds_read_b128 v[104:107], v7 offset:22528
  v_smfmac_f32_16x16x64_bf16 v[60:63], v[32:35], a[40:47], v6
  ds_read_b128 v[108:111], v7 offset:23552
  v_smfmac_f32_16x16x64_bf16 v[56:59], v[36:39], a[48:55], v6
  v_smfmac_f32_16x16x64_bf16 v[60:63], v[36:39], a[56:63], v6
  v_smfmac_f32_16x16x64_bf16 v[64:67], v[36:39], a[160:167], v6
  v_smfmac_f32_16x16x64_bf16 v[68:71], v[36:39], a[168:175], v6
  s_waitcnt lgkmcnt(4)
  v_smfmac_f32_16x16x64_bf16 v[56:59], v[40:43], v[80:87], v6
  ds_read_b128 v[80:83], v7 offset:24576
  v_smfmac_f32_16x16x64_bf16 v[60:63], v[40:43], v[88:95], v6
  ds_read_b128 v[84:87], v7 offset:25600
  v_smfmac_f32_16x16x64_bf16 v[64:67], v[40:43], a[176:183], v6
  ds_read_b128 v[88:91], v7 offset:26624
  v_smfmac_f32_16x16x64_bf16 v[68:71], v[40:43], a[184:191], v6
  ds_read_b128 v[92:95], v7 offset:27648
  v_smfmac_f32_16x16x64_bf16 v[56:59], v[44:47], a[64:71], v6
  v_smfmac_f32_16x16x64_bf16 v[60:63], v[44:47], a[72:79], v6
  v_smfmac_f32_16x16x64_bf16 v[64:67], v[44:47], a[192:199], v6
  v_smfmac_f32_16x16x64_bf16 v[68:71], v[44:47], a[200:207], v6
  v_smfmac_f32_16x16x64_bf16 v[56:59], v[48:51], a[80:87], v6
  v_smfmac_f32_16x16x64_bf16 v[60:63], v[48:51], a[88:95], v6
  v_smfmac_f32_16x16x64_bf16 v[64:67], v[48:51], a[208:215], v6
  v_smfmac_f32_16x16x64_bf16 v[68:71], v[48:51], a[216:223], v6
  v_smfmac_f32_16x16x64_bf16 v[56:59], v[52:55], a[96:103], v6
  v_smfmac_f32_16x16x64_bf16 v[60:63], v[52:55], a[104:111], v6
  v_smfmac_f32_16x16x64_bf16 v[64:67], v[52:55], a[224:231], v6
  v_smfmac_f32_16x16x64_bf16 v[68:71], v[52:55], a[232:239], v6
  s_waitcnt lgkmcnt(0)
  s_nop 7
  s_branch L_t1ok
L_team2:
  s_sub_u32 s60, s31, 32
  s_and_b32 s61, s60, 3
  s_lshr_b32 s60, s60, 2
  s_mul_i32 s63, s61, 10
  s_lshr_b32 s64, s60, 1
  s_add_u32 s63, s63, s64
  s_and_b32 s64, s60, 1
  s_lshl_b32 s67, s63, 1
  s_add_u32 s67, s67, s64
  s_lshl_b32 s67, s67, 7
  s_and_b32 s68, s67, 0x2000
  s_add_u32 s67, s67, s68
  s_add_u32 s67, s67, 131072
  s_sub_u32 s72, s31, 32
  s_cmp_lt_u32 s72, 4
  s_cselect_b32 s72, 0, 0x7ff00000
  s_cmp_eq_u32 s56, 0
  s_cselect_b32 s72, s72, 0x7ff00000
  s_add_u32 s72, s72, 212992

  v_min_u32 v12, 47, v1
  v_lshlrev_b32 v12, 9, v12
  v_lshrrev_b32 v7, 13, v12
  v_lshl_add_u32 v12, v7, 13, v12
  s_lshl_b32 s71, s61, 7
  v_add_u32 v12, s71, v12
  v_mov_b32 v7, s56
  v_lshlrev_b32 v7, 7, v7
  s_lshl_b32 s71, s61, 9
  v_add_u32 v7, s71, v7
  v_lshrrev_b32 v14, 4, v1
  v_lshlrev_b32 v14, 10, v14
  v_and_b32 v15, 15, v1
  v_lshl_add_u32 v14, v15, 4, v14
  s_lshl_b32 s68, s60, 5
  s_lshl_b32 s69, s56, 3
  s_add_u32 s68, s68, s69
  s_lshl_b32 s68, s68, 13
  s_lshl_b32 s69, s61, 8
  s_add_u32 s68, s68, s69
  s_mov_b32 s38, 5242880
  s_mov_b32 s36, s14
  s_mov_b32 s37, s15
  s_add_u32 s69, s68, 0
  buffer_load_dwordx4 v[32:35], v14, s[36:39], s69 offen
  s_add_u32 s69, s68, 4096
  buffer_load_dwordx4 v[36:39], v14, s[36:39], s69 offen
  s_add_u32 s69, s68, 8192
  buffer_load_dwordx4 v[40:43], v14, s[36:39], s69 offen
  s_add_u32 s69, s68, 12288
  buffer_load_dwordx4 v[44:47], v14, s[36:39], s69 offen
  s_add_u32 s69, s68, 16384
  buffer_load_dwordx4 v[48:51], v14, s[36:39], s69 offen
  s_add_u32 s69, s68, 20480
  buffer_load_dwordx4 v[52:55], v14, s[36:39], s69 offen
  s_add_u32 s69, s68, 24576
  buffer_load_dwordx4 v[56:59], v14, s[36:39], s69 offen
  s_add_u32 s69, s68, 28672
  buffer_load_dwordx4 v[60:63], v14, s[36:39], s69 offen
  s_add_u32 s69, s68, 32768
  buffer_load_dwordx4 v[64:67], v14, s[36:39], s69 offen
  s_add_u32 s69, s68, 36864
  buffer_load_dwordx4 v[68:71], v14, s[36:39], s69 offen
  s_add_u32 s69, s68, 40960
  buffer_load_dwordx4 v[72:75], v14, s[36:39], s69 offen
  s_add_u32 s69, s68, 45056
  buffer_load_dwordx4 v[76:79], v14, s[36:39], s69 offen
  s_add_u32 s69, s68, 49152
  buffer_load_dwordx4 v[80:83], v14, s[36:39], s69 offen
  s_add_u32 s69, s68, 53248
  buffer_load_dwordx4 v[84:87], v14, s[36:39], s69 offen
  s_add_u32 s69, s68, 57344
  buffer_load_dwordx4 v[88:91], v14, s[36:39], s69 offen
  s_add_u32 s69, s68, 61440
  buffer_load_dwordx4 v[92:95], v14, s[36:39], s69 offen
  s_mov_b32 s36, s16
  s_mov_b32 s37, s17
  s_add_u32 s69, s68, 0
  buffer_load_dwordx4 v[32:35], v14, s[36:39], s69 offen
  s_add_u32 s69, s68, 4096
  buffer_load_dwordx4 v[36:39], v14, s[36:39], s69 offen
  s_add_u32 s69, s68, 8192
  buffer_load_dwordx4 v[40:43], v14, s[36:39], s69 offen
  s_add_u32 s69, s68, 12288
  buffer_load_dwordx4 v[44:47], v14, s[36:39], s69 offen
  s_add_u32 s69, s68, 16384
  buffer_load_dwordx4 v[48:51], v14, s[36:39], s69 offen
  s_add_u32 s69, s68, 20480
  buffer_load_dwordx4 v[52:55], v14, s[36:39], s69 offen
  s_add_u32 s69, s68, 24576
  buffer_load_dwordx4 v[56:59], v14, s[36:39], s69 offen
  s_add_u32 s69, s68, 28672
  buffer_load_dwordx4 v[60:63], v14, s[36:39], s69 offen
  s_add_u32 s69, s68, 32768
  buffer_load_dwordx4 v[64:67], v14, s[36:39], s69 offen
  s_add_u32 s69, s68, 36864
  buffer_load_dwordx4 v[68:71], v14, s[36:39], s69 offen
  s_add_u32 s69, s68, 40960
  buffer_load_dwordx4 v[72:75], v14, s[36:39], s69 offen
  s_add_u32 s69, s68, 45056
  buffer_load_dwordx4 v[76:79], v14, s[36:39], s69 offen
  s_add_u32 s69, s68, 49152
  buffer_load_dwordx4 v[80:83], v14, s[36:39], s69 offen
  s_add_u32 s69, s68, 53248
  buffer_load_dwordx4 v[84:87], v14, s[36:39], s69 offen
  s_add_u32 s69, s68, 57344
  buffer_load_dwordx4 v[88:91], v14, s[36:39], s69 offen
  s_add_u32 s69, s68, 61440
  buffer_load_dwordx4 v[92:95], v14, s[36:39], s69 offen
  s_mov_b32 s36, s18
  s_mov_b32 s37, s19
  s_add_u32 s69, s68, 0
  buffer_load_dwordx4 v[32:35], v14, s[36:39], s69 offen
  s_add_u32 s69, s68, 4096
  buffer_load_dwordx4 v[36:39], v14, s[36:39], s69 offen
  s_add_u32 s69, s68, 8192
  buffer_load_dwordx4 v[40:43], v14, s[36:39], s69 offen
  s_add_u32 s69, s68, 12288
  buffer_load_dwordx4 v[44:47], v14, s[36:39], s69 offen
  s_add_u32 s69, s68, 16384
  buffer_load_dwordx4 v[48:51], v14, s[36:39], s69 offen
  s_add_u32 s69, s68, 20480
  buffer_load_dwordx4 v[52:55], v14, s[36:39], s69 offen
  s_add_u32 s69, s68, 24576
  buffer_load_dwordx4 v[56:59], v14, s[36:39], s69 offen
  s_add_u32 s69, s68, 28672
  buffer_load_dwordx4 v[60:63], v14, s[36:39], s69 offen
  s_add_u32 s69, s68, 32768
  buffer_load_dwordx4 v[64:67], v14, s[36:39], s69 offen
  s_add_u32 s69, s68, 36864
  buffer_load_dwordx4 v[68:71], v14, s[36:39], s69 offen
  s_add_u32 s69, s68, 40960
  buffer_load_dwordx4 v[72:75], v14, s[36:39], s69 offen
  s_add_u32 s69, s68, 45056
  buffer_load_dwordx4 v[76:79], v14, s[36:39], s69 offen
  s_add_u32 s69, s68, 49152
  buffer_load_dwordx4 v[80:83], v14, s[36:39], s69 offen
  s_add_u32 s69, s68, 53248
  buffer_load_dwordx4 v[84:87], v14, s[36:39], s69 offen
  s_add_u32 s69, s68, 57344
  buffer_load_dwordx4 v[88:91], v14, s[36:39], s69 offen
  s_add_u32 s69, s68, 61440
  buffer_load_dwordx4 v[92:95], v14, s[36:39], s69 offen
  v_lshrrev_b32 v22, 4, v1
  v_and_b32 v23, 15, v1
  v_lshrrev_b32 v26, 3, v23
  v_lshlrev_b32 v26, 1, v26
  v_lshrrev_b32 v27, 1, v22
  v_add_u32 v26, v26, v27
  v_lshlrev_b32 v26, 8, v26
  v_and_b32 v27, 1, v22
  v_lshlrev_b32 v27, 7, v27
  v_add_u32 v26, v26, v27
  v_and_b32 v27, 1, v23
  v_lshl_add_u32 v26, v27, 6, v26
  v_bfe_u32 v27, v23, 1, 2
  v_lshl_add_u32 v26, v27, 4, v26
  s_lshl_b32 s68, s64, 2
  s_add_u32 s68, s68, s56
  s_lshl_b32 s68, s68, 14
  v_add_u32 v2, s68, v26
  v_add_u32 v3, 4096, v2
  v_and_b32 v27, 1, v23
  v_cmp_eq_u32 vcc, 0, v27
  v_mov_b32 v27, 0xeeee
  v_mov_b32 v28, 0x4444
  v_cndmask_b32 v6, v27, v28, vcc
  v_lshlrev_b32 v4, 4, v1
  s_lshl_b32 s68, s56, 2
  v_add_u32 v5, s68, v4
  v_and_b32 v27, 1, v22
  v_lshlrev_b32 v27, 1, v27
  v_lshrrev_b32 v28, 1, v22
  v_add_u32 v27, v27, v28
  v_lshrrev_b32 v28, 3, v23
  v_lshl_add_u32 v27, v28, 2, v27
  v_lshlrev_b32 v27, 4, v27
  v_and_b32 v28, 7, v23
  v_lshl_add_u32 v8, v28, 1, v27
  v_mov_b32 v14, 0
  v_mov_b32 v16, -1
  v_mov_b32 v17, -1
  v_mov_b32 v18, -1
  v_mov_b32 v19, -1
  s_mov_b32 s74, 0
  s_mov_b32 s75, -1
  s_mov_b32 s76, 0x55555555
  s_mov_b32 s77, 0x55555555

  v_mov_b32 v21, 0
  s_movk_i32 s71, 16
  s_mov_b64 exec, 1
  s_mov_b32 s70, 0
SP_24:
  buffer_load_dword v20, v21, s[52:55], 0 offen sc1
  s_waitcnt vmcnt(0)
  v_cmp_gt_u32 vcc, s71, v20
  s_cbranch_vccz SD_25
  s_sleep 4
  s_add_u32 s70, s70, 1
  s_cmp_lt_u32 s70, 539568
  s_cbranch_scc1 SP_24
  s_endpgm
SD_25:
  s_mov_b64 exec, -1
  v_min_u32 v21, 7, v1
  v_lshlrev_b32 v21, 7, v21
  s_lshl_b32 s68, s56, 10
  s_add_u32 s68, s68, 88121344
  s_mov_b64 exec, 255
  s_mov_b32 s70, 0
SP_26:
  buffer_load_dword v20, v21, s[32:35], s68 offen sc1
  s_waitcnt vmcnt(0)
  v_cmp_gt_u32 vcc, 1, v20
  s_cbranch_vccz SD_27
  s_sleep 2
  s_add_u32 s70, s70, 1
  s_cmp_lt_u32 s70, 700934
  s_cbranch_scc1 SP_26
  s_endpgm
SD_27:
  s_mov_b64 exec, -1
  s_lshl_b32 s68, s63, 17
  s_lshl_b32 s69, s56, 15
  s_add_u32 s68, s68, s69
  s_add_u32 s68, s68, 92274688
  buffer_load_dwordx4 a[0:3], v4, s[32:35], s68 offen offset:0 sc1
  buffer_load_dwordx4 a[4:7], v4, s[32:35], s68 offen offset:1024 sc1
  buffer_load_dwordx4 a[8:11], v4, s[32:35], s68 offen offset:2048 sc1
  buffer_load_dwordx4 a[12:15], v4, s[32:35], s68 offen offset:3072 sc1
  s_add_u32 s68, s68, 4096
  buffer_load_dwordx4 a[16:19], v4, s[32:35], s68 offen offset:0 sc1
  buffer_load_dwordx4 a[20:23], v4, s[32:35], s68 offen offset:1024 sc1
  buffer_load_dwordx4 a[24:27], v4, s[32:35], s68 offen offset:2048 sc1
  buffer_load_dwordx4 a[28:31], v4, s[32:35], s68 offen offset:3072 sc1
  s_add_u32 s68, s68, 4096
  buffer_load_dwordx4 a[32:35], v4, s[32:35], s68 offen offset:0 sc1
  buffer_load_dwordx4 a[36:39], v4, s[32:35], s68 offen offset:1024 sc1
  buffer_load_dwordx4 a[40:43], v4, s[32:35], s68 offen offset:2048 sc1
  buffer_load_dwordx4 a[44:47], v4, s[32:35], s68 offen offset:3072 sc1
  s_add_u32 s68, s68, 4096
  buffer_load_dwordx4 a[48:51], v4, s[32:35], s68 offen offset:0 sc1
  buffer_load_dwordx4 a[52:55], v4, s[32:35], s68 offen offset:1024 sc1
  buffer_load_dwordx4 a[56:59], v4, s[32:35], s68 offen offset:2048 sc1
  buffer_load_dwordx4 a[60:63], v4, s[32:35], s68 offen offset:3072 sc1
  s_add_u32 s68, s68, 4096
  buffer_load_dwordx4 a[64:67], v4, s[32:35], s68 offen offset:0 sc1
  buffer_load_dwordx4 a[68:71], v4, s[32:35], s68 offen offset:1024 sc1
  buffer_load_dwordx4 a[72:75], v4, s[32:35], s68 offen offset:2048 sc1
  buffer_load_dwordx4 a[76:79], v4, s[32:35], s68 offen offset:3072 sc1
  s_add_u32 s68, s68, 4096
  buffer_load_dwordx4 a[80:83], v4, s[32:35], s68 offen offset:0 sc1
  buffer_load_dwordx4 a[84:87], v4, s[32:35], s68 offen offset:1024 sc1
  buffer_load_dwordx4 a[88:91], v4, s[32:35], s68 offen offset:2048 sc1
  buffer_load_dwordx4 a[92:95], v4, s[32:35], s68 offen offset:3072 sc1
  s_add_u32 s68, s68, 4096
  buffer_load_dwordx4 a[96:99], v4, s[32:35], s68 offen offset:0 sc1
  buffer_load_dwordx4 a[100:103], v4, s[32:35], s68 offen offset:1024 sc1
  buffer_load_dwordx4 a[104:107], v4, s[32:35], s68 offen offset:2048 sc1
  buffer_load_dwordx4 a[108:111], v4, s[32:35], s68 offen offset:3072 sc1
  s_add_u32 s68, s68, 4096
  buffer_load_dwordx4 a[112:115], v4, s[32:35], s68 offen offset:0 sc1
  buffer_load_dwordx4 a[116:119], v4, s[32:35], s68 offen offset:1024 sc1
  buffer_load_dwordx4 a[120:123], v4, s[32:35], s68 offen offset:2048 sc1
  buffer_load_dwordx4 a[124:127], v4, s[32:35], s68 offen offset:3072 sc1
  s_add_u32 s68, s68, 4096
  s_waitcnt vmcnt(0)
  s_sub_u32 s68, s31, 32
  s_lshr_b32 s68, s68, 2
  s_mul_i32 s68, s68, 3
  s_add_u32 s68, s68, s56
  s_sub_u32 s68, s68, 1
  s_lshl_b32 s68, s68, 2
  s_add_u32 s69, s68, 0
  s_mul_i32 s70, s69, 2731
  s_lshr_b32 s70, s70, 16
  s_mul_i32 s71, s70, 72
  s_add_u32 s71, s71, s69
  s_mul_i32 s70, s61, 24
  s_add_u32 s71, s71, s70
  s_lshl_b32 s71, s71, 10
  s_add_u32 s71, s71, 5767168
  s_cmp_lt_u32 s69, 192
  s_cselect_b32 s80, s71, 0x7ff00000
  s_add_u32 s69, s68, 1
  s_mul_i32 s70, s69, 2731
  s_lshr_b32 s70, s70, 16
  s_mul_i32 s71, s70, 72
  s_add_u32 s71, s71, s69
  s_mul_i32 s70, s61, 24
  s_add_u32 s71, s71, s70
  s_lshl_b32 s71, s71, 10
  s_add_u32 s71, s71, 5767168
  s_cmp_lt_u32 s69, 192
  s_cselect_b32 s81, s71, 0x7ff00000
  s_add_u32 s69, s68, 2
  s_mul_i32 s70, s69, 2731
  s_lshr_b32 s70, s70, 16
  s_mul_i32 s71, s70, 72
  s_add_u32 s71, s71, s69
  s_mul_i32 s70, s61, 24
  s_add_u32 s71, s71, s70
  s_lshl_b32 s71, s71, 10
  s_add_u32 s71, s71, 5767168
  s_cmp_lt_u32 s69, 192
  s_cselect_b32 s82, s71, 0x7ff00000
  s_add_u32 s69, s68, 3
  s_mul_i32 s70, s69, 2731
  s_lshr_b32 s70, s70, 16
  s_mul_i32 s71, s70, 72
  s_add_u32 s71, s71, s69
  s_mul_i32 s70, s61, 24
  s_add_u32 s71, s71, s70
  s_lshl_b32 s71, s71, 10
  s_add_u32 s71, s71, 5767168
  s_cmp_lt_u32 s69, 192
  s_cselect_b32 s83, s71, 0x7ff00000
  s_mov_b32 s62, 0
  s_mov_b32 s78, 0
  s_mov_b32 s60, 0
  s_barrier
L_t2loop:
  s_cmp_lg_u32 s60, 0
  s_cbranch_scc1 L_t2nsw
  v_mov_b32 v21, 128
  s_mov_b32 s71, 524288
  s_mov_b64 exec, 1
  s_mov_b32 s70, 0
SP_28:
  buffer_load_dword v20, v21, s[52:55], 0 offen sc1
  s_waitcnt vmcnt(0)
  v_cmp_gt_u32 vcc, s71, v20
  s_cbranch_vccz SD_29
  s_sleep 2
  s_add_u32 s70, s70, 1
  s_cmp_lt_u32 s70, 700934
  s_cbranch_scc1 SP_28
  s_endpgm
SD_29:
  s_mov_b64 exec, -1
  v_readfirstlane_b32 s62, v20
  s_nop 0
  s_and_b32 s62, s62, 0xffff
  s_cmp_gt_u32 s62, 2
  s_cselect_b32 s62, 8192, 0
  s_add_u32 s72, s72, s62
  s_add_u32 s67, s67, s62
L_t2nsw:
  s_cmp_eq_u32 s60, 1
  s_cselect_b32 s78, s62, s78

  s_and_b32 s63, s60, 7
  s_lshl_b32 s63, s63, 18
  s_add_u32 s63, s63, s78
  s_add_u32 s64, s60, 1
  s_and_b32 s65, s64, 7
  s_lshl_b32 s65, s65, 18
  s_add_u32 s79, s65, s72
  s_add_u32 s65, s65, s67
  s_add_u32 s73, s63, 163840
  s_add_u32 s66, s60, 2
  v_mov_b32 v13, s66
  v_mov_b32 v64, 0
  v_mov_b32 v65, 0
  v_mov_b32 v66, 0
  v_mov_b32 v67, 0
  v_mov_b32 v68, 0
  v_mov_b32 v69, 0
  v_mov_b32 v70, 0
  v_mov_b32 v71, 0
  s_mov_b32 s89, 0
  s_cmp_eq_u32 s60, 0
  s_cbranch_scc1 L_t2first
  s_sleep 17
  s_nop 2
  s_cmp_eq_u32 s56, 0
  s_cbranch_scc1 PO_32
  buffer_load_dwordx4 v[92:95], v4, s[32:35], s80 offen
  s_add_u32 s80, s80, 786432
  buffer_load_dwordx4 v[96:99], v4, s[32:35], s81 offen
  s_add_u32 s81, s81, 786432
  buffer_load_dwordx4 v[100:103], v4, s[32:35], s82 offen
  s_add_u32 s82, s82, 786432
  buffer_load_dwordx4 v[104:107], v4, s[32:35], s83 offen
  s_add_u32 s83, s83, 786432
PO_32:
  s_sleep 16
  s_nop 5
L_t2first:
  s_add_u32 s71, s73, 0
  buffer_load_dword v80, v7, s[48:51], s71 offen offset:0 sc1
  s_nop 15
  s_nop 8
  s_add_u32 s71, s73, 0
  buffer_load_dword v81, v7, s[48:51], s71 offen offset:2048 sc1
  s_nop 15
  s_nop 8
  s_add_u32 s71, s73, 4096
  buffer_load_dword v82, v7, s[48:51], s71 offen offset:0 sc1
  s_nop 15
  s_nop 8
  s_add_u32 s71, s73, 4096
  buffer_load_dword v83, v7, s[48:51], s71 offen offset:2048 sc1
  s_waitcnt vmcnt(3)
  v_cmp_gt_u32 vcc, s64, v80
  s_cbranch_vccz PD_31
  s_add_u32 s71, s73, 16384
  buffer_load_dword v84, v7, s[48:51], s71 offen offset:0 sc1
  s_waitcnt vmcnt(3)
  v_cmp_gt_u32 vcc, s64, v81
  s_cbranch_vccz PD_31
  s_add_u32 s71, s73, 16384
  buffer_load_dword v85, v7, s[48:51], s71 offen offset:2048 sc1
  s_waitcnt vmcnt(3)
  v_cmp_gt_u32 vcc, s64, v82
  s_cbranch_vccz PD_31
  s_add_u32 s71, s73, 20480
  buffer_load_dword v86, v7, s[48:51], s71 offen offset:0 sc1
  s_waitcnt vmcnt(3)
  v_cmp_gt_u32 vcc, s64, v83
  s_cbranch_vccz PD_31
  s_add_u32 s71, s73, 20480
  buffer_load_dword v87, v7, s[48:51], s71 offen offset:2048 sc1
  s_waitcnt vmcnt(3)
  v_cmp_gt_u32 vcc, s64, v84
  s_cbranch_vccz PD_31
  s_add_u32 s71, s73, 32768
  buffer_load_dword v88, v7, s[48:51], s71 offen offset:0 sc1
  s_waitcnt vmcnt(3)
  v_cmp_gt_u32 vcc, s64, v85
  s_cbranch_vccz PD_31
  s_add_u32 s71, s73, 32768
  buffer_load_dword v89, v7, s[48:51], s71 offen offset:2048 sc1
  s_waitcnt vmcnt(3)
  v_cmp_gt_u32 vcc, s64, v86
  s_cbranch_vccz PD_31
  s_add_u32 s71, s73, 36864
  buffer_load_dword v90, v7, s[48:51], s71 offen offset:0 sc1
  s_waitcnt vmcnt(3)
  v_cmp_gt_u32 vcc, s64, v87
  s_cbranch_vccz PD_31
  s_add_u32 s71, s73, 36864
  buffer_load_dword v91, v7, s[48:51], s71 offen offset:2048 sc1
  s_waitcnt vmcnt(3)
  v_cmp_gt_u32 vcc, s64, v88
  s_cbranch_vccz PD_31
  s_waitcnt vmcnt(2)
  v_cmp_gt_u32 vcc, s64, v89
  s_cbranch_vccz PD_31
  s_waitcnt vmcnt(1)
  v_cmp_gt_u32 vcc, s64, v90
  s_cbranch_vccz PD_31
  s_waitcnt vmcnt(0)
  v_cmp_gt_u32 vcc, s64, v91
  s_cbranch_vccz PD_31
  s_mov_b32 s70, 0
PF_30:
  s_add_u32 s71, s73, 36864
  buffer_load_dword v91, v7, s[48:51], s71 offen offset:2048 sc1
  s_waitcnt vmcnt(0)
  v_cmp_gt_u32 vcc, s64, v91
  s_cbranch_vccz PD_31
  s_add_u32 s70, s70, 1
  s_cmp_lt_u32 s70, 524288
  s_cbranch_scc1 PF_30
  s_endpgm
PD_31:
  s_barrier
  s_nop 15
  s_nop 3
  buffer_load_dwordx4 v[24:27], v2, s[48:51], s63 offen offset:0 sc1
  s_nop 5
  buffer_load_dwordx4 v[28:31], v2, s[48:51], s63 offen offset:1024 sc1
  s_nop 5
  buffer_load_dwordx4 v[32:35], v2, s[48:51], s63 offen offset:2048 sc1
  s_nop 5
  buffer_load_dwordx4 v[36:39], v2, s[48:51], s63 offen offset:3072 sc1
  s_nop 5
  buffer_load_dwordx4 v[40:43], v3, s[48:51], s63 offen offset:0 sc1
  s_nop 5
  buffer_load_dwordx4 v[44:47], v3, s[48:51], s63 offen offset:1024 sc1
  s_nop 5
  buffer_load_dwordx4 v[48:51], v3, s[48:51], s63 offen offset:2048 sc1
  s_nop 5
  buffer_load_dwordx4 v[52:55], v3, s[48:51], s63 offen offset:3072 sc1
  s_waitcnt vmcnt(7)
  v_smfmac_f32_16x16x64_bf16 v[64:67], v[24:27], a[0:7], v6
  v_smfmac_f32_16x16x64_bf16 v[68:71], v[24:27], a[8:15], v6
  s_waitcnt vmcnt(6)
  v_smfmac_f32_16x16x64_bf16 v[64:67], v[28:31], a[16:23], v6
  v_smfmac_f32_16x16x64_bf16 v[68:71], v[28:31], a[24:31], v6
  s_waitcnt vmcnt(5)
  v_smfmac_f32_16x16x64_bf16 v[64:67], v[32:35], a[32:39], v6
  v_smfmac_f32_16x16x64_bf16 v[68:71], v[32:35], a[40:47], v6
  s_waitcnt vmcnt(4)
  v_smfmac_f32_16x16x64_bf16 v[64:67], v[36:39], a[48:55], v6
  v_smfmac_f32_16x16x64_bf16 v[68:71], v[36:39], a[56:63], v6
  s_waitcnt vmcnt(3)
  v_smfmac_f32_16x16x64_bf16 v[64:67], v[40:43], a[64:71], v6
  v_smfmac_f32_16x16x64_bf16 v[68:71], v[40:43], a[72:79], v6
  buffer_store_dword v13, v12, s[48:51], s79 offen sc1
  s_waitcnt vmcnt(3)
  v_smfmac_f32_16x16x64_bf16 v[64:67], v[44:47], a[80:87], v6
  v_smfmac_f32_16x16x64_bf16 v[68:71], v[44:47], a[88:95], v6
  s_waitcnt vmcnt(2)
  v_smfmac_f32_16x16x64_bf16 v[64:67], v[48:51], a[96:103], v6
  v_smfmac_f32_16x16x64_bf16 v[68:71], v[48:51], a[104:111], v6
  s_waitcnt vmcnt(1)
  v_smfmac_f32_16x16x64_bf16 v[64:67], v[52:55], a[112:119], v6
  v_smfmac_f32_16x16x64_bf16 v[68:71], v[52:55], a[120:127], v6
L_t2ok:
  s_nop 6
  v_add_f32 v64, v64, v65
  v_add_f32 v66, v66, v67
  v_add_f32 v68, v68, v69
  v_add_f32 v70, v70, v71
  v_cndmask_b32 v64, v64, v68, s[74:75]
  v_cndmask_b32 v66, v66, v70, s[74:75]
  s_nop 1
  v_permlane32_swap_b32 v64, v66
  v_add_f32 v64, v64, v66
  ds_write_b32 v5, v64
  v_cmp_u_f32 vcc, v64, v64
  s_cbranch_vccnz L_t2retry
L_t2go:
  s_waitcnt lgkmcnt(0)
  s_barrier
  ds_read_b128 v[68:71], v4
  s_cmp_lg_u32 s56, 0
  s_cbranch_scc1 L_t2other
  s_waitcnt lgkmcnt(0)
  v_pk_add_f32 v[68:69], v[68:69], v[70:71]
  v_add_f32 v68, v68, v69
  s_nop 1
  v_mov_b32_dpp v69, v68 quad_perm:[1,0,3,2] row_mask:0xf bank_mask:0xf
  s_mov_b64 exec, s[76:77]
  v_cvt_pk_bf16_f32 v68, v68, v69
  buffer_store_dword v68, v8, s[48:51], s65 offen sc1
  s_mov_b64 exec, -1
  s_xor_b32 s79, s79, 1048576
  buffer_store_dword v14, v12, s[48:51], s79 offen sc1
  s_branch L_t2next
L_t2other:
  s_waitcnt lgkmcnt(0)
  s_cmp_lg_u32 s56, 1
  s_cbranch_scc1 L_t2next
  s_add_u32 s65, s60, 5
  s_and_b32 s65, s65, 7
  s_lshl_b32 s65, s65, 18
  s_add_u32 s65, s65, s67
  s_mov_b64 exec, 0xff
  buffer_store_dwordx4 v[16:19], v4, s[48:51], s65 offen sc1
  s_mov_b64 exec, -1
L_t2next:
  s_add_u32 s60, s60, 1
  s_cmp_lt_u32 s60, 63
  s_cbranch_scc1 L_t2loop
  s_endpgm
L_t2retry:
  s_cmp_eq_u32 s89, 1
  s_cbranch_scc1 L_t2go
  s_mov_b32 s89, 1
  s_mov_b32 s70, 0
L_t2r1:
  buffer_load_dwordx4 v[24:27], v2, s[48:51], s63 offen offset:0 sc1
  buffer_load_dwordx4 v[28:31], v2, s[48:51], s63 offen offset:1024 sc1
  buffer_load_dwordx4 v[32:35], v2, s[48:51], s63 offen offset:2048 sc1
  buffer_load_dwordx4 v[36:39], v2, s[48:51], s63 offen offset:3072 sc1
  buffer_load_dwordx4 v[40:43], v3, s[48:51], s63 offen offset:0 sc1
  buffer_load_dwordx4 v[44:47], v3, s[48:51], s63 offen offset:1024 sc1
  buffer_load_dwordx4 v[48:51], v3, s[48:51], s63 offen offset:2048 sc1
  buffer_load_dwordx4 v[52:55], v3, s[48:51], s63 offen offset:3072 sc1
  v_mov_b32 v9, 0
  s_waitcnt vmcnt(0)
  v_max3_u32 v9, v9, v24, v25
  v_max3_u32 v9, v9, v26, v27
  v_max3_u32 v9, v9, v28, v29
  v_max3_u32 v9, v9, v30, v31
  v_max3_u32 v9, v9, v32, v33
  v_max3_u32 v9, v9, v34, v35
  v_max3_u32 v9, v9, v36, v37
  v_max3_u32 v9, v9, v38, v39
  v_max3_u32 v9, v9, v40, v41
  v_max3_u32 v9, v9, v42, v43
  v_max3_u32 v9, v9, v44, v45
  v_max3_u32 v9, v9, v46, v47
  v_max3_u32 v9, v9, v48, v49
  v_max3_u32 v9, v9, v50, v51
  v_max3_u32 v9, v9, v52, v53
  v_max3_u32 v9, v9, v54, v55
  v_cmp_eq_u32 vcc, -1, v9
  s_cbranch_vccz L_t2r2
  s_add_u32 s70, s70, 1
  s_cmp_lt_u32 s70, 524288
  s_cbranch_scc1 L_t2r1
  s_endpgm
L_t2r2:
  v_mov_b32 v64, 0
  v_mov_b32 v65, 0
  v_mov_b32 v66, 0
  v_mov_b32 v67, 0
  v_mov_b32 v68, 0
  v_mov_b32 v69, 0
  v_mov_b32 v70, 0
  v_mov_b32 v71, 0
  v_smfmac_f32_16x16x64_bf16 v[64:67], v[24:27], a[0:7], v6
  s_nop 0
  v_smfmac_f32_16x16x64_bf16 v[68:71], v[24:27], a[8:15], v6
  v_smfmac_f32_16x16x64_bf16 v[64:67], v[28:31], a[16:23], v6
  v_smfmac_f32_16x16x64_bf16 v[68:71], v[28:31], a[24:31], v6
  v_smfmac_f32_16x16x64_bf16 v[64:67], v[32:35], a[32:39], v6
  v_smfmac_f32_16x16x64_bf16 v[68:71], v[32:35], a[40:47], v6
  v_smfmac_f32_16x16x64_bf16 v[64:67], v[36:39], a[48:55], v6
  v_smfmac_f32_16x16x64_bf16 v[68:71], v[36:39], a[56:63], v6
  v_smfmac_f32_16x16x64_bf16 v[64:67], v[40:43], a[64:71], v6
  v_smfmac_f32_16x16x64_bf16 v[68:71], v[40:43], a[72:79], v6
  v_smfmac_f32_16x16x64_bf16 v[64:67], v[44:47], a[80:87], v6
  v_smfmac_f32_16x16x64_bf16 v[68:71], v[44:47], a[88:95], v6
  v_smfmac_f32_16x16x64_bf16 v[64:67], v[48:51], a[96:103], v6
  v_smfmac_f32_16x16x64_bf16 v[68:71], v[48:51], a[104:111], v6
  v_smfmac_f32_16x16x64_bf16 v[64:67], v[52:55], a[112:119], v6
  v_smfmac_f32_16x16x64_bf16 v[68:71], v[52:55], a[120:127], v6
  s_nop 7
  s_branch L_t2ok
L_team3:
  v_lshlrev_b32 v4, 4, v1
  s_lshr_b32 s68, s57, 2
  s_lshl_b32 s68, s68, 2
  s_add_u32 s68, s68, s56
  s_mul_i32 s68, s68, 5120
  s_add_u32 s69, s68, 0
  buffer_load_dwordx4 v[160:163], v4, s[36:39], s69 offen
  s_add_u32 s69, s68, 1024
  buffer_load_dwordx4 v[164:167], v4, s[36:39], s69 offen
  s_add_u32 s69, s68, 2048
  buffer_load_dwordx4 v[168:171], v4, s[36:39], s69 offen
  s_add_u32 s69, s68, 3072
  buffer_load_dwordx4 v[172:175], v4, s[36:39], s69 offen
  s_add_u32 s69, s68, 4096
  buffer_load_dwordx4 v[176:179], v4, s[36:39], s69 offen
  s_cmp_ge_u32 s57, 32
  s_cbranch_scc1 L_nopack0
  s_mov_b32 s40, s20
  s_mov_b32 s41, s21
  s_mov_b32 s42, 5242880
  v_lshrrev_b32 v22, 4, v1
  v_and_b32 v23, 15, v1
  v_mul_u32_u24 v24, 1280, v22
  v_and_b32 v25, 1, v22
  v_or_b32 v25, 0, v25
  v_lshlrev_b32 v25, 1, v25
  v_xor_b32 v25, v25, v23
  v_lshl_add_u32 v8, v25, 4, v24
  v_and_b32 v25, 1, v22
  v_or_b32 v25, 2, v25
  v_lshlrev_b32 v25, 1, v25
  v_xor_b32 v25, v25, v23
  v_lshl_add_u32 v9, v25, 4, v24
  v_and_b32 v25, 1, v22
  v_or_b32 v25, 4, v25
  v_lshlrev_b32 v25, 1, v25
  v_xor_b32 v25, v25, v23
  v_lshl_add_u32 v10, v25, 4, v24
  v_and_b32 v25, 1, v22
  v_or_b32 v25, 6, v25
  v_lshlrev_b32 v25, 1, v25
  v_xor_b32 v25, v25, v23
  v_lshl_add_u32 v11, v25, 4, v24
  s_lshl_b32 s60, s57, 7
  s_lshl_b32 s61, s56, 5
  s_add_u32 s60, s60, s61
  s_mul_i32 s60, s60, 1280
  s_lshl_b32 s61, s56, 13
  s_mov_b32 s58, s60
  s_mov_b32 s59, s61
  s_add_u32 s63, s58, 0
  s_add_u32 m0, s59, 0
  s_nop 0
  buffer_load_dwordx4 v8, s[40:43], s63 offen  lds
  s_add_u32 s63, s58, 5120
  s_add_u32 m0, s59, 1024
  s_nop 0
  buffer_load_dwordx4 v9, s[40:43], s63 offen  lds
  s_add_u32 s63, s58, 10240
  s_add_u32 m0, s59, 2048
  s_nop 0
  buffer_load_dwordx4 v8, s[40:43], s63 offen  lds
  s_add_u32 s63, s58, 15360
  s_add_u32 m0, s59, 3072
  s_nop 0
  buffer_load_dwordx4 v9, s[40:43], s63 offen  lds
  s_add_u32 s63, s58, 20480
  s_add_u32 m0, s59, 4096
  s_nop 0
  buffer_load_dwordx4 v10, s[40:43], s63 offen  lds
  s_add_u32 s63, s58, 25600
  s_add_u32 m0, s59, 5120
  s_nop 0
  buffer_load_dwordx4 v11, s[40:43], s63 offen  lds
  s_add_u32 s63, s58, 30720
  s_add_u32 m0, s59, 6144
  s_nop 0
  buffer_load_dwordx4 v10, s[40:43], s63 offen  lds
  s_add_u32 s63, s58, 35840
  s_add_u32 m0, s59, 7168
  s_nop 0
  buffer_load_dwordx4 v11, s[40:43], s63 offen  lds
  s_add_u32 s63, s58, 256
  s_add_u32 m0, s59, 32768
  s_nop 0
  buffer_load_dwordx4 v8, s[40:43], s63 offen  lds
  s_add_u32 s63, s58, 5376
  s_add_u32 m0, s59, 33792
  s_nop 0
  buffer_load_dwordx4 v9, s[40:43], s63 offen  lds
  s_add_u32 s63, s58, 10496
  s_add_u32 m0, s59, 34816
  s_nop 0
  buffer_load_dwordx4 v8, s[40:43], s63 offen  lds
  s_add_u32 s63, s58, 15616
  s_add_u32 m0, s59, 35840
  s_nop 0
  buffer_load_dwordx4 v9, s[40:43], s63 offen  lds
  s_add_u32 s63, s58, 20736
  s_add_u32 m0, s59, 36864
  s_nop 0
  buffer_load_dwordx4 v10, s[40:43], s63 offen  lds
  s_add_u32 s63, s58, 25856
  s_add_u32 m0, s59, 37888
  s_nop 0
  buffer_load_dwordx4 v11, s[40:43], s63 offen  lds
  s_add_u32 s63, s58, 30976
  s_add_u32 m0, s59, 38912
  s_nop 0
  buffer_load_dwordx4 v10, s[40:43], s63 offen  lds
  s_add_u32 s63, s58, 36096
  s_add_u32 m0, s59, 39936
  s_nop 0
  buffer_load_dwordx4 v11, s[40:43], s63 offen  lds
  s_add_u32 s63, s58, 512
  s_add_u32 m0, s59, 65536
  s_nop 0
  buffer_load_dwordx4 v8, s[40:43], s63 offen  lds
  s_add_u32 s63, s58, 5632
  s_add_u32 m0, s59, 66560
  s_nop 0
  buffer_load_dwordx4 v9, s[40:43], s63 offen  lds
  s_add_u32 s63, s58, 10752
  s_add_u32 m0, s59, 67584
  s_nop 0
  buffer_load_dwordx4 v8, s[40:43], s63 offen  lds
  s_add_u32 s63, s58, 15872
  s_add_u32 m0, s59, 68608
  s_nop 0
  buffer_load_dwordx4 v9, s[40:43], s63 offen  lds
  s_add_u32 s63, s58, 20992
  s_add_u32 m0, s59, 69632
  s_nop 0
  buffer_load_dwordx4 v10, s[40:43], s63 offen  lds
  s_add_u32 s63, s58, 26112
  s_add_u32 m0, s59, 70656
  s_nop 0
  buffer_load_dwordx4 v11, s[40:43], s63 offen  lds
  s_add_u32 s63, s58, 31232
  s_add_u32 m0, s59, 71680
  s_nop 0
  buffer_load_dwordx4 v10, s[40:43], s63 offen  lds
  s_add_u32 s63, s58, 36352
  s_add_u32 m0, s59, 72704
  s_nop 0
  buffer_load_dwordx4 v11, s[40:43], s63 offen  lds
  s_add_u32 s63, s58, 768
  s_add_u32 m0, s59, 98304
  s_nop 0
  buffer_load_dwordx4 v8, s[40:43], s63 offen  lds
  s_add_u32 s63, s58, 5888
  s_add_u32 m0, s59, 99328
  s_nop 0
  buffer_load_dwordx4 v9, s[40:43], s63 offen  lds
  s_add_u32 s63, s58, 11008
  s_add_u32 m0, s59, 100352
  s_nop 0
  buffer_load_dwordx4 v8, s[40:43], s63 offen  lds
  s_add_u32 s63, s58, 16128
  s_add_u32 m0, s59, 101376
  s_nop 0
  buffer_load_dwordx4 v9, s[40:43], s63 offen  lds
  s_add_u32 s63, s58, 21248
  s_add_u32 m0, s59, 102400
  s_nop 0
  buffer_load_dwordx4 v10, s[40:43], s63 offen  lds
  s_add_u32 s63, s58, 26368
  s_add_u32 m0, s59, 103424
  s_nop 0
  buffer_load_dwordx4 v11, s[40:43], s63 offen  lds
  s_add_u32 s63, s58, 31488
  s_add_u32 m0, s59, 104448
  s_nop 0
  buffer_load_dwordx4 v10, s[40:43], s63 offen  lds
  s_add_u32 s63, s58, 36608
  s_add_u32 m0, s59, 105472
  s_nop 0
  buffer_load_dwordx4 v11, s[40:43], s63 offen  lds
  s_add_u32 s63, s58, 1024
  s_add_u32 m0, s59, 131072
  s_nop 0
  buffer_load_dwordx4 v8, s[40:43], s63 offen  lds
  s_add_u32 s63, s58, 6144
  s_add_u32 m0, s59, 132096
  s_nop 0
  buffer_load_dwordx4 v9, s[40:43], s63 offen  lds
  s_add_u32 s63, s58, 11264
  s_add_u32 m0, s59, 133120
  s_nop 0
  buffer_load_dwordx4 v8, s[40:43], s63 offen  lds
  s_add_u32 s63, s58, 16384
  s_add_u32 m0, s59, 134144
  s_nop 0
  buffer_load_dwordx4 v9, s[40:43], s63 offen  lds
  s_add_u32 s63, s58, 21504
  s_add_u32 m0, s59, 135168
  s_nop 0
  buffer_load_dwordx4 v10, s[40:43], s63 offen  lds
  s_add_u32 s63, s58, 26624
  s_add_u32 m0, s59, 136192
  s_nop 0
  buffer_load_dwordx4 v11, s[40:43], s63 offen  lds
  s_add_u32 s63, s58, 31744
  s_add_u32 m0, s59, 137216
  s_nop 0
  buffer_load_dwordx4 v10, s[40:43], s63 offen  lds
  s_add_u32 s63, s58, 36864
  s_add_u32 m0, s59, 138240
  s_nop 0
  buffer_load_dwordx4 v11, s[40:43], s63 offen  lds
L_nopack0:
  s_getpc_b64 s[64:65]
CW_33:
  s_sub_u32 s64, s64, CW_33-concat_heads__sliding_block__memory_aug_recurrent_mem_tr__prompt_kernel
  s_subb_u32 s65, s65, 0
  s_mov_b32 s66, L_exit-concat_heads__sliding_block__memory_aug_recurrent_mem_tr__prompt_kernel
  s_mov_b32 s67, 0x20000
  v_lshlrev_b32 v30, 4, v0
  s_lshr_b32 s60, s57, 2
  s_and_b32 s60, s60, 7
  s_mul_i32 s60, s60, 10240
  buffer_load_dwordx4 v[204:207], v30, s[64:67], s60 offen
  s_add_u32 s60, s60, 4096
  buffer_load_dwordx4 v[208:211], v30, s[64:67], s60 offen
  s_add_u32 s60, s60, 4096
  buffer_load_dwordx4 v[212:215], v30, s[64:67], s60 offen
  s_add_u32 s60, s60, 4096
  s_cmp_ge_u32 s57, 32
  s_cbranch_scc1 L_nopack
  v_lshrrev_b32 v24, 2, v23
  v_and_b32 v25, 1, v22
  v_lshlrev_b32 v26, 4, v25
  v_lshrrev_b32 v27, 1, v22
  v_lshl_add_u32 v26, v27, 3, v26
  v_lshrrev_b32 v27, 1, v24
  v_lshl_add_u32 v26, v27, 2, v26
  v_and_b32 v28, 1, v24
  v_add_u32 v26, v26, v28
  v_lshlrev_b32 v26, 8, v26
  v_lshl_add_u32 v28, v27, 1, v28
  v_lshl_add_u32 v28, v25, 2, v28
  v_lshlrev_b32 v28, 1, v28
  v_and_b32 v25, 3, v1
  v_lshlrev_b32 v25, 3, v25
  s_lshl_b32 s62, s56, 6
  v_add_u32 v25, s62, v25
  v_lshrrev_b32 v27, 4, v25
  v_xor_b32 v27, v27, v28
  v_lshl_add_u32 v27, v27, 4, v26
  v_and_b32 v29, 8, v25
  v_add_u32 v12, v27, v29
  v_add_u32 v25, 32, v25
  v_lshrrev_b32 v27, 4, v25
  v_xor_b32 v27, v27, v28
  v_lshl_add_u32 v27, v27, 4, v26
  v_and_b32 v29, 8, v25
  v_add_u32 v13, v27, v29
  v_lshlrev_b32 v14, 4, v1
  s_lshl_b32 s62, s56, 18
  s_lshl_b32 s63, s57, 12
  s_add_u32 s62, s62, s63
  s_add_u32 s62, s62, 92274688
  s_waitcnt vmcnt(35)
  s_barrier
  ds_read_b64_tr_b16 v[32:33], v12 offset:0
  ds_read_b64_tr_b16 v[34:35], v12 offset:512
  ds_read_b64_tr_b16 v[36:37], v12 offset:8192
  ds_read_b64_tr_b16 v[38:39], v12 offset:8704
  ds_read_b64_tr_b16 v[40:41], v12 offset:16384
  ds_read_b64_tr_b16 v[42:43], v12 offset:16896
  ds_read_b64_tr_b16 v[44:45], v12 offset:24576
  ds_read_b64_tr_b16 v[46:47], v12 offset:25088
  ds_read_b64_tr_b16 v[48:49], v13 offset:0
  ds_read_b64_tr_b16 v[50:51], v13 offset:512
  ds_read_b64_tr_b16 v[52:53], v13 offset:8192
  ds_read_b64_tr_b16 v[54:55], v13 offset:8704
  ds_read_b64_tr_b16 v[56:57], v13 offset:16384
  ds_read_b64_tr_b16 v[58:59], v13 offset:16896
  ds_read_b64_tr_b16 v[60:61], v13 offset:24576
  ds_read_b64_tr_b16 v[62:63], v13 offset:25088
  v_add_u32 v12, 0x8000, v12
  v_add_u32 v13, 0x8000, v13
  s_waitcnt lgkmcnt(0)
  s_add_u32 s63, s62, 0
  buffer_store_dwordx4 v[32:35], v14, s[32:35], s63 offen offset:0 sc1
  buffer_store_dwordx4 v[36:39], v14, s[32:35], s63 offen offset:1024 sc1
  buffer_store_dwordx4 v[40:43], v14, s[32:35], s63 offen offset:2048 sc1
  buffer_store_dwordx4 v[44:47], v14, s[32:35], s63 offen offset:3072 sc1
  s_add_u32 s63, s62, 131072
  buffer_store_dwordx4 v[48:51], v14, s[32:35], s63 offen offset:0 sc1
  buffer_store_dwordx4 v[52:55], v14, s[32:35], s63 offen offset:1024 sc1
  buffer_store_dwordx4 v[56:59], v14, s[32:35], s63 offen offset:2048 sc1
  buffer_store_dwordx4 v[60:63], v14, s[32:35], s63 offen offset:3072 sc1
  s_waitcnt vmcnt(35)
  s_barrier
  ds_read_b64_tr_b16 v[64:65], v12 offset:0
  ds_read_b64_tr_b16 v[66:67], v12 offset:512
  ds_read_b64_tr_b16 v[68:69], v12 offset:8192
  ds_read_b64_tr_b16 v[70:71], v12 offset:8704
  ds_read_b64_tr_b16 v[72:73], v12 offset:16384
  ds_read_b64_tr_b16 v[74:75], v12 offset:16896
  ds_read_b64_tr_b16 v[76:77], v12 offset:24576
  ds_read_b64_tr_b16 v[78:79], v12 offset:25088
  ds_read_b64_tr_b16 v[80:81], v13 offset:0
  ds_read_b64_tr_b16 v[82:83], v13 offset:512
  ds_read_b64_tr_b16 v[84:85], v13 offset:8192
  ds_read_b64_tr_b16 v[86:87], v13 offset:8704
  ds_read_b64_tr_b16 v[88:89], v13 offset:16384
  ds_read_b64_tr_b16 v[90:91], v13 offset:16896
  ds_read_b64_tr_b16 v[92:93], v13 offset:24576
  ds_read_b64_tr_b16 v[94:95], v13 offset:25088
  v_add_u32 v12, 0x8000, v12
  v_add_u32 v13, 0x8000, v13
  s_waitcnt lgkmcnt(0)
  s_add_u32 s63, s62, 1048576
  buffer_store_dwordx4 v[64:67], v14, s[32:35], s63 offen offset:0 sc1
  buffer_store_dwordx4 v[68:71], v14, s[32:35], s63 offen offset:1024 sc1
  buffer_store_dwordx4 v[72:75], v14, s[32:35], s63 offen offset:2048 sc1
  buffer_store_dwordx4 v[76:79], v14, s[32:35], s63 offen offset:3072 sc1
  s_add_u32 s63, s62, 1179648
  buffer_store_dwordx4 v[80:83], v14, s[32:35], s63 offen offset:0 sc1
  buffer_store_dwordx4 v[84:87], v14, s[32:35], s63 offen offset:1024 sc1
  buffer_store_dwordx4 v[88:91], v14, s[32:35], s63 offen offset:2048 sc1
  buffer_store_dwordx4 v[92:95], v14, s[32:35], s63 offen offset:3072 sc1
  s_waitcnt vmcnt(35)
  s_barrier
  ds_read_b64_tr_b16 v[32:33], v12 offset:0
  ds_read_b64_tr_b16 v[34:35], v12 offset:512
  ds_read_b64_tr_b16 v[36:37], v12 offset:8192
  ds_read_b64_tr_b16 v[38:39], v12 offset:8704
  ds_read_b64_tr_b16 v[40:41], v12 offset:16384
  ds_read_b64_tr_b16 v[42:43], v12 offset:16896
  ds_read_b64_tr_b16 v[44:45], v12 offset:24576
  ds_read_b64_tr_b16 v[46:47], v12 offset:25088
  ds_read_b64_tr_b16 v[48:49], v13 offset:0
  ds_read_b64_tr_b16 v[50:51], v13 offset:512
  ds_read_b64_tr_b16 v[52:53], v13 offset:8192
  ds_read_b64_tr_b16 v[54:55], v13 offset:8704
  ds_read_b64_tr_b16 v[56:57], v13 offset:16384
  ds_read_b64_tr_b16 v[58:59], v13 offset:16896
  ds_read_b64_tr_b16 v[60:61], v13 offset:24576
  ds_read_b64_tr_b16 v[62:63], v13 offset:25088
  v_add_u32 v12, 0x8000, v12
  v_add_u32 v13, 0x8000, v13
  s_waitcnt lgkmcnt(0)
  s_add_u32 s63, s62, 2097152
  buffer_store_dwordx4 v[32:35], v14, s[32:35], s63 offen offset:0 sc1
  buffer_store_dwordx4 v[36:39], v14, s[32:35], s63 offen offset:1024 sc1
  buffer_store_dwordx4 v[40:43], v14, s[32:35], s63 offen offset:2048 sc1
  buffer_store_dwordx4 v[44:47], v14, s[32:35], s63 offen offset:3072 sc1
  s_add_u32 s63, s62, 2228224
  buffer_store_dwordx4 v[48:51], v14, s[32:35], s63 offen offset:0 sc1
  buffer_store_dwordx4 v[52:55], v14, s[32:35], s63 offen offset:1024 sc1
  buffer_store_dwordx4 v[56:59], v14, s[32:35], s63 offen offset:2048 sc1
  buffer_store_dwordx4 v[60:63], v14, s[32:35], s63 offen offset:3072 sc1
  s_waitcnt vmcnt(35)
  s_barrier
  ds_read_b64_tr_b16 v[64:65], v12 offset:0
  ds_read_b64_tr_b16 v[66:67], v12 offset:512
  ds_read_b64_tr_b16 v[68:69], v12 offset:8192
  ds_read_b64_tr_b16 v[70:71], v12 offset:8704
  ds_read_b64_tr_b16 v[72:73], v12 offset:16384
  ds_read_b64_tr_b16 v[74:75], v12 offset:16896
  ds_read_b64_tr_b16 v[76:77], v12 offset:24576
  ds_read_b64_tr_b16 v[78:79], v12 offset:25088
  ds_read_b64_tr_b16 v[80:81], v13 offset:0
  ds_read_b64_tr_b16 v[82:83], v13 offset:512
  ds_read_b64_tr_b16 v[84:85], v13 offset:8192
  ds_read_b64_tr_b16 v[86:87], v13 offset:8704
  ds_read_b64_tr_b16 v[88:89], v13 offset:16384
  ds_read_b64_tr_b16 v[90:91], v13 offset:16896
  ds_read_b64_tr_b16 v[92:93], v13 offset:24576
  ds_read_b64_tr_b16 v[94:95], v13 offset:25088
  v_add_u32 v12, 0x8000, v12
  v_add_u32 v13, 0x8000, v13
  s_waitcnt lgkmcnt(0)
  s_add_u32 s63, s62, 3145728
  buffer_store_dwordx4 v[64:67], v14, s[32:35], s63 offen offset:0 sc1
  buffer_store_dwordx4 v[68:71], v14, s[32:35], s63 offen offset:1024 sc1
  buffer_store_dwordx4 v[72:75], v14, s[32:35], s63 offen offset:2048 sc1
  buffer_store_dwordx4 v[76:79], v14, s[32:35], s63 offen offset:3072 sc1
  s_add_u32 s63, s62, 3276800
  buffer_store_dwordx4 v[80:83], v14, s[32:35], s63 offen offset:0 sc1
  buffer_store_dwordx4 v[84:87], v14, s[32:35], s63 offen offset:1024 sc1
  buffer_store_dwordx4 v[88:91], v14, s[32:35], s63 offen offset:2048 sc1
  buffer_store_dwordx4 v[92:95], v14, s[32:35], s63 offen offset:3072 sc1
  s_waitcnt vmcnt(35)
  s_barrier
  ds_read_b64_tr_b16 v[32:33], v12 offset:0
  ds_read_b64_tr_b16 v[34:35], v12 offset:512
  ds_read_b64_tr_b16 v[36:37], v12 offset:8192
  ds_read_b64_tr_b16 v[38:39], v12 offset:8704
  ds_read_b64_tr_b16 v[40:41], v12 offset:16384
  ds_read_b64_tr_b16 v[42:43], v12 offset:16896
  ds_read_b64_tr_b16 v[44:45], v12 offset:24576
  ds_read_b64_tr_b16 v[46:47], v12 offset:25088
  ds_read_b64_tr_b16 v[48:49], v13 offset:0
  ds_read_b64_tr_b16 v[50:51], v13 offset:512
  ds_read_b64_tr_b16 v[52:53], v13 offset:8192
  ds_read_b64_tr_b16 v[54:55], v13 offset:8704
  ds_read_b64_tr_b16 v[56:57], v13 offset:16384
  ds_read_b64_tr_b16 v[58:59], v13 offset:16896
  ds_read_b64_tr_b16 v[60:61], v13 offset:24576
  ds_read_b64_tr_b16 v[62:63], v13 offset:25088
  v_add_u32 v12, 0x8000, v12
  v_add_u32 v13, 0x8000, v13
  s_waitcnt lgkmcnt(0)
  s_add_u32 s63, s62, 4194304
  buffer_store_dwordx4 v[32:35], v14, s[32:35], s63 offen offset:0 sc1
  buffer_store_dwordx4 v[36:39], v14, s[32:35], s63 offen offset:1024 sc1
  buffer_store_dwordx4 v[40:43], v14, s[32:35], s63 offen offset:2048 sc1
  buffer_store_dwordx4 v[44:47], v14, s[32:35], s63 offen offset:3072 sc1
  s_add_u32 s63, s62, 4325376
  buffer_store_dwordx4 v[48:51], v14, s[32:35], s63 offen offset:0 sc1
  buffer_store_dwordx4 v[52:55], v14, s[32:35], s63 offen offset:1024 sc1
  buffer_store_dwordx4 v[56:59], v14, s[32:35], s63 offen offset:2048 sc1
  buffer_store_dwordx4 v[60:63], v14, s[32:35], s63 offen offset:3072 sc1
  s_lshl_b32 s62, s57, 7
  s_add_u32 s62, s62, 88121344
  v_mov_b32 v14, 0
  v_mov_b32 v15, 1
  v_mov_b32 v21, 0
  s_movk_i32 s71, 16
  s_mov_b64 exec, 1
  s_mov_b32 s70, 0
SP_34:
  buffer_load_dword v20, v21, s[52:55], 0 offen sc1
  s_waitcnt vmcnt(0)
  v_cmp_gt_u32 vcc, s71, v20
  s_cbranch_vccz SD_35
  s_sleep 4
  s_add_u32 s70, s70, 1
  s_cmp_lt_u32 s70, 539568
  s_cbranch_scc1 SP_34
  s_endpgm
SD_35:
  s_mov_b64 exec, -1
  s_barrier
  buffer_store_dword v15, v14, s[32:35], s62 offen sc1
  s_branch L_packed
L_nopack:
  s_sub_u32 s59, s57, 32
  v_lshlrev_b32 v8, 4, v1
  v_mov_b32 v12, -1
  v_mov_b32 v13, -1
  v_mov_b32 v14, -1
  v_mov_b32 v15, -1
  v_mov_b32 v16, 0
  v_mov_b32 v17, 0
  v_mov_b32 v18, 0
  v_mov_b32 v19, 0
  s_lshl_b32 s60, s59, 2
  s_add_u32 s60, s60, s56
IN_36:
  s_lshl_b32 s61, s60, 10
  s_sub_u32 s62, s60, 128
  s_cmp_lt_u32 s62, 8
  s_cbranch_scc1 INX_39
  s_sub_u32 s62, s60, 144
  s_cmp_lt_u32 s62, 2
  s_cbranch_scc1 INX_39
  s_cmp_ge_u32 s60, 2048
  s_cbranch_scc1 IZ_37
  s_sub_u32 s62, s60, 208
  s_cmp_lt_u32 s62, 48
  s_cselect_b32 s62, 1, 0
  v_mov_b32 v16, s62
  s_and_b32 s62, s60, 255
  s_cmp_ge_u32 s62, 160
  s_cbranch_scc1 IZ_37
  buffer_store_dwordx4 v[12:15], v8, s[48:51], s61 offen sc1
  s_branch INX_39
IZ_37:
  buffer_store_dwordx4 v[16:19], v8, s[48:51], s61 offen sc1
  s_cmp_lt_u32 s60, 2048
  s_cbranch_scc1 INX_39
  s_add_u32 s61, s61, 85983232
  v_mov_b32 v16, 0
  buffer_store_dwordx4 v[16:19], v8, s[32:35], s61 offen sc1
INX_39:
  s_add_u32 s60, s60, 64
  s_cmp_lt_u32 s60, 2116
  s_cbranch_scc1 IN_36
  s_waitcnt vmcnt(0)
  s_barrier
  s_cmp_lg_u32 s56, 0
  s_cbranch_scc1 AR_40
  s_mov_b64 exec, 1
  v_mov_b32 v20, 0
  v_mov_b32 v21, 1
  buffer_atomic_add v21, v20, s[52:55], 0 offen sc1
  s_mov_b64 exec, -1
AR_40:
L_packed:
  s_mov_b32 s75, 1
  s_mov_b32 s76, 62
  L_t3entry:
  s_and_b32 s60, s57, 3
  s_mul_i32 s61, s60, 5
  s_lshr_b32 s62, s57, 3
  s_add_u32 s61, s61, s62
  s_lshr_b32 s62, s57, 2
  s_and_b32 s62, s62, 1
  s_mov_b32 s40, s20
  s_mov_b32 s41, s21
  s_mov_b32 s42, 5242880
  s_mov_b32 s44, s24
  s_mov_b32 s45, s25
  s_mov_b32 s46, 5242880
  v_lshrrev_b32 v22, 4, v1
  v_and_b32 v23, 15, v1
  v_lshrrev_b32 v2, 2, v1
  v_mul_u32_u24 v2, 1280, v2
  v_and_b32 v3, 3, v1
  v_lshl_add_u32 v2, v3, 4, v2
  s_mul_i32 s65, s56, 1310720
  s_lshl_b32 s66, s61, 6
  s_add_u32 s65, s65, s66
  s_lshl_b32 s66, s56, 15
  v_lshrrev_b32 v24, 2, v23
  v_lshl_add_u32 v24, v22, 2, v24
  v_lshlrev_b32 v24, 6, v24
  v_lshl_add_u32 v24, v3, 4, v24
  v_add_u32 v24, s66, v24
  v_lshlrev_b32 v4, 4, v1
  v_lshlrev_b32 v7, 7, v1
  v_mul_u32_u24 v5, 2560, v23
  v_lshl_add_u32 v5, v22, 4, v5
  s_lshl_b32 s67, s56, 11
  v_add_u32 v6, s67, v4

  v_mov_b32 v21, 0
  s_movk_i32 s71, 16
  s_mov_b64 exec, 1
  s_mov_b32 s70, 0
SP_41:
  buffer_load_dword v20, v21, s[52:55], 0 offen sc1
  s_waitcnt vmcnt(0)
  v_cmp_gt_u32 vcc, s71, v20
  s_cbranch_vccz SD_42
  s_sleep 4
  s_add_u32 s70, s70, 1
  s_cmp_lt_u32 s70, 539568
  s_cbranch_scc1 SP_41
  s_endpgm
SD_42:
  s_mov_b64 exec, -1
  v_mov_b32 v21, 0
  s_mov_b32 s68, 88080384
  s_mov_b64 exec, 1
  s_mov_b32 s70, 0
SP_43:
  buffer_load_dword v20, v21, s[32:35], s68 offen sc1
  s_waitcnt vmcnt(0)
  v_cmp_gt_u32 vcc, 1, v20
  s_cbranch_vccz SD_44
  s_sleep 8
  s_add_u32 s70, s70, 1
  s_cmp_lt_u32 s70, 369458
  s_cbranch_scc1 SP_43
  s_endpgm
SD_44:
  s_mov_b64 exec, -1
  s_add_u32 m0, s66, 0
  s_nop 0
  buffer_load_dwordx4 v2, s[40:43], s65 offen lds
  s_add_u32 s65, s65, 20480
  s_add_u32 m0, s66, 1024
  s_nop 0
  buffer_load_dwordx4 v2, s[40:43], s65 offen lds
  s_add_u32 s65, s65, 20480
  s_add_u32 m0, s66, 2048
  s_nop 0
  buffer_load_dwordx4 v2, s[40:43], s65 offen lds
  s_add_u32 s65, s65, 20480
  s_add_u32 m0, s66, 3072
  s_nop 0
  buffer_load_dwordx4 v2, s[40:43], s65 offen lds
  s_add_u32 s65, s65, 20480
  s_add_u32 m0, s66, 4096
  s_nop 0
  buffer_load_dwordx4 v2, s[40:43], s65 offen lds
  s_add_u32 s65, s65, 20480
  s_add_u32 m0, s66, 5120
  s_nop 0
  buffer_load_dwordx4 v2, s[40:43], s65 offen lds
  s_add_u32 s65, s65, 20480
  s_add_u32 m0, s66, 6144
  s_nop 0
  buffer_load_dwordx4 v2, s[40:43], s65 offen lds
  s_add_u32 s65, s65, 20480
  s_add_u32 m0, s66, 7168
  s_nop 0
  buffer_load_dwordx4 v2, s[40:43], s65 offen lds
  s_add_u32 s65, s65, 20480
  s_add_u32 m0, s66, 8192
  s_nop 0
  buffer_load_dwordx4 v2, s[40:43], s65 offen lds
  s_add_u32 s65, s65, 20480
  s_add_u32 m0, s66, 9216
  s_nop 0
  buffer_load_dwordx4 v2, s[40:43], s65 offen lds
  s_add_u32 s65, s65, 20480
  s_add_u32 m0, s66, 10240
  s_nop 0
  buffer_load_dwordx4 v2, s[40:43], s65 offen lds
  s_add_u32 s65, s65, 20480
  s_add_u32 m0, s66, 11264
  s_nop 0
  buffer_load_dwordx4 v2, s[40:43], s65 offen lds
  s_add_u32 s65, s65, 20480
  s_add_u32 m0, s66, 12288
  s_nop 0
  buffer_load_dwordx4 v2, s[40:43], s65 offen lds
  s_add_u32 s65, s65, 20480
  s_add_u32 m0, s66, 13312
  s_nop 0
  buffer_load_dwordx4 v2, s[40:43], s65 offen lds
  s_add_u32 s65, s65, 20480
  s_add_u32 m0, s66, 14336
  s_nop 0
  buffer_load_dwordx4 v2, s[40:43], s65 offen lds
  s_add_u32 s65, s65, 20480
  s_add_u32 m0, s66, 15360
  s_nop 0
  buffer_load_dwordx4 v2, s[40:43], s65 offen lds
  s_add_u32 s65, s65, 20480
  s_add_u32 m0, s66, 16384
  s_nop 0
  buffer_load_dwordx4 v2, s[40:43], s65 offen lds
  s_add_u32 s65, s65, 20480
  s_add_u32 m0, s66, 17408
  s_nop 0
  buffer_load_dwordx4 v2, s[40:43], s65 offen lds
  s_add_u32 s65, s65, 20480
  s_add_u32 m0, s66, 18432
  s_nop 0
  buffer_load_dwordx4 v2, s[40:43], s65 offen lds
  s_add_u32 s65, s65, 20480
  s_add_u32 m0, s66, 19456
  s_nop 0
  buffer_load_dwordx4 v2, s[40:43], s65 offen lds
  s_add_u32 s65, s65, 20480
  s_add_u32 m0, s66, 20480
  s_nop 0
  buffer_load_dwordx4 v2, s[40:43], s65 offen lds
  s_add_u32 s65, s65, 20480
  s_add_u32 m0, s66, 21504
  s_nop 0
  buffer_load_dwordx4 v2, s[40:43], s65 offen lds
  s_add_u32 s65, s65, 20480
  s_add_u32 m0, s66, 22528
  s_nop 0
  buffer_load_dwordx4 v2, s[40:43], s65 offen lds
  s_add_u32 s65, s65, 20480
  s_add_u32 m0, s66, 23552
  s_nop 0
  buffer_load_dwordx4 v2, s[40:43], s65 offen lds
  s_add_u32 s65, s65, 20480
  s_add_u32 m0, s66, 24576
  s_nop 0
  buffer_load_dwordx4 v2, s[40:43], s65 offen lds
  s_add_u32 s65, s65, 20480
  s_add_u32 m0, s66, 25600
  s_nop 0
  buffer_load_dwordx4 v2, s[40:43], s65 offen lds
  s_add_u32 s65, s65, 20480
  s_add_u32 m0, s66, 26624
  s_nop 0
  buffer_load_dwordx4 v2, s[40:43], s65 offen lds
  s_add_u32 s65, s65, 20480
  s_add_u32 m0, s66, 27648
  s_nop 0
  buffer_load_dwordx4 v2, s[40:43], s65 offen lds
  s_add_u32 s65, s65, 20480
  s_add_u32 m0, s66, 28672
  s_nop 0
  buffer_load_dwordx4 v2, s[40:43], s65 offen lds
  s_add_u32 s65, s65, 20480
  s_add_u32 m0, s66, 29696
  s_nop 0
  buffer_load_dwordx4 v2, s[40:43], s65 offen lds
  s_add_u32 s65, s65, 20480
  s_add_u32 m0, s66, 30720
  s_nop 0
  buffer_load_dwordx4 v2, s[40:43], s65 offen lds
  s_add_u32 s65, s65, 20480
  s_add_u32 m0, s66, 31744
  s_nop 0
  buffer_load_dwordx4 v2, s[40:43], s65 offen lds
  s_add_u32 s65, s65, 20480
  s_waitcnt vmcnt(0)
  ds_read_b64_tr_b16 a[0:1], v24 offset:0
  ds_read_b64_tr_b16 a[2:3], v24 offset:1024
  ds_read_b64_tr_b16 a[4:5], v24 offset:8
  ds_read_b64_tr_b16 a[6:7], v24 offset:1032
  s_waitcnt lgkmcnt(0)
  ds_read_b64_tr_b16 a[8:9], v24 offset:2048
  ds_read_b64_tr_b16 a[10:11], v24 offset:3072
  ds_read_b64_tr_b16 a[12:13], v24 offset:2056
  ds_read_b64_tr_b16 a[14:15], v24 offset:3080
  s_waitcnt lgkmcnt(0)
  ds_read_b64_tr_b16 a[16:17], v24 offset:4096
  ds_read_b64_tr_b16 a[18:19], v24 offset:5120
  ds_read_b64_tr_b16 a[20:21], v24 offset:4104
  ds_read_b64_tr_b16 a[22:23], v24 offset:5128
  s_waitcnt lgkmcnt(0)
  ds_read_b64_tr_b16 a[24:25], v24 offset:6144
  ds_read_b64_tr_b16 a[26:27], v24 offset:7168
  ds_read_b64_tr_b16 a[28:29], v24 offset:6152
  ds_read_b64_tr_b16 a[30:31], v24 offset:7176
  s_waitcnt lgkmcnt(0)
  ds_read_b64_tr_b16 a[32:33], v24 offset:8192
  ds_read_b64_tr_b16 a[34:35], v24 offset:9216
  ds_read_b64_tr_b16 a[36:37], v24 offset:8200
  ds_read_b64_tr_b16 a[38:39], v24 offset:9224
  s_waitcnt lgkmcnt(0)
  ds_read_b64_tr_b16 a[40:41], v24 offset:10240
  ds_read_b64_tr_b16 a[42:43], v24 offset:11264
  ds_read_b64_tr_b16 a[44:45], v24 offset:10248
  ds_read_b64_tr_b16 a[46:47], v24 offset:11272
  s_waitcnt lgkmcnt(0)
  ds_read_b64_tr_b16 a[48:49], v24 offset:12288
  ds_read_b64_tr_b16 a[50:51], v24 offset:13312
  ds_read_b64_tr_b16 a[52:53], v24 offset:12296
  ds_read_b64_tr_b16 a[54:55], v24 offset:13320
  s_waitcnt lgkmcnt(0)
  ds_read_b64_tr_b16 a[56:57], v24 offset:14336
  ds_read_b64_tr_b16 a[58:59], v24 offset:15360
  ds_read_b64_tr_b16 a[60:61], v24 offset:14344
  ds_read_b64_tr_b16 a[62:63], v24 offset:15368
  s_waitcnt lgkmcnt(0)
  ds_read_b64_tr_b16 a[64:65], v24 offset:16384
  ds_read_b64_tr_b16 a[66:67], v24 offset:17408
  ds_read_b64_tr_b16 a[68:69], v24 offset:16392
  ds_read_b64_tr_b16 a[70:71], v24 offset:17416
  s_waitcnt lgkmcnt(0)
  ds_read_b64_tr_b16 a[72:73], v24 offset:18432
  ds_read_b64_tr_b16 a[74:75], v24 offset:19456
  ds_read_b64_tr_b16 a[76:77], v24 offset:18440
  ds_read_b64_tr_b16 a[78:79], v24 offset:19464
  s_waitcnt lgkmcnt(0)
  ds_read_b64_tr_b16 a[80:81], v24 offset:20480
  ds_read_b64_tr_b16 a[82:83], v24 offset:21504
  ds_read_b64_tr_b16 a[84:85], v24 offset:20488
  ds_read_b64_tr_b16 a[86:87], v24 offset:21512
  s_waitcnt lgkmcnt(0)
  ds_read_b64_tr_b16 a[88:89], v24 offset:22528
  ds_read_b64_tr_b16 a[90:91], v24 offset:23552
  ds_read_b64_tr_b16 a[92:93], v24 offset:22536
  ds_read_b64_tr_b16 a[94:95], v24 offset:23560
  s_waitcnt lgkmcnt(0)
  ds_read_b64_tr_b16 a[96:97], v24 offset:24576
  ds_read_b64_tr_b16 a[98:99], v24 offset:25600
  ds_read_b64_tr_b16 a[100:101], v24 offset:24584
  ds_read_b64_tr_b16 a[102:103], v24 offset:25608
  s_waitcnt lgkmcnt(0)
  ds_read_b64_tr_b16 a[104:105], v24 offset:26624
  ds_read_b64_tr_b16 a[106:107], v24 offset:27648
  ds_read_b64_tr_b16 a[108:109], v24 offset:26632
  ds_read_b64_tr_b16 a[110:111], v24 offset:27656
  s_waitcnt lgkmcnt(0)
  ds_read_b64_tr_b16 a[112:113], v24 offset:28672
  ds_read_b64_tr_b16 a[114:115], v24 offset:29696
  ds_read_b64_tr_b16 a[116:117], v24 offset:28680
  ds_read_b64_tr_b16 a[118:119], v24 offset:29704
  s_waitcnt lgkmcnt(0)
  ds_read_b64_tr_b16 a[120:121], v24 offset:30720
  ds_read_b64_tr_b16 a[122:123], v24 offset:31744
  ds_read_b64_tr_b16 a[124:125], v24 offset:30728
  ds_read_b64_tr_b16 a[126:127], v24 offset:31752
  s_waitcnt lgkmcnt(0)
  s_add_u32 m0, s66, 0
  s_nop 0
  buffer_load_dwordx4 v2, s[40:43], s65 offen lds
  s_add_u32 s65, s65, 20480
  s_add_u32 m0, s66, 1024
  s_nop 0
  buffer_load_dwordx4 v2, s[40:43], s65 offen lds
  s_add_u32 s65, s65, 20480
  s_add_u32 m0, s66, 2048
  s_nop 0
  buffer_load_dwordx4 v2, s[40:43], s65 offen lds
  s_add_u32 s65, s65, 20480
  s_add_u32 m0, s66, 3072
  s_nop 0
  buffer_load_dwordx4 v2, s[40:43], s65 offen lds
  s_add_u32 s65, s65, 20480
  s_add_u32 m0, s66, 4096
  s_nop 0
  buffer_load_dwordx4 v2, s[40:43], s65 offen lds
  s_add_u32 s65, s65, 20480
  s_add_u32 m0, s66, 5120
  s_nop 0
  buffer_load_dwordx4 v2, s[40:43], s65 offen lds
  s_add_u32 s65, s65, 20480
  s_add_u32 m0, s66, 6144
  s_nop 0
  buffer_load_dwordx4 v2, s[40:43], s65 offen lds
  s_add_u32 s65, s65, 20480
  s_add_u32 m0, s66, 7168
  s_nop 0
  buffer_load_dwordx4 v2, s[40:43], s65 offen lds
  s_add_u32 s65, s65, 20480
  s_add_u32 m0, s66, 8192
  s_nop 0
  buffer_load_dwordx4 v2, s[40:43], s65 offen lds
  s_add_u32 s65, s65, 20480
  s_add_u32 m0, s66, 9216
  s_nop 0
  buffer_load_dwordx4 v2, s[40:43], s65 offen lds
  s_add_u32 s65, s65, 20480
  s_add_u32 m0, s66, 10240
  s_nop 0
  buffer_load_dwordx4 v2, s[40:43], s65 offen lds
  s_add_u32 s65, s65, 20480
  s_add_u32 m0, s66, 11264
  s_nop 0
  buffer_load_dwordx4 v2, s[40:43], s65 offen lds
  s_add_u32 s65, s65, 20480
  s_add_u32 m0, s66, 12288
  s_nop 0
  buffer_load_dwordx4 v2, s[40:43], s65 offen lds
  s_add_u32 s65, s65, 20480
  s_add_u32 m0, s66, 13312
  s_nop 0
  buffer_load_dwordx4 v2, s[40:43], s65 offen lds
  s_add_u32 s65, s65, 20480
  s_add_u32 m0, s66, 14336
  s_nop 0
  buffer_load_dwordx4 v2, s[40:43], s65 offen lds
  s_add_u32 s65, s65, 20480
  s_add_u32 m0, s66, 15360
  s_nop 0
  buffer_load_dwordx4 v2, s[40:43], s65 offen lds
  s_add_u32 s65, s65, 20480
  s_add_u32 m0, s66, 16384
  s_nop 0
  buffer_load_dwordx4 v2, s[40:43], s65 offen lds
  s_add_u32 s65, s65, 20480
  s_add_u32 m0, s66, 17408
  s_nop 0
  buffer_load_dwordx4 v2, s[40:43], s65 offen lds
  s_add_u32 s65, s65, 20480
  s_add_u32 m0, s66, 18432
  s_nop 0
  buffer_load_dwordx4 v2, s[40:43], s65 offen lds
  s_add_u32 s65, s65, 20480
  s_add_u32 m0, s66, 19456
  s_nop 0
  buffer_load_dwordx4 v2, s[40:43], s65 offen lds
  s_add_u32 s65, s65, 20480
  s_add_u32 m0, s66, 20480
  s_nop 0
  buffer_load_dwordx4 v2, s[40:43], s65 offen lds
  s_add_u32 s65, s65, 20480
  s_add_u32 m0, s66, 21504
  s_nop 0
  buffer_load_dwordx4 v2, s[40:43], s65 offen lds
  s_add_u32 s65, s65, 20480
  s_add_u32 m0, s66, 22528
  s_nop 0
  buffer_load_dwordx4 v2, s[40:43], s65 offen lds
  s_add_u32 s65, s65, 20480
  s_add_u32 m0, s66, 23552
  s_nop 0
  buffer_load_dwordx4 v2, s[40:43], s65 offen lds
  s_add_u32 s65, s65, 20480
  s_add_u32 m0, s66, 24576
  s_nop 0
  buffer_load_dwordx4 v2, s[40:43], s65 offen lds
  s_add_u32 s65, s65, 20480
  s_add_u32 m0, s66, 25600
  s_nop 0
  buffer_load_dwordx4 v2, s[40:43], s65 offen lds
  s_add_u32 s65, s65, 20480
  s_add_u32 m0, s66, 26624
  s_nop 0
  buffer_load_dwordx4 v2, s[40:43], s65 offen lds
  s_add_u32 s65, s65, 20480
  s_add_u32 m0, s66, 27648
  s_nop 0
  buffer_load_dwordx4 v2, s[40:43], s65 offen lds
  s_add_u32 s65, s65, 20480
  s_add_u32 m0, s66, 28672
  s_nop 0
  buffer_load_dwordx4 v2, s[40:43], s65 offen lds
  s_add_u32 s65, s65, 20480
  s_add_u32 m0, s66, 29696
  s_nop 0
  buffer_load_dwordx4 v2, s[40:43], s65 offen lds
  s_add_u32 s65, s65, 20480
  s_add_u32 m0, s66, 30720
  s_nop 0
  buffer_load_dwordx4 v2, s[40:43], s65 offen lds
  s_add_u32 s65, s65, 20480
  s_add_u32 m0, s66, 31744
  s_nop 0
  buffer_load_dwordx4 v2, s[40:43], s65 offen lds
  s_add_u32 s65, s65, 20480
  s_waitcnt vmcnt(0)
  ds_read_b64_tr_b16 a[128:129], v24 offset:0
  ds_read_b64_tr_b16 a[130:131], v24 offset:1024
  ds_read_b64_tr_b16 a[132:133], v24 offset:8
  ds_read_b64_tr_b16 a[134:135], v24 offset:1032
  s_waitcnt lgkmcnt(0)
  ds_read_b64_tr_b16 a[136:137], v24 offset:2048
  ds_read_b64_tr_b16 a[138:139], v24 offset:3072
  ds_read_b64_tr_b16 a[140:141], v24 offset:2056
  ds_read_b64_tr_b16 a[142:143], v24 offset:3080
  s_waitcnt lgkmcnt(0)
  ds_read_b64_tr_b16 a[144:145], v24 offset:4096
  ds_read_b64_tr_b16 a[146:147], v24 offset:5120
  ds_read_b64_tr_b16 a[148:149], v24 offset:4104
  ds_read_b64_tr_b16 a[150:151], v24 offset:5128
  s_waitcnt lgkmcnt(0)
  ds_read_b64_tr_b16 a[152:153], v24 offset:6144
  ds_read_b64_tr_b16 a[154:155], v24 offset:7168
  ds_read_b64_tr_b16 a[156:157], v24 offset:6152
  ds_read_b64_tr_b16 a[158:159], v24 offset:7176
  s_waitcnt lgkmcnt(0)
  ds_read_b64_tr_b16 a[160:161], v24 offset:8192
  ds_read_b64_tr_b16 a[162:163], v24 offset:9216
  ds_read_b64_tr_b16 a[164:165], v24 offset:8200
  ds_read_b64_tr_b16 a[166:167], v24 offset:9224
  s_waitcnt lgkmcnt(0)
  ds_read_b64_tr_b16 a[168:169], v24 offset:10240
  ds_read_b64_tr_b16 a[170:171], v24 offset:11264
  ds_read_b64_tr_b16 a[172:173], v24 offset:10248
  ds_read_b64_tr_b16 a[174:175], v24 offset:11272
  s_waitcnt lgkmcnt(0)
  ds_read_b64_tr_b16 a[176:177], v24 offset:12288
  ds_read_b64_tr_b16 a[178:179], v24 offset:13312
  ds_read_b64_tr_b16 a[180:181], v24 offset:12296
  ds_read_b64_tr_b16 a[182:183], v24 offset:13320
  s_waitcnt lgkmcnt(0)
  ds_read_b64_tr_b16 a[184:185], v24 offset:14336
  ds_read_b64_tr_b16 a[186:187], v24 offset:15360
  ds_read_b64_tr_b16 a[188:189], v24 offset:14344
  ds_read_b64_tr_b16 a[190:191], v24 offset:15368
  s_waitcnt lgkmcnt(0)
  ds_read_b64_tr_b16 a[192:193], v24 offset:16384
  ds_read_b64_tr_b16 a[194:195], v24 offset:17408
  ds_read_b64_tr_b16 a[196:197], v24 offset:16392
  ds_read_b64_tr_b16 a[198:199], v24 offset:17416
  s_waitcnt lgkmcnt(0)
  ds_read_b64_tr_b16 a[200:201], v24 offset:18432
  ds_read_b64_tr_b16 a[202:203], v24 offset:19456
  ds_read_b64_tr_b16 a[204:205], v24 offset:18440
  ds_read_b64_tr_b16 a[206:207], v24 offset:19464
  s_waitcnt lgkmcnt(0)
  ds_read_b64_tr_b16 a[208:209], v24 offset:20480
  ds_read_b64_tr_b16 a[210:211], v24 offset:21504
  ds_read_b64_tr_b16 a[212:213], v24 offset:20488
  ds_read_b64_tr_b16 a[214:215], v24 offset:21512
  s_waitcnt lgkmcnt(0)
  ds_read_b64_tr_b16 a[216:217], v24 offset:22528
  ds_read_b64_tr_b16 a[218:219], v24 offset:23552
  ds_read_b64_tr_b16 a[220:221], v24 offset:22536
  ds_read_b64_tr_b16 a[222:223], v24 offset:23560
  s_waitcnt lgkmcnt(0)
  ds_read_b64_tr_b16 a[224:225], v24 offset:24576
  ds_read_b64_tr_b16 a[226:227], v24 offset:25600
  ds_read_b64_tr_b16 a[228:229], v24 offset:24584
  ds_read_b64_tr_b16 a[230:231], v24 offset:25608
  s_waitcnt lgkmcnt(0)
  ds_read_b64_tr_b16 a[232:233], v24 offset:26624
  ds_read_b64_tr_b16 a[234:235], v24 offset:27648
  ds_read_b64_tr_b16 a[236:237], v24 offset:26632
  ds_read_b64_tr_b16 a[238:239], v24 offset:27656
  s_waitcnt lgkmcnt(0)
  ds_read_b64_tr_b16 a[240:241], v24 offset:28672
  ds_read_b64_tr_b16 a[242:243], v24 offset:29696
  ds_read_b64_tr_b16 a[244:245], v24 offset:28680
  ds_read_b64_tr_b16 a[246:247], v24 offset:29704
  s_waitcnt lgkmcnt(0)
  ds_read_b64_tr_b16 a[248:249], v24 offset:30720
  ds_read_b64_tr_b16 a[250:251], v24 offset:31744
  ds_read_b64_tr_b16 a[252:253], v24 offset:30728
  ds_read_b64_tr_b16 a[254:255], v24 offset:31752
  s_waitcnt lgkmcnt(0)
  s_barrier
  s_lshl_b32 s68, s56, 10
  s_add_u32 s68, s68, 88113152
  s_lshl_b32 s69, s56, 16
  s_lshl_b32 s70, s62, 12
  s_add_u32 s69, s69, s70
  s_add_u32 s69, s69, 54525952
  s_mul_i32 s72, s62, 40960
  s_lshl_b32 s70, s61, 6
  s_add_u32 s72, s72, s70
  s_add_u32 s72, s72, 1280
  s_sub_u32 s60, s75, 1
  s_mul_i32 s70, s60, 262144
  s_add_u32 s69, s69, s70
  s_mul_i32 s70, s60, 81920
  s_add_u32 s72, s72, s70
  s_max_u32 s60, s60, 4
  s_sub_u32 s60, s60, 4
  v_min_u32 v7, 7, v1
  v_lshlrev_b32 v7, 7, v7

  s_mov_b32 s70, 0
SP_45:
  buffer_load_dwordx4 v[20:23], v7, s[32:35], s68 offen sc1
  s_waitcnt vmcnt(0)
  v_min_u32 v20, v20, v21
  v_min3_u32 v20, v20, v22, v23
  v_cmp_gt_u32 vcc, s60, v20
  s_cbranch_vccz SD_46
  s_sleep 24
  s_add_u32 s70, s70, 1
  s_cmp_lt_u32 s70, 163398
  s_cbranch_scc1 SP_45
  s_endpgm
SD_46:
  s_mov_b64 exec, -1
  s_mov_b32 s60, s75
  s_mov_b32 s74, 0
L_t3loop:
  s_cmp_eq_u32 s74, 1
  s_cbranch_scc1 L_t3have
  v_cmp_gt_u32 vcc, s60, v20
  s_cbranch_vccz L_t3go

  s_mov_b32 s70, 0
SP_47:
  buffer_load_dwordx4 v[20:23], v7, s[32:35], s68 offen sc1
  s_waitcnt vmcnt(0)
  v_min_u32 v20, v20, v21
  v_min3_u32 v20, v20, v22, v23
  v_cmp_gt_u32 vcc, s60, v20
  s_cbranch_vccz SD_48
  s_sleep 1
  s_add_u32 s70, s70, 1
  s_cmp_lt_u32 s70, 824175
  s_cbranch_scc1 SP_47
  s_endpgm
SD_48:
  s_mov_b64 exec, -1
L_t3go:
  s_add_u32 s73, s69, 0
  buffer_load_dwordx4 v[32:35], v4, s[32:35], s73 offen offset:0 sc1
  buffer_load_dwordx4 v[36:39], v4, s[32:35], s73 offen offset:1024 sc1
  buffer_load_dwordx4 v[40:43], v4, s[32:35], s73 offen offset:2048 sc1
  buffer_load_dwordx4 v[44:47], v4, s[32:35], s73 offen offset:3072 sc1
  s_add_u32 s73, s69, 8192
  buffer_load_dwordx4 v[48:51], v4, s[32:35], s73 offen offset:0 sc1
  buffer_load_dwordx4 v[52:55], v4, s[32:35], s73 offen offset:1024 sc1
  buffer_load_dwordx4 v[56:59], v4, s[32:35], s73 offen offset:2048 sc1
  buffer_load_dwordx4 v[60:63], v4, s[32:35], s73 offen offset:3072 sc1
  s_add_u32 s73, s69, 16384
  buffer_load_dwordx4 v[64:67], v4, s[32:35], s73 offen offset:0 sc1
  buffer_load_dwordx4 v[68:71], v4, s[32:35], s73 offen offset:1024 sc1
  buffer_load_dwordx4 v[72:75], v4, s[32:35], s73 offen offset:2048 sc1
  buffer_load_dwordx4 v[76:79], v4, s[32:35], s73 offen offset:3072 sc1
  s_add_u32 s73, s69, 24576
  buffer_load_dwordx4 v[80:83], v4, s[32:35], s73 offen offset:0 sc1
  buffer_load_dwordx4 v[84:87], v4, s[32:35], s73 offen offset:1024 sc1
  buffer_load_dwordx4 v[88:91], v4, s[32:35], s73 offen offset:2048 sc1
  buffer_load_dwordx4 v[92:95], v4, s[32:35], s73 offen offset:3072 sc1
  s_add_u32 s73, s69, 32768
  buffer_load_dwordx4 v[96:99], v4, s[32:35], s73 offen offset:0 sc1
  buffer_load_dwordx4 v[100:103], v4, s[32:35], s73 offen offset:1024 sc1
  buffer_load_dwordx4 v[104:107], v4, s[32:35], s73 offen offset:2048 sc1
  buffer_load_dwordx4 v[108:111], v4, s[32:35], s73 offen offset:3072 sc1
  s_add_u32 s73, s69, 40960
  buffer_load_dwordx4 v[112:115], v4, s[32:35], s73 offen offset:0 sc1
  buffer_load_dwordx4 v[116:119], v4, s[32:35], s73 offen offset:1024 sc1
  buffer_load_dwordx4 v[120:123], v4, s[32:35], s73 offen offset:2048 sc1
  buffer_load_dwordx4 v[124:127], v4, s[32:35], s73 offen offset:3072 sc1
  s_add_u32 s73, s69, 49152
  buffer_load_dwordx4 v[128:131], v4, s[32:35], s73 offen offset:0 sc1
  buffer_load_dwordx4 v[132:135], v4, s[32:35], s73 offen offset:1024 sc1
  buffer_load_dwordx4 v[136:139], v4, s[32:35], s73 offen offset:2048 sc1
  buffer_load_dwordx4 v[140:143], v4, s[32:35], s73 offen offset:3072 sc1
  s_add_u32 s73, s69, 57344
  buffer_load_dwordx4 v[144:147], v4, s[32:35], s73 offen offset:0 sc1
  buffer_load_dwordx4 v[148:151], v4, s[32:35], s73 offen offset:1024 sc1
  buffer_load_dwordx4 v[152:155], v4, s[32:35], s73 offen offset:2048 sc1
  buffer_load_dwordx4 v[156:159], v4, s[32:35], s73 offen offset:3072 sc1
L_t3have:
  s_add_u32 s69, s69, 262144
  s_cmp_ge_u32 s60, s76
  s_cbranch_scc1 L_t3plain
  v_cmp_ge_u32 vcc, s60, v20
  s_cbranch_vccz L_t3ahead
L_t3plain:
  s_mov_b32 s74, 0
  buffer_load_dwordx4 v[20:23], v7, s[32:35], s68 offen sc1
  s_waitcnt vmcnt(32)
  v_mfma_f32_16x16x32_bf16 v[8:11], a[0:3], v[32:35], 0
  v_mfma_f32_16x16x32_bf16 v[12:15], a[4:7], v[32:35], 0
  s_waitcnt vmcnt(31)
  v_mfma_f32_16x16x32_bf16 v[8:11], a[8:11], v[36:39], v[8:11]
  v_mfma_f32_16x16x32_bf16 v[12:15], a[12:15], v[36:39], v[12:15]
  s_waitcnt vmcnt(30)
  v_mfma_f32_16x16x32_bf16 v[8:11], a[16:19], v[40:43], v[8:11]
  v_mfma_f32_16x16x32_bf16 v[12:15], a[20:23], v[40:43], v[12:15]
  s_waitcnt vmcnt(29)
  v_mfma_f32_16x16x32_bf16 v[8:11], a[24:27], v[44:47], v[8:11]
  v_mfma_f32_16x16x32_bf16 v[12:15], a[28:31], v[44:47], v[12:15]
  s_waitcnt vmcnt(28)
  v_mfma_f32_16x16x32_bf16 v[8:11], a[32:35], v[48:51], v[8:11]
  v_mfma_f32_16x16x32_bf16 v[12:15], a[36:39], v[48:51], v[12:15]
  s_waitcnt vmcnt(27)
  v_mfma_f32_16x16x32_bf16 v[8:11], a[40:43], v[52:55], v[8:11]
  v_mfma_f32_16x16x32_bf16 v[12:15], a[44:47], v[52:55], v[12:15]
  s_waitcnt vmcnt(26)
  v_mfma_f32_16x16x32_bf16 v[8:11], a[48:51], v[56:59], v[8:11]
  v_mfma_f32_16x16x32_bf16 v[12:15], a[52:55], v[56:59], v[12:15]
  s_waitcnt vmcnt(25)
  v_mfma_f32_16x16x32_bf16 v[8:11], a[56:59], v[60:63], v[8:11]
  v_mfma_f32_16x16x32_bf16 v[12:15], a[60:63], v[60:63], v[12:15]
  s_waitcnt vmcnt(24)
  v_mfma_f32_16x16x32_bf16 v[8:11], a[64:67], v[64:67], v[8:11]
  v_mfma_f32_16x16x32_bf16 v[12:15], a[68:71], v[64:67], v[12:15]
  s_waitcnt vmcnt(23)
  v_mfma_f32_16x16x32_bf16 v[8:11], a[72:75], v[68:71], v[8:11]
  v_mfma_f32_16x16x32_bf16 v[12:15], a[76:79], v[68:71], v[12:15]
  s_waitcnt vmcnt(22)
  v_mfma_f32_16x16x32_bf16 v[8:11], a[80:83], v[72:75], v[8:11]
  v_mfma_f32_16x16x32_bf16 v[12:15], a[84:87], v[72:75], v[12:15]
  s_waitcnt vmcnt(21)
  v_mfma_f32_16x16x32_bf16 v[8:11], a[88:91], v[76:79], v[8:11]
  v_mfma_f32_16x16x32_bf16 v[12:15], a[92:95], v[76:79], v[12:15]
  s_waitcnt vmcnt(20)
  v_mfma_f32_16x16x32_bf16 v[8:11], a[96:99], v[80:83], v[8:11]
  v_mfma_f32_16x16x32_bf16 v[12:15], a[100:103], v[80:83], v[12:15]
  s_waitcnt vmcnt(19)
  v_mfma_f32_16x16x32_bf16 v[8:11], a[104:107], v[84:87], v[8:11]
  v_mfma_f32_16x16x32_bf16 v[12:15], a[108:111], v[84:87], v[12:15]
  s_waitcnt vmcnt(18)
  v_mfma_f32_16x16x32_bf16 v[8:11], a[112:115], v[88:91], v[8:11]
  v_mfma_f32_16x16x32_bf16 v[12:15], a[116:119], v[88:91], v[12:15]
  s_waitcnt vmcnt(17)
  v_mfma_f32_16x16x32_bf16 v[8:11], a[120:123], v[92:95], v[8:11]
  v_mfma_f32_16x16x32_bf16 v[12:15], a[124:127], v[92:95], v[12:15]
  s_waitcnt vmcnt(16)
  v_mfma_f32_16x16x32_bf16 v[8:11], a[128:131], v[96:99], v[8:11]
  v_mfma_f32_16x16x32_bf16 v[12:15], a[132:135], v[96:99], v[12:15]
  s_waitcnt vmcnt(15)
  v_mfma_f32_16x16x32_bf16 v[8:11], a[136:139], v[100:103], v[8:11]
  v_mfma_f32_16x16x32_bf16 v[12:15], a[140:143], v[100:103], v[12:15]
  s_waitcnt vmcnt(14)
  v_mfma_f32_16x16x32_bf16 v[8:11], a[144:147], v[104:107], v[8:11]
  v_mfma_f32_16x16x32_bf16 v[12:15], a[148:151], v[104:107], v[12:15]
  s_waitcnt vmcnt(13)
  v_mfma_f32_16x16x32_bf16 v[8:11], a[152:155], v[108:111], v[8:11]
  v_mfma_f32_16x16x32_bf16 v[12:15], a[156:159], v[108:111], v[12:15]
  s_waitcnt vmcnt(12)
  v_mfma_f32_16x16x32_bf16 v[8:11], a[160:163], v[112:115], v[8:11]
  v_mfma_f32_16x16x32_bf16 v[12:15], a[164:167], v[112:115], v[12:15]
  s_waitcnt vmcnt(11)
  v_mfma_f32_16x16x32_bf16 v[8:11], a[168:171], v[116:119], v[8:11]
  v_mfma_f32_16x16x32_bf16 v[12:15], a[172:175], v[116:119], v[12:15]
  s_waitcnt vmcnt(10)
  v_mfma_f32_16x16x32_bf16 v[8:11], a[176:179], v[120:123], v[8:11]
  v_mfma_f32_16x16x32_bf16 v[12:15], a[180:183], v[120:123], v[12:15]
  s_waitcnt vmcnt(9)
  v_mfma_f32_16x16x32_bf16 v[8:11], a[184:187], v[124:127], v[8:11]
  v_mfma_f32_16x16x32_bf16 v[12:15], a[188:191], v[124:127], v[12:15]
  s_waitcnt vmcnt(8)
  v_mfma_f32_16x16x32_bf16 v[8:11], a[192:195], v[128:131], v[8:11]
  v_mfma_f32_16x16x32_bf16 v[12:15], a[196:199], v[128:131], v[12:15]
  s_waitcnt vmcnt(7)
  v_mfma_f32_16x16x32_bf16 v[8:11], a[200:203], v[132:135], v[8:11]
  v_mfma_f32_16x16x32_bf16 v[12:15], a[204:207], v[132:135], v[12:15]
  s_waitcnt vmcnt(6)
  v_mfma_f32_16x16x32_bf16 v[8:11], a[208:211], v[136:139], v[8:11]
  v_mfma_f32_16x16x32_bf16 v[12:15], a[212:215], v[136:139], v[12:15]
  s_waitcnt vmcnt(5)
  v_mfma_f32_16x16x32_bf16 v[8:11], a[216:219], v[140:143], v[8:11]
  v_mfma_f32_16x16x32_bf16 v[12:15], a[220:223], v[140:143], v[12:15]
  s_waitcnt vmcnt(4)
  v_mfma_f32_16x16x32_bf16 v[8:11], a[224:227], v[144:147], v[8:11]
  v_mfma_f32_16x16x32_bf16 v[12:15], a[228:231], v[144:147], v[12:15]
  s_waitcnt vmcnt(3)
  v_mfma_f32_16x16x32_bf16 v[8:11], a[232:235], v[148:151], v[8:11]
  v_mfma_f32_16x16x32_bf16 v[12:15], a[236:239], v[148:151], v[12:15]
  s_waitcnt vmcnt(2)
  v_mfma_f32_16x16x32_bf16 v[8:11], a[240:243], v[152:155], v[8:11]
  v_mfma_f32_16x16x32_bf16 v[12:15], a[244:247], v[152:155], v[12:15]
  s_waitcnt vmcnt(1)
  v_mfma_f32_16x16x32_bf16 v[8:11], a[248:251], v[156:159], v[8:11]
  v_mfma_f32_16x16x32_bf16 v[12:15], a[252:255], v[156:159], v[12:15]
  s_waitcnt vmcnt(0)
  v_min_u32 v20, v20, v21
  v_min3_u32 v20, v20, v22, v23
  s_branch L_t3red
L_t3ahead:
  s_mov_b32 s74, 1
  s_waitcnt vmcnt(31)
  v_mfma_f32_16x16x32_bf16 v[8:11], a[0:3], v[32:35], 0
  v_mfma_f32_16x16x32_bf16 v[12:15], a[4:7], v[32:35], 0
  s_add_u32 s73, s69, 0
  buffer_load_dwordx4 v[32:35], v4, s[32:35], s73 offen offset:0 sc1
  s_waitcnt vmcnt(31)
  v_mfma_f32_16x16x32_bf16 v[8:11], a[8:11], v[36:39], v[8:11]
  v_mfma_f32_16x16x32_bf16 v[12:15], a[12:15], v[36:39], v[12:15]
  buffer_load_dwordx4 v[36:39], v4, s[32:35], s73 offen offset:1024 sc1
  s_waitcnt vmcnt(31)
  v_mfma_f32_16x16x32_bf16 v[8:11], a[16:19], v[40:43], v[8:11]
  v_mfma_f32_16x16x32_bf16 v[12:15], a[20:23], v[40:43], v[12:15]
  buffer_load_dwordx4 v[40:43], v4, s[32:35], s73 offen offset:2048 sc1
  s_waitcnt vmcnt(31)
  v_mfma_f32_16x16x32_bf16 v[8:11], a[24:27], v[44:47], v[8:11]
  v_mfma_f32_16x16x32_bf16 v[12:15], a[28:31], v[44:47], v[12:15]
  buffer_load_dwordx4 v[44:47], v4, s[32:35], s73 offen offset:3072 sc1
  s_waitcnt vmcnt(31)
  v_mfma_f32_16x16x32_bf16 v[8:11], a[32:35], v[48:51], v[8:11]
  v_mfma_f32_16x16x32_bf16 v[12:15], a[36:39], v[48:51], v[12:15]
  s_add_u32 s73, s69, 8192
  buffer_load_dwordx4 v[48:51], v4, s[32:35], s73 offen offset:0 sc1
  s_waitcnt vmcnt(31)
  v_mfma_f32_16x16x32_bf16 v[8:11], a[40:43], v[52:55], v[8:11]
  v_mfma_f32_16x16x32_bf16 v[12:15], a[44:47], v[52:55], v[12:15]
  buffer_load_dwordx4 v[52:55], v4, s[32:35], s73 offen offset:1024 sc1
  s_waitcnt vmcnt(31)
  v_mfma_f32_16x16x32_bf16 v[8:11], a[48:51], v[56:59], v[8:11]
  v_mfma_f32_16x16x32_bf16 v[12:15], a[52:55], v[56:59], v[12:15]
  buffer_load_dwordx4 v[56:59], v4, s[32:35], s73 offen offset:2048 sc1
  s_waitcnt vmcnt(31)
  v_mfma_f32_16x16x32_bf16 v[8:11], a[56:59], v[60:63], v[8:11]
  v_mfma_f32_16x16x32_bf16 v[12:15], a[60:63], v[60:63], v[12:15]
  buffer_load_dwordx4 v[60:63], v4, s[32:35], s73 offen offset:3072 sc1
  s_waitcnt vmcnt(31)
  v_mfma_f32_16x16x32_bf16 v[8:11], a[64:67], v[64:67], v[8:11]
  v_mfma_f32_16x16x32_bf16 v[12:15], a[68:71], v[64:67], v[12:15]
  s_add_u32 s73, s69, 16384
  buffer_load_dwordx4 v[64:67], v4, s[32:35], s73 offen offset:0 sc1
  s_waitcnt vmcnt(31)
  v_mfma_f32_16x16x32_bf16 v[8:11], a[72:75], v[68:71], v[8:11]
  v_mfma_f32_16x16x32_bf16 v[12:15], a[76:79], v[68:71], v[12:15]
  buffer_load_dwordx4 v[68:71], v4, s[32:35], s73 offen offset:1024 sc1
  s_waitcnt vmcnt(31)
  v_mfma_f32_16x16x32_bf16 v[8:11], a[80:83], v[72:75], v[8:11]
  v_mfma_f32_16x16x32_bf16 v[12:15], a[84:87], v[72:75], v[12:15]
  buffer_load_dwordx4 v[72:75], v4, s[32:35], s73 offen offset:2048 sc1
  s_waitcnt vmcnt(31)
  v_mfma_f32_16x16x32_bf16 v[8:11], a[88:91], v[76:79], v[8:11]
  v_mfma_f32_16x16x32_bf16 v[12:15], a[92:95], v[76:79], v[12:15]
  buffer_load_dwordx4 v[76:79], v4, s[32:35], s73 offen offset:3072 sc1
  s_waitcnt vmcnt(31)
  v_mfma_f32_16x16x32_bf16 v[8:11], a[96:99], v[80:83], v[8:11]
  v_mfma_f32_16x16x32_bf16 v[12:15], a[100:103], v[80:83], v[12:15]
  s_add_u32 s73, s69, 24576
  buffer_load_dwordx4 v[80:83], v4, s[32:35], s73 offen offset:0 sc1
  s_waitcnt vmcnt(31)
  v_mfma_f32_16x16x32_bf16 v[8:11], a[104:107], v[84:87], v[8:11]
  v_mfma_f32_16x16x32_bf16 v[12:15], a[108:111], v[84:87], v[12:15]
  buffer_load_dwordx4 v[84:87], v4, s[32:35], s73 offen offset:1024 sc1
  s_waitcnt vmcnt(31)
  v_mfma_f32_16x16x32_bf16 v[8:11], a[112:115], v[88:91], v[8:11]
  v_mfma_f32_16x16x32_bf16 v[12:15], a[116:119], v[88:91], v[12:15]
  buffer_load_dwordx4 v[88:91], v4, s[32:35], s73 offen offset:2048 sc1
  s_waitcnt vmcnt(31)
  v_mfma_f32_16x16x32_bf16 v[8:11], a[120:123], v[92:95], v[8:11]
  v_mfma_f32_16x16x32_bf16 v[12:15], a[124:127], v[92:95], v[12:15]
  buffer_load_dwordx4 v[92:95], v4, s[32:35], s73 offen offset:3072 sc1
  s_waitcnt vmcnt(31)
  v_mfma_f32_16x16x32_bf16 v[8:11], a[128:131], v[96:99], v[8:11]
  v_mfma_f32_16x16x32_bf16 v[12:15], a[132:135], v[96:99], v[12:15]
  s_add_u32 s73, s69, 32768
  buffer_load_dwordx4 v[96:99], v4, s[32:35], s73 offen offset:0 sc1
  s_waitcnt vmcnt(31)
  v_mfma_f32_16x16x32_bf16 v[8:11], a[136:139], v[100:103], v[8:11]
  v_mfma_f32_16x16x32_bf16 v[12:15], a[140:143], v[100:103], v[12:15]
  buffer_load_dwordx4 v[100:103], v4, s[32:35], s73 offen offset:1024 sc1
  s_waitcnt vmcnt(31)
  v_mfma_f32_16x16x32_bf16 v[8:11], a[144:147], v[104:107], v[8:11]
  v_mfma_f32_16x16x32_bf16 v[12:15], a[148:151], v[104:107], v[12:15]
  buffer_load_dwordx4 v[104:107], v4, s[32:35], s73 offen offset:2048 sc1
  s_waitcnt vmcnt(31)
  v_mfma_f32_16x16x32_bf16 v[8:11], a[152:155], v[108:111], v[8:11]
  v_mfma_f32_16x16x32_bf16 v[12:15], a[156:159], v[108:111], v[12:15]
  buffer_load_dwordx4 v[108:111], v4, s[32:35], s73 offen offset:3072 sc1
  s_waitcnt vmcnt(31)
  v_mfma_f32_16x16x32_bf16 v[8:11], a[160:163], v[112:115], v[8:11]
  v_mfma_f32_16x16x32_bf16 v[12:15], a[164:167], v[112:115], v[12:15]
  s_add_u32 s73, s69, 40960
  buffer_load_dwordx4 v[112:115], v4, s[32:35], s73 offen offset:0 sc1
  s_waitcnt vmcnt(31)
  v_mfma_f32_16x16x32_bf16 v[8:11], a[168:171], v[116:119], v[8:11]
  v_mfma_f32_16x16x32_bf16 v[12:15], a[172:175], v[116:119], v[12:15]
  buffer_load_dwordx4 v[116:119], v4, s[32:35], s73 offen offset:1024 sc1
  s_waitcnt vmcnt(31)
  v_mfma_f32_16x16x32_bf16 v[8:11], a[176:179], v[120:123], v[8:11]
  v_mfma_f32_16x16x32_bf16 v[12:15], a[180:183], v[120:123], v[12:15]
  buffer_load_dwordx4 v[120:123], v4, s[32:35], s73 offen offset:2048 sc1
  s_waitcnt vmcnt(31)
  v_mfma_f32_16x16x32_bf16 v[8:11], a[184:187], v[124:127], v[8:11]
  v_mfma_f32_16x16x32_bf16 v[12:15], a[188:191], v[124:127], v[12:15]
  buffer_load_dwordx4 v[124:127], v4, s[32:35], s73 offen offset:3072 sc1
  s_waitcnt vmcnt(31)
  v_mfma_f32_16x16x32_bf16 v[8:11], a[192:195], v[128:131], v[8:11]
  v_mfma_f32_16x16x32_bf16 v[12:15], a[196:199], v[128:131], v[12:15]
  s_add_u32 s73, s69, 49152
  buffer_load_dwordx4 v[128:131], v4, s[32:35], s73 offen offset:0 sc1
  s_waitcnt vmcnt(31)
  v_mfma_f32_16x16x32_bf16 v[8:11], a[200:203], v[132:135], v[8:11]
  v_mfma_f32_16x16x32_bf16 v[12:15], a[204:207], v[132:135], v[12:15]
  buffer_load_dwordx4 v[132:135], v4, s[32:35], s73 offen offset:1024 sc1
  s_waitcnt vmcnt(31)
  v_mfma_f32_16x16x32_bf16 v[8:11], a[208:211], v[136:139], v[8:11]
  v_mfma_f32_16x16x32_bf16 v[12:15], a[212:215], v[136:139], v[12:15]
  buffer_load_dwordx4 v[136:139], v4, s[32:35], s73 offen offset:2048 sc1
  s_waitcnt vmcnt(31)
  v_mfma_f32_16x16x32_bf16 v[8:11], a[216:219], v[140:143], v[8:11]
  v_mfma_f32_16x16x32_bf16 v[12:15], a[220:223], v[140:143], v[12:15]
  buffer_load_dwordx4 v[140:143], v4, s[32:35], s73 offen offset:3072 sc1
  s_waitcnt vmcnt(31)
  v_mfma_f32_16x16x32_bf16 v[8:11], a[224:227], v[144:147], v[8:11]
  v_mfma_f32_16x16x32_bf16 v[12:15], a[228:231], v[144:147], v[12:15]
  s_add_u32 s73, s69, 57344
  buffer_load_dwordx4 v[144:147], v4, s[32:35], s73 offen offset:0 sc1
  s_waitcnt vmcnt(31)
  v_mfma_f32_16x16x32_bf16 v[8:11], a[232:235], v[148:151], v[8:11]
  v_mfma_f32_16x16x32_bf16 v[12:15], a[236:239], v[148:151], v[12:15]
  buffer_load_dwordx4 v[148:151], v4, s[32:35], s73 offen offset:1024 sc1
  s_waitcnt vmcnt(31)
  v_mfma_f32_16x16x32_bf16 v[8:11], a[240:243], v[152:155], v[8:11]
  v_mfma_f32_16x16x32_bf16 v[12:15], a[244:247], v[152:155], v[12:15]
  buffer_load_dwordx4 v[152:155], v4, s[32:35], s73 offen offset:2048 sc1
  s_waitcnt vmcnt(31)
  v_mfma_f32_16x16x32_bf16 v[8:11], a[248:251], v[156:159], v[8:11]
  v_mfma_f32_16x16x32_bf16 v[12:15], a[252:255], v[156:159], v[12:15]
  buffer_load_dwordx4 v[156:159], v4, s[32:35], s73 offen offset:3072 sc1
L_t3red:
  s_nop 4
  s_nop 0
  ds_write_b128 v6, v[8:11]
  ds_write_b128 v6, v[12:15] offset:1024
  v_xor_b32 v6, 8192, v6
  s_waitcnt lgkmcnt(0)
  s_barrier
  s_cmp_lg_u32 s56, 0
  s_cbranch_scc1 L_t3n
  v_xor_b32 v24, 8192, v6
  ds_read_b128 v[160:163], v24 offset:2048
  ds_read_b128 v[164:167], v24 offset:3072
  ds_read_b128 v[168:171], v24 offset:4096
  ds_read_b128 v[172:175], v24 offset:5120
  ds_read_b128 v[176:179], v24 offset:6144
  ds_read_b128 v[180:183], v24 offset:7168
  s_waitcnt lgkmcnt(0)
  v_pk_add_f32 v[8:9], v[8:9], v[160:161]
  v_pk_add_f32 v[10:11], v[10:11], v[162:163]
  v_pk_add_f32 v[12:13], v[12:13], v[164:165]
  v_pk_add_f32 v[14:15], v[14:15], v[166:167]
  v_pk_add_f32 v[8:9], v[8:9], v[168:169]
  v_pk_add_f32 v[10:11], v[10:11], v[170:171]
  v_pk_add_f32 v[12:13], v[12:13], v[172:173]
  v_pk_add_f32 v[14:15], v[14:15], v[174:175]
  v_pk_add_f32 v[8:9], v[8:9], v[176:177]
  v_pk_add_f32 v[10:11], v[10:11], v[178:179]
  v_pk_add_f32 v[12:13], v[12:13], v[180:181]
  v_pk_add_f32 v[14:15], v[14:15], v[182:183]
  v_cvt_pk_bf16_f32 v16, v8, v9
  v_cvt_pk_bf16_f32 v17, v10, v11
  v_cvt_pk_bf16_f32 v18, v12, v13
  v_cvt_pk_bf16_f32 v19, v14, v15
  buffer_store_dwordx4 v[16:19], v5, s[44:47], s72 offen sc1
L_t3n:

  s_add_u32 s72, s72, 81920
  s_add_u32 s60, s60, 1
  s_cmp_le_u32 s60, s76
  s_cbranch_scc1 L_t3loop
  s_endpgm
L_spare:
  s_sub_u32 s59, s31, 112
  v_lshlrev_b32 v8, 4, v1
  v_mov_b32 v12, -1
  v_mov_b32 v13, -1
  v_mov_b32 v14, -1
  v_mov_b32 v15, -1
  v_mov_b32 v16, 0
  v_mov_b32 v17, 0
  v_mov_b32 v18, 0
  v_mov_b32 v19, 0
  s_lshl_b32 s60, s59, 2
  s_add_u32 s60, s60, s56
IN_49:
  s_lshl_b32 s61, s60, 10
  s_sub_u32 s62, s60, 128
  s_cmp_lt_u32 s62, 8
  s_cbranch_scc1 INX_52
  s_sub_u32 s62, s60, 144
  s_cmp_lt_u32 s62, 2
  s_cbranch_scc1 INX_52
  s_cmp_ge_u32 s60, 2048
  s_cbranch_scc1 IZ_50
  s_sub_u32 s62, s60, 208
  s_cmp_lt_u32 s62, 48
  s_cselect_b32 s62, 1, 0
  v_mov_b32 v16, s62
  s_and_b32 s62, s60, 255
  s_cmp_ge_u32 s62, 160
  s_cbranch_scc1 IZ_50
  buffer_store_dwordx4 v[12:15], v8, s[48:51], s61 offen sc1
  s_branch INX_52
IZ_50:
  buffer_store_dwordx4 v[16:19], v8, s[48:51], s61 offen sc1
  s_cmp_lt_u32 s60, 2048
  s_cbranch_scc1 INX_52
  s_add_u32 s61, s61, 85983232
  v_mov_b32 v16, 0
  buffer_store_dwordx4 v[16:19], v8, s[32:35], s61 offen sc1
INX_52:
  s_add_u32 s60, s60, 64
  s_cmp_lt_u32 s60, 2116
  s_cbranch_scc1 IN_49
  s_lshl_b32 s60, s59, 2
  s_add_u32 s60, s60, s56
  s_cmp_lg_u32 s60, 63
  s_cbranch_scc1 IE_51
  s_mov_b32 s36, s12
  s_mov_b32 s37, s13
  s_mov_b32 s38, 10240
  v_bfe_u32 v9, v1, 3, 1
  v_lshlrev_b32 v9, 2, v9
  v_and_b32 v10, 3, v1
  v_add_u32 v9, v9, v10
  v_mul_u32_u24 v9, 1280, v9
  v_lshrrev_b32 v10, 4, v1
  v_lshl_add_u32 v9, v10, 5, v9
  v_bfe_u32 v10, v1, 2, 1
  v_lshl_add_u32 v9, v10, 4, v9
  buffer_load_dwordx4 v[24:27], v9, s[36:39], 0 offen offset:0
  buffer_load_dwordx4 v[28:31], v9, s[36:39], 0 offen offset:128
  buffer_load_dwordx4 v[32:35], v9, s[36:39], 0 offen offset:256
  buffer_load_dwordx4 v[36:39], v9, s[36:39], 0 offen offset:384
  buffer_load_dwordx4 v[40:43], v9, s[36:39], 0 offen offset:512
  buffer_load_dwordx4 v[44:47], v9, s[36:39], 0 offen offset:640
  buffer_load_dwordx4 v[48:51], v9, s[36:39], 0 offen offset:768
  buffer_load_dwordx4 v[52:55], v9, s[36:39], 0 offen offset:896
  buffer_load_dwordx4 v[56:59], v9, s[36:39], 0 offen offset:1024
  buffer_load_dwordx4 v[60:63], v9, s[36:39], 0 offen offset:1152
  s_waitcnt vmcnt(0)
  v_min_u32 v24, -2, v24
  v_min_u32 v25, -2, v25
  v_min_u32 v26, -2, v26
  v_min_u32 v27, -2, v27
  s_mov_b32 s61, 131072
  buffer_store_dwordx4 v[24:27], v8, s[48:51], s61 offen sc1
  v_min_u32 v28, -2, v28
  v_min_u32 v29, -2, v29
  v_min_u32 v30, -2, v30
  v_min_u32 v31, -2, v31
  s_mov_b32 s61, 132096
  buffer_store_dwordx4 v[28:31], v8, s[48:51], s61 offen sc1
  v_min_u32 v32, -2, v32
  v_min_u32 v33, -2, v33
  v_min_u32 v34, -2, v34
  v_min_u32 v35, -2, v35
  s_mov_b32 s61, 133120
  buffer_store_dwordx4 v[32:35], v8, s[48:51], s61 offen sc1
  v_min_u32 v36, -2, v36
  v_min_u32 v37, -2, v37
  v_min_u32 v38, -2, v38
  v_min_u32 v39, -2, v39
  s_mov_b32 s61, 134144
  buffer_store_dwordx4 v[36:39], v8, s[48:51], s61 offen sc1
  v_min_u32 v40, -2, v40
  v_min_u32 v41, -2, v41
  v_min_u32 v42, -2, v42
  v_min_u32 v43, -2, v43
  s_mov_b32 s61, 135168
  buffer_store_dwordx4 v[40:43], v8, s[48:51], s61 offen sc1
  v_min_u32 v44, -2, v44
  v_min_u32 v45, -2, v45
  v_min_u32 v46, -2, v46
  v_min_u32 v47, -2, v47
  s_mov_b32 s61, 136192
  buffer_store_dwordx4 v[44:47], v8, s[48:51], s61 offen sc1
  v_min_u32 v48, -2, v48
  v_min_u32 v49, -2, v49
  v_min_u32 v50, -2, v50
  v_min_u32 v51, -2, v51
  s_mov_b32 s61, 137216
  buffer_store_dwordx4 v[48:51], v8, s[48:51], s61 offen sc1
  v_min_u32 v52, -2, v52
  v_min_u32 v53, -2, v53
  v_min_u32 v54, -2, v54
  v_min_u32 v55, -2, v55
  s_mov_b32 s61, 138240
  buffer_store_dwordx4 v[52:55], v8, s[48:51], s61 offen sc1
  v_min_u32 v56, -2, v56
  v_min_u32 v57, -2, v57
  v_min_u32 v58, -2, v58
  v_min_u32 v59, -2, v59
  s_mov_b32 s61, 147456
  buffer_store_dwordx4 v[56:59], v8, s[48:51], s61 offen sc1
  v_min_u32 v60, -2, v60
  v_min_u32 v61, -2, v61
  v_min_u32 v62, -2, v62
  v_min_u32 v63, -2, v63
  s_mov_b32 s61, 148480
  buffer_store_dwordx4 v[60:63], v8, s[48:51], s61 offen sc1
IE_51:
  s_getpc_b64 s[64:65]
CW_53:
  s_sub_u32 s64, s64, CW_53-concat_heads__sliding_block__memory_aug_recurrent_mem_tr__prompt_kernel
  s_subb_u32 s65, s65, 0
  s_mov_b32 s66, L_exit-concat_heads__sliding_block__memory_aug_recurrent_mem_tr__prompt_kernel
  s_mov_b32 s67, 0x20000
  v_lshlrev_b32 v30, 4, v0
  s_lshr_b32 s60, s59, 2
  s_and_b32 s60, s60, 1
  s_mul_i32 s60, s60, 40960
  buffer_load_dwordx4 v[204:207], v30, s[64:67], s60 offen
  s_add_u32 s60, s60, 4096
  buffer_load_dwordx4 v[208:211], v30, s[64:67], s60 offen
  s_add_u32 s60, s60, 4096
  buffer_load_dwordx4 v[212:215], v30, s[64:67], s60 offen
  s_add_u32 s60, s60, 4096
  buffer_load_dwordx4 v[216:219], v30, s[64:67], s60 offen
  s_add_u32 s60, s60, 4096
  buffer_load_dwordx4 v[220:223], v30, s[64:67], s60 offen
  s_add_u32 s60, s60, 4096
  buffer_load_dwordx4 v[224:227], v30, s[64:67], s60 offen
  s_add_u32 s60, s60, 4096
  buffer_load_dwordx4 v[228:231], v30, s[64:67], s60 offen
  s_add_u32 s60, s60, 4096
  buffer_load_dwordx4 v[232:235], v30, s[64:67], s60 offen
  s_add_u32 s60, s60, 4096
  buffer_load_dwordx4 v[236:239], v30, s[64:67], s60 offen
  s_add_u32 s60, s60, 4096
  buffer_load_dwordx4 v[240:243], v30, s[64:67], s60 offen
  s_add_u32 s60, s60, 4096
  s_waitcnt vmcnt(10)
  s_barrier
  s_cmp_lg_u32 s56, 0
  s_cbranch_scc1 AR_54
  s_mov_b64 exec, 1
  v_mov_b32 v20, 0
  v_mov_b32 v21, 1
  buffer_atomic_add v21, v20, s[52:55], 0 offen sc1
  s_mov_b64 exec, -1
AR_54:
  s_sleep 1
  v_mov_b32 v21, 0
  s_movk_i32 s71, 16
  s_mov_b64 exec, 1
  s_mov_b32 s70, 0
SP_55:
  buffer_load_dword v20, v21, s[52:55], 0 offen sc1
  s_waitcnt vmcnt(0)
  v_cmp_gt_u32 vcc, s71, v20
  s_cbranch_vccz SD_56
  s_sleep 4
  s_add_u32 s70, s70, 1
  s_cmp_lt_u32 s70, 539568
  s_cbranch_scc1 SP_55
  s_endpgm
SD_56:
  s_mov_b64 exec, -1
  s_cmp_lg_u32 s56, 0
  s_cbranch_scc1 L_exit
  v_mov_b32 v2, 0
  s_bfe_u32 s60, s31, 0x10002
  s_lshl_b32 s61, s60, 13
  s_and_b32 s62, s31, 3
  s_mul_i32 s62, s62, 896
  s_add_u32 s61, s61, s62
  s_add_u32 s61, s61, 151552
  s_mov_b32 s63, 0
  s_mov_b64 exec, 1
L_walk:
  buffer_store_dword v2, v2, s[48:51], s61 offen sc1
  s_add_u32 s63, s63, 1
  s_cmp_lt_u32 s63, 12
  s_waitcnt vmcnt(0)
  s_cbranch_scc1 L_walk
  v_mov_b32 v4, 132
  v_mov_b32 v5, 1
  buffer_atomic_add v5, v4, s[52:55], 0 offen sc0 sc1
  s_waitcnt vmcnt(0)
  v_readfirstlane_b32 s63, v5
  s_cmp_lt_u32 s63, 4
  s_cselect_b32 s60, s60, 0
  s_add_u32 s60, s60, 0x10000
  v_mov_b32 v5, s60
  v_mov_b32 v4, 128
  buffer_atomic_add v5, v4, s[52:55], 0 offen sc1
  s_endpgm
L_pwexit:
L_exit:
  s_endpgm

.section .rodata,"a"
.p2align 6
.amdhsa_kernel concat_heads__sliding_block__memory_aug_recurrent_mem_tr__prompt_kernel
  .amdhsa_next_free_vgpr 512
  .amdhsa_next_free_sgpr 102
  .amdhsa_accum_offset 256
  .amdhsa_group_segment_fixed_size 0
  .amdhsa_kernarg_size 104
  .amdhsa_user_sgpr_count 2
  .amdhsa_user_sgpr_kernarg_segment_ptr 1
  .amdhsa_system_sgpr_workgroup_id_x 1
.end_amdhsa_kernel
```
